```python
import torch

def _softmax(x, axis=-1):
    return torch.softmax(x, dim=axis)
def _gelu(x):
    return torch.nn.functional.gelu(x, approximate="tanh")
def _silu(x):
    return torch.nn.functional.silu(x)
def _sigmoid(x):
    return torch.sigmoid(x)
def _layernorm(x, axis=-1, eps=1e-5):
    m = x.mean(dim=axis, keepdim=True)
    v = x.var(dim=axis, keepdim=True, unbiased=False)
    return (x - m) / torch.sqrt(v + eps)
def _scatter_add(tgt, idx, src, axis=0):
    return tgt.clone().index_add_(axis, idx, src)
def _segment_sum(src, seg, n):
    out = torch.zeros((n,) + src.shape[1:], dtype=src.dtype)
    return out.index_add_(0, seg, src)
def _pad(x, pw):
    flat = tuple(v for pair in reversed(pw) for v in pair)
    return torch.nn.functional.pad(x, flat)

kernel_name = 'sequential_preLN__sliding_block__dense_activation_gelu__prompt'

def setup_inputs():

    _w = (lambda a: (lambda t: t.to(torch.bfloat16) if t.is_floating_point() else t)(torch.as_tensor(a)))
    def _A_setup():
        B, S, D = 1, 2048, 640
        return {
            "x": _w((lambda *s: torch.randn(*s, dtype=torch.bfloat16) * 0.05)(B, S, D)),
            "wqkv": _w((lambda *s: torch.randn(*s, dtype=torch.bfloat16) * 0.05)(D, 3 * D)),
            "wo": _w((lambda *s: torch.randn(*s, dtype=torch.bfloat16) * 0.05)(D, D)),
        }
    _A_in = _A_setup()

    def _B_setup():
        B, S, D, F = 1, 2048, 640, 1728
        return {
            "x": _w((lambda *s: torch.randn(*s, dtype=torch.bfloat16) * 0.05)(B, S, D)),
            "w1": _w((lambda *s: torch.randn(*s, dtype=torch.bfloat16) * 0.8)(D, F) * (D ** -0.5)),
            "b1": _w((lambda *s: torch.randn(*s, dtype=torch.bfloat16) * 0.8)(F) * 0.01),
            "w2": _w((lambda *s: torch.randn(*s, dtype=torch.bfloat16) * 0.8)(F, D) * (F ** -0.5)),
            "b2": _w((lambda *s: torch.randn(*s, dtype=torch.bfloat16) * 0.8)(D) * 0.01),
        }
    _B_in = _B_setup()

    return {
        "A_x": _A_in["x"],
        "A_wqkv": _A_in["wqkv"],
        "A_wo": _A_in["wo"],
        "B_x": _B_in["x"],
        "B_w1": _B_in["w1"],
        "B_b1": _B_in["b1"],
        "B_w2": _B_in["w2"],
        "B_b2": _B_in["b2"],
    }

def reference(A_x, A_wqkv, A_wo, B_x, B_w1, B_b1, B_w2, B_b2):
    def _A_ref(x, wqkv, wo):
        B, S, D = x.shape
        H = 32; Dh = D // H; W = 256
        qkv = (lambda x, *d: x.permute(*d))((x @ wqkv).reshape(B, S, 3, H, Dh), 2, 0, 3, 1, 4)
        q, k, v = qkv[0], qkv[1], qkv[2]
        scores = torch.einsum("bhqd,bhkd->bhqk", q, k) * (Dh ** -0.5)
        idx = torch.arange(S)
        mask = (idx[:, None] - idx[None, :] >= 0) & (idx[:, None] - idx[None, :] < W)
        scores = torch.where(mask[None, None], scores, -1e9)
        p = _softmax(scores, axis=-1)
        o = torch.einsum("bhqk,bhkd->bhqd", p, v)
        return (lambda x, *d: x.permute(*d))(o, 0, 2, 1, 3).reshape(B, S, D) @ wo

    def _B_ref(x, w1, b1, w2, b2):
        h = torch.einsum("bsd,df->bsf", x, w1) + b1
        h = _gelu(h)
        return torch.einsum("bsf,fd->bsd", h, w2) + b2

    x = A_x
    h = x + _A_ref(_layernorm(x, axis=-1), A_wqkv, A_wo)
    h2 = h + _B_ref(_layernorm(h, axis=-1), B_w1, B_b1, B_w2, B_b2)
    return h2
```

```asm
; @launch grid=(256,1,1) block=(512,1,1) lds=163840
.amdgcn_target "amdgcn-amd-amdhsa--gfx950"
.text
.globl sequential_preLN__sliding_block__dense_activation_gelu__prompt_kernel
.p2align 8
.type sequential_preLN__sliding_block__dense_activation_gelu__prompt_kernel,@function
sequential_preLN__sliding_block__dense_activation_gelu__prompt_kernel:
    s_cmp_ge_u32 s2, 256
    s_cbranch_scc1 L_end
    s_load_dwordx16 s[64:79], s[0:1], 0
    s_getpc_b64 s[60:61]
L_cpf0:
    s_sub_u32 s60, s60, L_cpf0-sequential_preLN__sliding_block__dense_activation_gelu__prompt_kernel
    s_subb_u32 s61, s61, 0
    s_mov_b32 s62, L_TABEND-sequential_preLN__sliding_block__dense_activation_gelu__prompt_kernel
    s_mov_b32 s63, 0x20000
    v_lshrrev_b32 v2, 6, v0
    v_and_b32 v3, 1, v0
    v_lshl_add_u32 v2, v2, 1, v3
    v_lshlrev_b32 v2, 7, v2
    s_lshr_b32 s57, s2, 3
    s_lshl_b32 s57, s57, 11
    s_mov_b64 exec, 3
    buffer_load_dword v252, v2, s[60:63], s57 offen
    s_mov_b64 exec, -1
    s_load_dwordx4 s[80:83], s[0:1], 64
    s_load_dwordx2 s[84:85], s[0:1], 80
    v_lshrrev_b32 v2, 6, v0
    v_and_b32 v1, 63, v0
    v_readfirstlane_b32 s48, v2
    s_and_b32 s49, s2, 7
    s_lshr_b32 s50, s2, 3
    s_lshr_b32 s57, s49, 1
    s_lshl_b32 s57, s57, 2
    s_lshr_b32 s58, s50, 3
    s_add_u32 s53, s57, s58
    s_and_b32 s57, s49, 1
    s_lshl_b32 s57, s57, 3
    s_and_b32 s58, s50, 7
    s_add_u32 s54, s57, s58
    s_getreg_b32 s51, hwreg(HW_REG_XCC_ID)
    s_and_b32 s51, s51, 31
    s_min_u32 s57, s53, 13
    s_movk_i32 s58, 3840
    s_movk_i32 s59, 3456
    s_mov_b32 s60, 2457600
    s_mov_b32 s61, 2211840
    s_waitcnt lgkmcnt(0)
    s_mov_b32 s8, s64
    s_mov_b32 s9, s65
    s_mov_b32 s10, 2621440
    s_mov_b32 s11, 0x20000
    s_cmp_lt_u32 s54, 15
    s_cselect_b32 s12, s66, s72
    s_cselect_b32 s13, s67, s73
    s_cselect_b32 s14, s60, s61
    s_mov_b32 s15, 0x20000
    s_cselect_b32 s55, s58, s59
    s_cselect_b32 s56, s54, s57
    s_mov_b32 s28, s84
    s_mov_b32 s29, s85
    s_mov_b32 s30, 27262976
    s_mov_b32 s31, 0x20000
    s_mov_b32 s36, s82
    s_mov_b32 s37, s83
    s_mov_b32 s38, 256
    s_mov_b32 s39, 0x20000
    s_cmp_ge_u32 s48, 4
    s_cbranch_scc0 L_M_start
    v_mov_b32 v30, 0
    v_lshlrev_b32 v8, 4, v1
    v_lshrrev_b32 v5, 3, v1
    v_lshrrev_b32 v6, 4, v1
    v_and_b32 v7, 7, v1
    v_xor_b32 v7, v7, v6
    v_mul_u32_u24 v5, 1280, v5
    v_lshl_add_u32 v2, v7, 4, v5
    v_xor_b32 v3, 64, v2
    v_lshlrev_b32 v7, 2, v6
    v_sub_u32 v7, v1, v7
    v_and_b32 v7, 15, v7
    v_mul_lo_u32 v5, v6, s55
    v_lshl_add_u32 v4, v7, 4, v5
    s_sub_u32 s63, s48, 4
    s_lshl_b32 s62, s53, 7
    s_lshl_b32 s86, s63, 5
    s_add_u32 s62, s62, s86
    s_mul_i32 s57, s62, 1280
    s_lshl_b32 s60, s55, 2
    s_lshl_b32 s61, s55, 6
    s_lshl_b32 s62, s63, 4
    s_mul_i32 s58, s62, s55
    s_lshl_b32 s62, s56, 8
    s_add_u32 s58, s58, s62
    s_lshl_b32 s59, s63, 12
    s_cmp_eq_u32 s54, 15
    s_cbranch_scc1 L_H_cs
    s_add_u32 m0, s59, 0
    s_nop 0
    buffer_load_dwordx4 v2, s[8:11], s57 offen lds
    s_add_u32 m0, s59, 1024
    s_add_u32 s62, s57, 10240
    buffer_load_dwordx4 v3, s[8:11], s62 offen lds
    s_add_u32 m0, s59, 2048
    s_add_u32 s62, s57, 20480
    buffer_load_dwordx4 v2, s[8:11], s62 offen lds
    s_add_u32 m0, s59, 3072
    s_add_u32 s62, s57, 30720
    buffer_load_dwordx4 v3, s[8:11], s62 offen lds
    s_add_u32 m0, s59, 16384
    s_mov_b32 s62, s58
    buffer_load_dwordx4 v4, s[12:15], s62 offen lds
    s_add_u32 m0, s59, 17408
    s_add_u32 s62, s62, s60
    buffer_load_dwordx4 v4, s[12:15], s62 offen lds
    s_add_u32 m0, s59, 18432
    s_add_u32 s62, s62, s60
    buffer_load_dwordx4 v4, s[12:15], s62 offen lds
    s_add_u32 m0, s59, 19456
    s_add_u32 s62, s62, s60
    buffer_load_dwordx4 v4, s[12:15], s62 offen lds
    s_add_u32 s57, s57, 128
    s_add_u32 s58, s58, s61
    s_add_u32 m0, s59, 32768
    s_nop 0
    buffer_load_dwordx4 v2, s[8:11], s57 offen lds
    s_add_u32 m0, s59, 33792
    s_add_u32 s62, s57, 10240
    buffer_load_dwordx4 v3, s[8:11], s62 offen lds
    s_add_u32 m0, s59, 34816
    s_add_u32 s62, s57, 20480
    buffer_load_dwordx4 v2, s[8:11], s62 offen lds
    s_add_u32 m0, s59, 35840
    s_add_u32 s62, s57, 30720
    buffer_load_dwordx4 v3, s[8:11], s62 offen lds
    s_add_u32 m0, s59, 49152
    s_mov_b32 s62, s58
    buffer_load_dwordx4 v4, s[12:15], s62 offen lds
    s_add_u32 m0, s59, 50176
    s_add_u32 s62, s62, s60
    buffer_load_dwordx4 v4, s[12:15], s62 offen lds
    s_add_u32 m0, s59, 51200
    s_add_u32 s62, s62, s60
    buffer_load_dwordx4 v4, s[12:15], s62 offen lds
    s_add_u32 m0, s59, 52224
    s_add_u32 s62, s62, s60
    buffer_load_dwordx4 v4, s[12:15], s62 offen lds
    s_add_u32 s57, s57, 128
    s_add_u32 s58, s58, s61
    s_mov_b32 s16, s68
    s_mov_b32 s17, s69
    s_mov_b32 s18, 819200
    s_mov_b32 s19, 0x20000
    s_mov_b32 s20, s72
    s_mov_b32 s21, s73
    s_mov_b32 s22, 2211840
    s_mov_b32 s23, 0x20000
    s_mov_b32 s24, s76
    s_mov_b32 s25, s77
    s_mov_b32 s26, 2211840
    s_mov_b32 s27, 0x20000
    s_mov_b32 s32, s80
    s_mov_b32 s33, s81
    s_mov_b32 s34, 2621440
    s_mov_b32 s35, 0x20000
    s_mov_b32 s40, s74
    s_mov_b32 s41, s75
    s_mov_b32 s42, 3456
    s_mov_b32 s43, 0x20000
    s_mov_b32 s44, s78
    s_mov_b32 s45, s79
    s_mov_b32 s46, 1280
    s_mov_b32 s47, 0x20000
    v_mov_b32 v8, 161312
    v_mov_b32 v12, 0
    v_mov_b32 v13, 0
    v_mov_b32 v14, 0
    v_mov_b32 v15, 0
    ds_write_b128 v8, v[12:15]
    ds_write_b128 v8, v[12:15] offset:32
    ds_write_b128 v8, v[12:15] offset:48
    ds_write_b128 v8, v[12:15] offset:64
    ds_write_b128 v8, v[12:15] offset:192
    ds_write_b128 v8, v[12:15] offset:208
    ds_write_b128 v8, v[12:15] offset:224
    ds_write_b128 v8, v[12:15] offset:240
    ds_write_b128 v8, v[12:15] offset:1824
    v_mov_b32 v12, 0x7fffffff
    ds_write_b128 v8, v[12:15] offset:1840
    ds_write_b128 v8, v[12:15] offset:16
    ds_write_b128 v8, v[12:15] offset:80
    s_waitcnt lgkmcnt(0)
    s_sub_u32 s86, s48, 5
    s_lshl_b32 s86, s86, 8
    s_add_u32 s86, s86, s2
    s_mov_b32 s92, -1
    s_mov_b32 s91, 0x20000
    s_mov_b32 s93, 0
    s_mov_b32 s88, s76
    s_mov_b32 s89, s77
    s_mov_b32 s90, 2211840
    s_mov_b32 s87, 0
    s_cmp_ge_u32 s86, 592
    s_cbranch_scc1 L_H_ps_1
    s_cmp_lt_u32 s86, 160
    s_cbranch_scc1 L_H_ps_wo_1
    s_sub_u32 s86, s86, 160
    s_mul_hi_u32 s62, s86, 79536432
    s_mul_i32 s63, s62, 54
    s_sub_u32 s63, s86, s63
    s_mul_i32 s87, s63, 40960
    s_mul_i32 s93, s62, 160
    s_add_u32 s87, s87, s93
    s_mul_i32 s92, s62, 276480
    s_mul_i32 s93, s63, 5120
    s_add_u32 s92, s92, s93
    s_add_u32 s92, s92, 24117248
    s_mov_b32 s93, 2560
    s_branch L_H_ps_1
L_H_ps_wo_1:
    s_mul_hi_u32 s62, s86, 214748365
    s_mul_i32 s63, s62, 20
    s_sub_u32 s63, s86, s63
    s_mul_i32 s92, s62, 102400
    s_mul_i32 s93, s63, 5120
    s_add_u32 s92, s92, s93
    s_add_u32 s92, s92, 23068672
    s_mov_b32 s88, s68
    s_mov_b32 s89, s69
    s_mov_b32 s90, 819200
    s_mul_i32 s62, s62, 160
    s_cmp_lt_u32 s63, 16
    s_cbranch_scc0 L_H_ps_wot_1
    s_mul_i32 s87, s63, 51200
    s_add_u32 s87, s87, s62
    s_mov_b32 s93, 0
    s_branch L_H_ps_1
L_H_ps_wot_1:
    s_sub_u32 s87, s63, 16
    s_mul_i32 s87, s87, 204800
    s_add_u32 s87, s87, s62
    s_mov_b32 s93, 1280
L_H_ps_1:
    s_getpc_b64 s[64:65]
L_H_pc_1:
    s_add_u32 s64, s64, L_TAB-L_H_pc_1
    s_addc_u32 s65, s65, 0
    s_mov_b32 s66, 3840
    s_mov_b32 s67, 0x20000
    v_lshlrev_b32 v40, 2, v1
    buffer_load_dword v220, v40, s[64:67], s93 offen offset:0
    buffer_load_dword v221, v40, s[64:67], s93 offen offset:256
    buffer_load_dword v222, v40, s[64:67], s93 offen offset:512
    buffer_load_dword v223, v40, s[64:67], s93 offen offset:768
    buffer_load_dword v224, v40, s[64:67], s93 offen offset:1024
    s_waitcnt vmcnt(13)
    s_barrier
    s_add_u32 m0, s59, 65536
    s_nop 0
    buffer_load_dwordx4 v2, s[8:11], s57 offen lds
    s_add_u32 m0, s59, 66560
    s_add_u32 s62, s57, 10240
    buffer_load_dwordx4 v3, s[8:11], s62 offen lds
    s_add_u32 m0, s59, 67584
    s_add_u32 s62, s57, 20480
    buffer_load_dwordx4 v2, s[8:11], s62 offen lds
    s_add_u32 m0, s59, 68608
    s_add_u32 s62, s57, 30720
    buffer_load_dwordx4 v3, s[8:11], s62 offen lds
    s_add_u32 m0, s59, 81920
    s_mov_b32 s62, s58
    buffer_load_dwordx4 v4, s[12:15], s62 offen lds
    s_add_u32 m0, s59, 82944
    s_add_u32 s62, s62, s60
    buffer_load_dwordx4 v4, s[12:15], s62 offen lds
    s_add_u32 m0, s59, 83968
    s_add_u32 s62, s62, s60
    buffer_load_dwordx4 v4, s[12:15], s62 offen lds
    s_add_u32 m0, s59, 84992
    s_add_u32 s62, s62, s60
    buffer_load_dwordx4 v4, s[12:15], s62 offen lds
    s_add_u32 s57, s57, 128
    s_add_u32 s58, s58, s61
    s_cmp_lg_u32 s48, 4
    s_cbranch_scc1 L_H_np1
    buffer_load_dwordx2 v[28:29], v30, s[36:39], 0 offen sc1
L_H_np1:
    s_cmp_eq_u32 s48, 4
    s_cbranch_scc1 L_H_w4a1
    s_waitcnt vmcnt(13)
    s_branch L_H_w4b1
L_H_w4a1:
    s_waitcnt vmcnt(14)
L_H_w4b1:
    s_barrier
    s_add_u32 m0, s59, 98304
    s_nop 0
    buffer_load_dwordx4 v2, s[8:11], s57 offen lds
    s_add_u32 m0, s59, 99328
    s_add_u32 s62, s57, 10240
    buffer_load_dwordx4 v3, s[8:11], s62 offen lds
    s_add_u32 m0, s59, 100352
    s_add_u32 s62, s57, 20480
    buffer_load_dwordx4 v2, s[8:11], s62 offen lds
    s_add_u32 m0, s59, 101376
    s_add_u32 s62, s57, 30720
    buffer_load_dwordx4 v3, s[8:11], s62 offen lds
    s_add_u32 m0, s59, 114688
    s_mov_b32 s62, s58
    buffer_load_dwordx4 v4, s[12:15], s62 offen lds
    s_add_u32 m0, s59, 115712
    s_add_u32 s62, s62, s60
    buffer_load_dwordx4 v4, s[12:15], s62 offen lds
    s_add_u32 m0, s59, 116736
    s_add_u32 s62, s62, s60
    buffer_load_dwordx4 v4, s[12:15], s62 offen lds
    s_add_u32 m0, s59, 117760
    s_add_u32 s62, s62, s60
    buffer_load_dwordx4 v4, s[12:15], s62 offen lds
    s_add_u32 s57, s57, 128
    s_add_u32 s58, s58, s61
    s_waitcnt vmcnt(8)
    s_barrier
    s_add_u32 m0, s59, 0
    s_nop 0
    buffer_load_dwordx4 v2, s[8:11], s57 offen lds
    s_add_u32 m0, s59, 1024
    s_add_u32 s62, s57, 10240
    buffer_load_dwordx4 v3, s[8:11], s62 offen lds
    s_add_u32 m0, s59, 2048
    s_add_u32 s62, s57, 20480
    buffer_load_dwordx4 v2, s[8:11], s62 offen lds
    s_add_u32 m0, s59, 3072
    s_add_u32 s62, s57, 30720
    buffer_load_dwordx4 v3, s[8:11], s62 offen lds
    s_add_u32 m0, s59, 16384
    s_mov_b32 s62, s58
    buffer_load_dwordx4 v4, s[12:15], s62 offen lds
    s_add_u32 m0, s59, 17408
    s_add_u32 s62, s62, s60
    buffer_load_dwordx4 v4, s[12:15], s62 offen lds
    s_add_u32 m0, s59, 18432
    s_add_u32 s62, s62, s60
    buffer_load_dwordx4 v4, s[12:15], s62 offen lds
    s_add_u32 m0, s59, 19456
    s_add_u32 s62, s62, s60
    buffer_load_dwordx4 v4, s[12:15], s62 offen lds
    s_add_u32 s57, s57, 128
    s_add_u32 s58, s58, s61
    s_cmp_lg_u32 s48, 4
    s_cbranch_scc1 L_H_gn2
    s_mov_b32 s63, 0
L_H_npoll2:
    v_readfirstlane_b32 s62, v29
    s_add_u32 s63, s63, 1
    s_cmp_gt_u32 s63, 200000
    s_cbranch_scc1 L_H_npd2
    s_nop 0
    s_cmp_lg_u32 s62, 0
    s_cbranch_scc1 L_H_npd2
    buffer_load_dwordx2 v[28:29], v30, s[36:39], 0 offen sc1
    s_waitcnt vmcnt(0)
    s_branch L_H_npoll2
L_H_npd2:
    v_readfirstlane_b32 s94, v28
    v_readfirstlane_b32 s95, v29
    v_and_b32 v31, 7, v1
    v_lshlrev_b32 v32, 3, v31
    v_add_u32 v32, 161424, v32
    ds_read_b64 v[20:21], v32
    s_lshr_b32 s62, s49, 1
    s_lshl_b32 s62, s62, 6
    s_and_b32 s63, s49, 1
    s_lshl_b32 s63, s63, 5
    s_add_u32 s62, s62, s63
    s_add_u32 s62, s62, s50
    v_lshlrev_b32 v31, 4, v31
    s_lshl_b32 s62, s62, 7
    s_add_u32 s62, s62, 22020096
    s_waitcnt lgkmcnt(0)
    v_mov_b32 v22, v21
    v_mov_b32 v21, v28
    v_mov_b32 v23, v28
    s_mov_b64 exec, 0xff
    buffer_store_dwordx4 v[20:23], v31, s[28:31], s62 offen sc1
    s_lshl_b32 s62, s49, 8
    s_lshl_b32 s63, s50, 3
    s_add_u32 s62, s62, s63
    s_add_u32 s62, s62, 22364160
    s_mov_b64 exec, -1
    v_add_u32 v24, s51, v28
    v_mov_b32 v25, v29
    s_mov_b64 exec, 1
    buffer_store_dwordx2 v[24:25], v30, s[28:31], s62 offen sc1
    s_mov_b64 exec, -1
L_H_gn2:
    s_cmp_eq_u32 s48, 4
    s_cbranch_scc1 L_H_w4a2
    s_waitcnt vmcnt(8)
    s_branch L_H_w4b2
L_H_w4a2:
    s_waitcnt vmcnt(10)
L_H_w4b2:
    s_barrier
    s_add_u32 m0, s59, 32768
    s_nop 0
    buffer_load_dwordx4 v2, s[8:11], s57 offen lds
    s_add_u32 m0, s59, 33792
    s_add_u32 s62, s57, 10240
    buffer_load_dwordx4 v3, s[8:11], s62 offen lds
    s_add_u32 m0, s59, 34816
    s_add_u32 s62, s57, 20480
    buffer_load_dwordx4 v2, s[8:11], s62 offen lds
    s_add_u32 m0, s59, 35840
    s_add_u32 s62, s57, 30720
    buffer_load_dwordx4 v3, s[8:11], s62 offen lds
    s_add_u32 m0, s59, 49152
    s_mov_b32 s62, s58
    buffer_load_dwordx4 v4, s[12:15], s62 offen lds
    s_add_u32 m0, s59, 50176
    s_add_u32 s62, s62, s60
    buffer_load_dwordx4 v4, s[12:15], s62 offen lds
    s_add_u32 m0, s59, 51200
    s_add_u32 s62, s62, s60
    buffer_load_dwordx4 v4, s[12:15], s62 offen lds
    s_add_u32 m0, s59, 52224
    s_add_u32 s62, s62, s60
    buffer_load_dwordx4 v4, s[12:15], s62 offen lds
    s_add_u32 s57, s57, 128
    s_add_u32 s58, s58, s61
    s_cmp_eq_u32 s48, 4
    s_cbranch_scc1 L_H_w4a3
    s_waitcnt vmcnt(8)
    s_branch L_H_w4b3
L_H_w4a3:
    s_waitcnt vmcnt(10)
L_H_w4b3:
    s_barrier
    s_add_u32 m0, s59, 65536
    s_nop 0
    buffer_load_dwordx4 v2, s[8:11], s57 offen lds
    s_add_u32 m0, s59, 66560
    s_add_u32 s62, s57, 10240
    buffer_load_dwordx4 v3, s[8:11], s62 offen lds
    s_add_u32 m0, s59, 67584
    s_add_u32 s62, s57, 20480
    buffer_load_dwordx4 v2, s[8:11], s62 offen lds
    s_add_u32 m0, s59, 68608
    s_add_u32 s62, s57, 30720
    buffer_load_dwordx4 v3, s[8:11], s62 offen lds
    s_add_u32 m0, s59, 81920
    s_mov_b32 s62, s58
    buffer_load_dwordx4 v4, s[12:15], s62 offen lds
    s_add_u32 m0, s59, 82944
    s_add_u32 s62, s62, s60
    buffer_load_dwordx4 v4, s[12:15], s62 offen lds
    s_add_u32 m0, s59, 83968
    s_add_u32 s62, s62, s60
    buffer_load_dwordx4 v4, s[12:15], s62 offen lds
    s_add_u32 m0, s59, 84992
    s_add_u32 s62, s62, s60
    buffer_load_dwordx4 v4, s[12:15], s62 offen lds
    s_add_u32 s57, s57, 128
    s_add_u32 s58, s58, s61
    s_waitcnt vmcnt(8)
    s_barrier
    s_add_u32 m0, s59, 98304
    s_nop 0
    buffer_load_dwordx4 v2, s[8:11], s57 offen lds
    s_add_u32 m0, s59, 99328
    s_add_u32 s62, s57, 10240
    buffer_load_dwordx4 v3, s[8:11], s62 offen lds
    s_add_u32 m0, s59, 100352
    s_add_u32 s62, s57, 20480
    buffer_load_dwordx4 v2, s[8:11], s62 offen lds
    s_add_u32 m0, s59, 101376
    s_add_u32 s62, s57, 30720
    buffer_load_dwordx4 v3, s[8:11], s62 offen lds
    s_add_u32 m0, s59, 114688
    s_mov_b32 s62, s58
    buffer_load_dwordx4 v4, s[12:15], s62 offen lds
    s_add_u32 m0, s59, 115712
    s_add_u32 s62, s62, s60
    buffer_load_dwordx4 v4, s[12:15], s62 offen lds
    s_add_u32 m0, s59, 116736
    s_add_u32 s62, s62, s60
    buffer_load_dwordx4 v4, s[12:15], s62 offen lds
    s_add_u32 m0, s59, 117760
    s_add_u32 s62, s62, s60
    buffer_load_dwordx4 v4, s[12:15], s62 offen lds
    s_add_u32 s57, s57, 128
    s_add_u32 s58, s58, s61
    s_cmp_lg_u32 s48, 4
    s_cbranch_scc1 L_H_sti_1
    s_lshl_b32 s63, s53, 11
    s_add_u32 s63, s63, 22020096
    v_lshlrev_b32 v8, 4, v1
    buffer_load_dwordx4 v[12:15], v8, s[28:31], s63 offen sc1
    buffer_load_dwordx4 v[16:19], v8, s[28:31], s63 offen offset:1024 sc1
L_H_sti_1:
    s_cmp_eq_u32 s48, 4
    s_cbranch_scc1 L_H_w4a4
    s_waitcnt vmcnt(8)
    s_branch L_H_w4b4
L_H_w4a4:
    s_waitcnt vmcnt(10)
L_H_w4b4:
    s_barrier
    s_add_u32 m0, s59, 0
    s_nop 0
    buffer_load_dwordx4 v2, s[8:11], s57 offen lds
    s_add_u32 m0, s59, 1024
    s_add_u32 s62, s57, 10240
    buffer_load_dwordx4 v3, s[8:11], s62 offen lds
    s_add_u32 m0, s59, 2048
    s_add_u32 s62, s57, 20480
    buffer_load_dwordx4 v2, s[8:11], s62 offen lds
    s_add_u32 m0, s59, 3072
    s_add_u32 s62, s57, 30720
    buffer_load_dwordx4 v3, s[8:11], s62 offen lds
    s_add_u32 m0, s59, 16384
    s_mov_b32 s62, s58
    buffer_load_dwordx4 v4, s[12:15], s62 offen lds
    s_add_u32 m0, s59, 17408
    s_add_u32 s62, s62, s60
    buffer_load_dwordx4 v4, s[12:15], s62 offen lds
    s_add_u32 m0, s59, 18432
    s_add_u32 s62, s62, s60
    buffer_load_dwordx4 v4, s[12:15], s62 offen lds
    s_add_u32 m0, s59, 19456
    s_add_u32 s62, s62, s60
    buffer_load_dwordx4 v4, s[12:15], s62 offen lds
    s_add_u32 s57, s57, 128
    s_add_u32 s58, s58, s61
    s_cmp_eq_u32 s48, 4
    s_cbranch_scc1 L_H_w4a5
    s_waitcnt vmcnt(8)
    s_branch L_H_w4b5
L_H_w4a5:
    s_waitcnt vmcnt(10)
L_H_w4b5:
    s_barrier
    s_add_u32 m0, s59, 32768
    s_nop 0
    buffer_load_dwordx4 v2, s[8:11], s57 offen lds
    s_add_u32 m0, s59, 33792
    s_add_u32 s62, s57, 10240
    buffer_load_dwordx4 v3, s[8:11], s62 offen lds
    s_add_u32 m0, s59, 34816
    s_add_u32 s62, s57, 20480
    buffer_load_dwordx4 v2, s[8:11], s62 offen lds
    s_add_u32 m0, s59, 35840
    s_add_u32 s62, s57, 30720
    buffer_load_dwordx4 v3, s[8:11], s62 offen lds
    s_add_u32 m0, s59, 49152
    s_mov_b32 s62, s58
    buffer_load_dwordx4 v4, s[12:15], s62 offen lds
    s_add_u32 m0, s59, 50176
    s_add_u32 s62, s62, s60
    buffer_load_dwordx4 v4, s[12:15], s62 offen lds
    s_add_u32 m0, s59, 51200
    s_add_u32 s62, s62, s60
    buffer_load_dwordx4 v4, s[12:15], s62 offen lds
    s_add_u32 m0, s59, 52224
    s_add_u32 s62, s62, s60
    buffer_load_dwordx4 v4, s[12:15], s62 offen lds
    s_add_u32 s57, s57, 128
    s_add_u32 s58, s58, s61
    s_cmp_eq_u32 s92, -1
    s_cbranch_scc1 L_H_nopack_2
    buffer_load_dwordx4 v[200:203], v220, s[88:91], s87 offen
    buffer_load_dwordx4 v[204:207], v221, s[88:91], s87 offen
    buffer_load_dwordx4 v[208:211], v222, s[88:91], s87 offen
    buffer_load_dwordx4 v[212:215], v223, s[88:91], s87 offen
    buffer_load_dwordx4 v[216:219], v224, s[88:91], s87 offen
    s_branch L_H_exdone_2
L_H_nopack_2:
    v_lshlrev_b32 v250, 7, v1
    s_mul_i32 s57, s2, 8640
    v_lshlrev_b32 v249, 2, v1
    s_cmp_lg_u32 s48, 4
    s_cbranch_scc1 L_H_dum_2
    buffer_load_dword v251, v250, s[20:23], s57 offen
    buffer_load_dword v251, v250, s[20:23], s57 offen offset:512
    buffer_load_dword v251, v249, s[8:11], 0 offen
    buffer_load_dword v251, v249, s[8:11], 0 offen
    buffer_load_dword v251, v249, s[8:11], 0 offen
    s_branch L_H_exdone_2
L_H_dum_2:
    buffer_load_dword v251, v249, s[8:11], 0 offen
    buffer_load_dword v251, v249, s[8:11], 0 offen
    buffer_load_dword v251, v249, s[8:11], 0 offen
    buffer_load_dword v251, v249, s[8:11], 0 offen
    buffer_load_dword v251, v249, s[8:11], 0 offen
L_H_exdone_2:
    s_waitcnt vmcnt(13)
    s_barrier
    s_cmp_lg_u32 s48, 4
    s_cbranch_scc1 L_H_statskip_2
    s_lshl_b32 s62, s53, 11
    s_add_u32 s62, s62, 22020096
    s_mov_b32 s63, 0
L_H_statpoll_2:
    v_xor_b32 v20, s94, v13
    v_xor_b32 v21, s94, v15
    v_xor_b32 v22, s94, v17
    v_xor_b32 v23, s94, v19
    v_or_b32 v20, v20, v21
    v_or3_b32 v20, v20, v22, v23
    v_cmp_ne_u32 vcc, 0, v20
    s_add_u32 s63, s63, 1
    s_cmp_gt_u32 s63, 100000
    s_cbranch_scc1 L_H_statdone_2
    s_cbranch_vccz L_H_statdone_2
    buffer_load_dwordx4 v[12:15], v8, s[28:31], s62 offen sc1
    buffer_load_dwordx4 v[16:19], v8, s[28:31], s62 offen offset:1024 sc1
    s_waitcnt vmcnt(0)
    s_branch L_H_statpoll_2
L_H_statdone_2:
    v_mov_b32 v13, v14
    v_mov_b32 v17, v18
    v_lshlrev_b32 v9, 3, v1
    v_add_u32 v9, 159744, v9
    ds_write_b64 v9, v[12:13]
    ds_write_b64 v9, v[16:17] offset:512
    s_waitcnt lgkmcnt(0)
L_H_statskip_2:
    s_waitcnt vmcnt(5)
    s_barrier
    s_branch L_H_qdone
L_H_cs:
    s_add_u32 m0, s59, 16384
    s_mov_b32 s62, s58
    buffer_load_dwordx4 v4, s[12:15], s62 offen lds
    s_add_u32 m0, s59, 17408
    s_add_u32 s62, s62, s60
    buffer_load_dwordx4 v4, s[12:15], s62 offen lds
    s_add_u32 m0, s59, 18432
    s_add_u32 s62, s62, s60
    buffer_load_dwordx4 v4, s[12:15], s62 offen lds
    s_add_u32 m0, s59, 19456
    s_add_u32 s62, s62, s60
    buffer_load_dwordx4 v4, s[12:15], s62 offen lds
    s_add_u32 s57, s57, 128
    s_add_u32 s58, s58, s61
    s_add_u32 m0, s59, 49152
    s_mov_b32 s62, s58
    buffer_load_dwordx4 v4, s[12:15], s62 offen lds
    s_add_u32 m0, s59, 50176
    s_add_u32 s62, s62, s60
    buffer_load_dwordx4 v4, s[12:15], s62 offen lds
    s_add_u32 m0, s59, 51200
    s_add_u32 s62, s62, s60
    buffer_load_dwordx4 v4, s[12:15], s62 offen lds
    s_add_u32 m0, s59, 52224
    s_add_u32 s62, s62, s60
    buffer_load_dwordx4 v4, s[12:15], s62 offen lds
    s_add_u32 s57, s57, 128
    s_add_u32 s58, s58, s61
    s_add_u32 m0, s59, 81920
    s_mov_b32 s62, s58
    buffer_load_dwordx4 v4, s[12:15], s62 offen lds
    s_add_u32 m0, s59, 82944
    s_add_u32 s62, s62, s60
    buffer_load_dwordx4 v4, s[12:15], s62 offen lds
    s_add_u32 m0, s59, 83968
    s_add_u32 s62, s62, s60
    buffer_load_dwordx4 v4, s[12:15], s62 offen lds
    s_add_u32 m0, s59, 84992
    s_add_u32 s62, s62, s60
    buffer_load_dwordx4 v4, s[12:15], s62 offen lds
    s_add_u32 s57, s57, 128
    s_add_u32 s58, s58, s61
    s_mov_b32 s16, s68
    s_mov_b32 s17, s69
    s_mov_b32 s18, 819200
    s_mov_b32 s19, 0x20000
    s_mov_b32 s20, s72
    s_mov_b32 s21, s73
    s_mov_b32 s22, 2211840
    s_mov_b32 s23, 0x20000
    s_mov_b32 s24, s76
    s_mov_b32 s25, s77
    s_mov_b32 s26, 2211840
    s_mov_b32 s27, 0x20000
    s_mov_b32 s32, s80
    s_mov_b32 s33, s81
    s_mov_b32 s34, 2621440
    s_mov_b32 s35, 0x20000
    s_mov_b32 s40, s74
    s_mov_b32 s41, s75
    s_mov_b32 s42, 3456
    s_mov_b32 s43, 0x20000
    s_mov_b32 s44, s78
    s_mov_b32 s45, s79
    s_mov_b32 s46, 1280
    s_mov_b32 s47, 0x20000
    v_mov_b32 v8, 161312
    v_mov_b32 v12, 0
    v_mov_b32 v13, 0
    v_mov_b32 v14, 0
    v_mov_b32 v15, 0
    ds_write_b128 v8, v[12:15]
    ds_write_b128 v8, v[12:15] offset:32
    ds_write_b128 v8, v[12:15] offset:48
    ds_write_b128 v8, v[12:15] offset:64
    ds_write_b128 v8, v[12:15] offset:192
    ds_write_b128 v8, v[12:15] offset:208
    ds_write_b128 v8, v[12:15] offset:224
    ds_write_b128 v8, v[12:15] offset:240
    ds_write_b128 v8, v[12:15] offset:1824
    v_mov_b32 v12, 0x7fffffff
    ds_write_b128 v8, v[12:15] offset:1840
    ds_write_b128 v8, v[12:15] offset:16
    ds_write_b128 v8, v[12:15] offset:80
    s_waitcnt lgkmcnt(0)
    s_sub_u32 s86, s48, 5
    s_lshl_b32 s86, s86, 8
    s_add_u32 s86, s86, s2
    s_mov_b32 s92, -1
    s_mov_b32 s91, 0x20000
    s_mov_b32 s93, 0
    s_mov_b32 s88, s76
    s_mov_b32 s89, s77
    s_mov_b32 s90, 2211840
    s_mov_b32 s87, 0
    s_cmp_ge_u32 s86, 592
    s_cbranch_scc1 L_H_ps_3
    s_cmp_lt_u32 s86, 160
    s_cbranch_scc1 L_H_ps_wo_3
    s_sub_u32 s86, s86, 160
    s_mul_hi_u32 s62, s86, 79536432
    s_mul_i32 s63, s62, 54
    s_sub_u32 s63, s86, s63
    s_mul_i32 s87, s63, 40960
    s_mul_i32 s93, s62, 160
    s_add_u32 s87, s87, s93
    s_mul_i32 s92, s62, 276480
    s_mul_i32 s93, s63, 5120
    s_add_u32 s92, s92, s93
    s_add_u32 s92, s92, 24117248
    s_mov_b32 s93, 2560
    s_branch L_H_ps_3
L_H_ps_wo_3:
    s_mul_hi_u32 s62, s86, 214748365
    s_mul_i32 s63, s62, 20
    s_sub_u32 s63, s86, s63
    s_mul_i32 s92, s62, 102400
    s_mul_i32 s93, s63, 5120
    s_add_u32 s92, s92, s93
    s_add_u32 s92, s92, 23068672
    s_mov_b32 s88, s68
    s_mov_b32 s89, s69
    s_mov_b32 s90, 819200
    s_mul_i32 s62, s62, 160
    s_cmp_lt_u32 s63, 16
    s_cbranch_scc0 L_H_ps_wot_3
    s_mul_i32 s87, s63, 51200
    s_add_u32 s87, s87, s62
    s_mov_b32 s93, 0
    s_branch L_H_ps_3
L_H_ps_wot_3:
    s_sub_u32 s87, s63, 16
    s_mul_i32 s87, s87, 204800
    s_add_u32 s87, s87, s62
    s_mov_b32 s93, 1280
L_H_ps_3:
    s_getpc_b64 s[64:65]
L_H_pc_3:
    s_add_u32 s64, s64, L_TAB-L_H_pc_3
    s_addc_u32 s65, s65, 0
    s_mov_b32 s66, 3840
    s_mov_b32 s67, 0x20000
    v_lshlrev_b32 v40, 2, v1
    buffer_load_dword v220, v40, s[64:67], s93 offen offset:0
    buffer_load_dword v221, v40, s[64:67], s93 offen offset:256
    buffer_load_dword v222, v40, s[64:67], s93 offen offset:512
    buffer_load_dword v223, v40, s[64:67], s93 offen offset:768
    buffer_load_dword v224, v40, s[64:67], s93 offen offset:1024
    s_waitcnt vmcnt(13)
    s_barrier
    s_cmp_lg_u32 s48, 4
    s_cbranch_scc1 L_H_np3
    buffer_load_dwordx2 v[28:29], v30, s[36:39], 0 offen sc1
L_H_np3:
    s_cmp_eq_u32 s48, 4
    s_cbranch_scc1 L_H_w4a6
    s_waitcnt vmcnt(9)
    s_branch L_H_w4b6
L_H_w4a6:
    s_waitcnt vmcnt(10)
L_H_w4b6:
    s_barrier
    s_add_u32 m0, s59, 114688
    s_mov_b32 s62, s58
    buffer_load_dwordx4 v4, s[12:15], s62 offen lds
    s_add_u32 m0, s59, 115712
    s_add_u32 s62, s62, s60
    buffer_load_dwordx4 v4, s[12:15], s62 offen lds
    s_add_u32 m0, s59, 116736
    s_add_u32 s62, s62, s60
    buffer_load_dwordx4 v4, s[12:15], s62 offen lds
    s_add_u32 m0, s59, 117760
    s_add_u32 s62, s62, s60
    buffer_load_dwordx4 v4, s[12:15], s62 offen lds
    s_add_u32 s57, s57, 128
    s_add_u32 s58, s58, s61
    s_waitcnt vmcnt(4)
    s_barrier
    s_add_u32 m0, s59, 16384
    s_mov_b32 s62, s58
    buffer_load_dwordx4 v4, s[12:15], s62 offen lds
    s_add_u32 m0, s59, 17408
    s_add_u32 s62, s62, s60
    buffer_load_dwordx4 v4, s[12:15], s62 offen lds
    s_add_u32 m0, s59, 18432
    s_add_u32 s62, s62, s60
    buffer_load_dwordx4 v4, s[12:15], s62 offen lds
    s_add_u32 m0, s59, 19456
    s_add_u32 s62, s62, s60
    buffer_load_dwordx4 v4, s[12:15], s62 offen lds
    s_add_u32 s57, s57, 128
    s_add_u32 s58, s58, s61
    s_cmp_lg_u32 s48, 4
    s_cbranch_scc1 L_H_gn4
    s_mov_b32 s63, 0
L_H_npoll4:
    v_readfirstlane_b32 s62, v29
    s_add_u32 s63, s63, 1
    s_cmp_gt_u32 s63, 200000
    s_cbranch_scc1 L_H_npd4
    s_nop 0
    s_cmp_lg_u32 s62, 0
    s_cbranch_scc1 L_H_npd4
    buffer_load_dwordx2 v[28:29], v30, s[36:39], 0 offen sc1
    s_waitcnt vmcnt(0)
    s_branch L_H_npoll4
L_H_npd4:
    v_readfirstlane_b32 s94, v28
    v_readfirstlane_b32 s95, v29
    v_and_b32 v31, 7, v1
    v_lshlrev_b32 v32, 3, v31
    v_add_u32 v32, 161424, v32
    ds_read_b64 v[20:21], v32
    s_lshr_b32 s62, s49, 1
    s_lshl_b32 s62, s62, 6
    s_and_b32 s63, s49, 1
    s_lshl_b32 s63, s63, 5
    s_add_u32 s62, s62, s63
    s_add_u32 s62, s62, s50
    v_lshlrev_b32 v31, 4, v31
    s_lshl_b32 s62, s62, 7
    s_add_u32 s62, s62, 22020096
    s_waitcnt lgkmcnt(0)
    v_mov_b32 v22, v21
    v_mov_b32 v21, v28
    v_mov_b32 v23, v28
    s_mov_b64 exec, 0xff
    buffer_store_dwordx4 v[20:23], v31, s[28:31], s62 offen sc1
    s_lshl_b32 s62, s49, 8
    s_lshl_b32 s63, s50, 3
    s_add_u32 s62, s62, s63
    s_add_u32 s62, s62, 22364160
    s_mov_b64 exec, -1
    v_add_u32 v24, s51, v28
    v_mov_b32 v25, v29
    s_mov_b64 exec, 1
    buffer_store_dwordx2 v[24:25], v30, s[28:31], s62 offen sc1
    s_mov_b64 exec, -1
L_H_gn4:
    s_cmp_eq_u32 s48, 4
    s_cbranch_scc1 L_H_w4a7
    s_waitcnt vmcnt(4)
    s_branch L_H_w4b7
L_H_w4a7:
    s_waitcnt vmcnt(6)
L_H_w4b7:
    s_barrier
    s_add_u32 m0, s59, 49152
    s_mov_b32 s62, s58
    buffer_load_dwordx4 v4, s[12:15], s62 offen lds
    s_add_u32 m0, s59, 50176
    s_add_u32 s62, s62, s60
    buffer_load_dwordx4 v4, s[12:15], s62 offen lds
    s_add_u32 m0, s59, 51200
    s_add_u32 s62, s62, s60
    buffer_load_dwordx4 v4, s[12:15], s62 offen lds
    s_add_u32 m0, s59, 52224
    s_add_u32 s62, s62, s60
    buffer_load_dwordx4 v4, s[12:15], s62 offen lds
    s_add_u32 s57, s57, 128
    s_add_u32 s58, s58, s61
    s_cmp_eq_u32 s48, 4
    s_cbranch_scc1 L_H_w4a8
    s_waitcnt vmcnt(4)
    s_branch L_H_w4b8
L_H_w4a8:
    s_waitcnt vmcnt(6)
L_H_w4b8:
    s_barrier
    s_add_u32 m0, s59, 81920
    s_mov_b32 s62, s58
    buffer_load_dwordx4 v4, s[12:15], s62 offen lds
    s_add_u32 m0, s59, 82944
    s_add_u32 s62, s62, s60
    buffer_load_dwordx4 v4, s[12:15], s62 offen lds
    s_add_u32 m0, s59, 83968
    s_add_u32 s62, s62, s60
    buffer_load_dwordx4 v4, s[12:15], s62 offen lds
    s_add_u32 m0, s59, 84992
    s_add_u32 s62, s62, s60
    buffer_load_dwordx4 v4, s[12:15], s62 offen lds
    s_add_u32 s57, s57, 128
    s_add_u32 s58, s58, s61
    s_waitcnt vmcnt(4)
    s_barrier
    s_add_u32 m0, s59, 114688
    s_mov_b32 s62, s58
    buffer_load_dwordx4 v4, s[12:15], s62 offen lds
    s_add_u32 m0, s59, 115712
    s_add_u32 s62, s62, s60
    buffer_load_dwordx4 v4, s[12:15], s62 offen lds
    s_add_u32 m0, s59, 116736
    s_add_u32 s62, s62, s60
    buffer_load_dwordx4 v4, s[12:15], s62 offen lds
    s_add_u32 m0, s59, 117760
    s_add_u32 s62, s62, s60
    buffer_load_dwordx4 v4, s[12:15], s62 offen lds
    s_add_u32 s57, s57, 128
    s_add_u32 s58, s58, s61
    s_cmp_lg_u32 s48, 4
    s_cbranch_scc1 L_H_sti_3
    s_lshl_b32 s63, s53, 11
    s_add_u32 s63, s63, 22020096
    v_lshlrev_b32 v8, 4, v1
    buffer_load_dwordx4 v[12:15], v8, s[28:31], s63 offen sc1
    buffer_load_dwordx4 v[16:19], v8, s[28:31], s63 offen offset:1024 sc1
L_H_sti_3:
    s_cmp_eq_u32 s48, 4
    s_cbranch_scc1 L_H_w4a9
    s_waitcnt vmcnt(4)
    s_branch L_H_w4b9
L_H_w4a9:
    s_waitcnt vmcnt(6)
L_H_w4b9:
    s_barrier
    s_add_u32 m0, s59, 16384
    s_mov_b32 s62, s58
    buffer_load_dwordx4 v4, s[12:15], s62 offen lds
    s_add_u32 m0, s59, 17408
    s_add_u32 s62, s62, s60
    buffer_load_dwordx4 v4, s[12:15], s62 offen lds
    s_add_u32 m0, s59, 18432
    s_add_u32 s62, s62, s60
    buffer_load_dwordx4 v4, s[12:15], s62 offen lds
    s_add_u32 m0, s59, 19456
    s_add_u32 s62, s62, s60
    buffer_load_dwordx4 v4, s[12:15], s62 offen lds
    s_add_u32 s57, s57, 128
    s_add_u32 s58, s58, s61
    s_cmp_eq_u32 s48, 4
    s_cbranch_scc1 L_H_w4a10
    s_waitcnt vmcnt(4)
    s_branch L_H_w4b10
L_H_w4a10:
    s_waitcnt vmcnt(6)
L_H_w4b10:
    s_barrier
    s_add_u32 m0, s59, 49152
    s_mov_b32 s62, s58
    buffer_load_dwordx4 v4, s[12:15], s62 offen lds
    s_add_u32 m0, s59, 50176
    s_add_u32 s62, s62, s60
    buffer_load_dwordx4 v4, s[12:15], s62 offen lds
    s_add_u32 m0, s59, 51200
    s_add_u32 s62, s62, s60
    buffer_load_dwordx4 v4, s[12:15], s62 offen lds
    s_add_u32 m0, s59, 52224
    s_add_u32 s62, s62, s60
    buffer_load_dwordx4 v4, s[12:15], s62 offen lds
    s_add_u32 s57, s57, 128
    s_add_u32 s58, s58, s61
    s_cmp_eq_u32 s92, -1
    s_cbranch_scc1 L_H_nopack_4
    buffer_load_dwordx4 v[200:203], v220, s[88:91], s87 offen
    buffer_load_dwordx4 v[204:207], v221, s[88:91], s87 offen
    buffer_load_dwordx4 v[208:211], v222, s[88:91], s87 offen
    buffer_load_dwordx4 v[212:215], v223, s[88:91], s87 offen
    buffer_load_dwordx4 v[216:219], v224, s[88:91], s87 offen
    s_branch L_H_exdone_4
L_H_nopack_4:
    v_lshlrev_b32 v250, 7, v1
    s_mul_i32 s57, s2, 8640
    v_lshlrev_b32 v249, 2, v1
    s_cmp_lg_u32 s48, 4
    s_cbranch_scc1 L_H_dum_4
    buffer_load_dword v251, v250, s[20:23], s57 offen
    buffer_load_dword v251, v250, s[20:23], s57 offen offset:512
    buffer_load_dword v251, v249, s[8:11], 0 offen
    buffer_load_dword v251, v249, s[8:11], 0 offen
    buffer_load_dword v251, v249, s[8:11], 0 offen
    s_branch L_H_exdone_4
L_H_dum_4:
    buffer_load_dword v251, v249, s[8:11], 0 offen
    buffer_load_dword v251, v249, s[8:11], 0 offen
    buffer_load_dword v251, v249, s[8:11], 0 offen
    buffer_load_dword v251, v249, s[8:11], 0 offen
    buffer_load_dword v251, v249, s[8:11], 0 offen
L_H_exdone_4:
    s_waitcnt vmcnt(9)
    s_barrier
    s_cmp_lg_u32 s48, 4
    s_cbranch_scc1 L_H_statskip_4
    s_lshl_b32 s62, s53, 11
    s_add_u32 s62, s62, 22020096
    s_mov_b32 s63, 0
L_H_statpoll_4:
    v_xor_b32 v20, s94, v13
    v_xor_b32 v21, s94, v15
    v_xor_b32 v22, s94, v17
    v_xor_b32 v23, s94, v19
    v_or_b32 v20, v20, v21
    v_or3_b32 v20, v20, v22, v23
    v_cmp_ne_u32 vcc, 0, v20
    s_add_u32 s63, s63, 1
    s_cmp_gt_u32 s63, 100000
    s_cbranch_scc1 L_H_statdone_4
    s_cbranch_vccz L_H_statdone_4
    buffer_load_dwordx4 v[12:15], v8, s[28:31], s62 offen sc1
    buffer_load_dwordx4 v[16:19], v8, s[28:31], s62 offen offset:1024 sc1
    s_waitcnt vmcnt(0)
    s_branch L_H_statpoll_4
L_H_statdone_4:
    v_mov_b32 v13, v14
    v_mov_b32 v17, v18
    v_lshlrev_b32 v9, 3, v1
    v_add_u32 v9, 159744, v9
    ds_write_b64 v9, v[12:13]
    ds_write_b64 v9, v[16:17] offset:512
    s_waitcnt lgkmcnt(0)
L_H_statskip_4:
    s_waitcnt vmcnt(5)
    s_barrier
L_H_qdone:
    s_barrier
    s_cmp_eq_u32 s48, 4
    s_cbranch_scc1 L_H_w4pub
    s_cmp_eq_u32 s92, -1
    s_cbranch_scc1 L_H_nopst_1
    s_waitcnt vmcnt(0)
    s_sub_u32 s57, s48, 5
    s_mul_i32 s57, s57, 5120
    s_add_u32 s57, s57, 0
    v_lshlrev_b32 v40, 4, v1
    v_add_u32 v41, s57, v40
    ds_write_b128 v41, v[200:203] offset:0
    ds_write_b128 v41, v[204:207] offset:1024
    ds_write_b128 v41, v[208:211] offset:2048
    ds_write_b128 v41, v[212:215] offset:3072
    ds_write_b128 v41, v[216:219] offset:4096
    v_lshrrev_b32 v42, 4, v1
    v_bfe_u32 v43, v1, 2, 2
    v_lshl_add_u32 v43, v42, 2, v43
    v_mul_u32_u24 v43, 160, v43
    v_and_b32 v44, 3, v1
    v_mul_u32_u24 v44, 40, v44
    v_add3_u32 v43, v43, v44, s57
    s_waitcnt lgkmcnt(0)
    ds_read_b64_tr_b16 v[200:201], v43 offset:0
    ds_read_b64_tr_b16 v[202:203], v43 offset:2560
    ds_read_b64_tr_b16 v[204:205], v43 offset:8
    ds_read_b64_tr_b16 v[206:207], v43 offset:2568
    ds_read_b64_tr_b16 v[208:209], v43 offset:16
    ds_read_b64_tr_b16 v[210:211], v43 offset:2576
    ds_read_b64_tr_b16 v[212:213], v43 offset:24
    ds_read_b64_tr_b16 v[214:215], v43 offset:2584
    ds_read_b64_tr_b16 v[216:217], v43 offset:32
    ds_read_b64_tr_b16 v[218:219], v43 offset:2592
    s_waitcnt lgkmcnt(0)
    buffer_store_dwordx4 v[200:203], v40, s[28:31], s92 offen offset:0 sc1
    buffer_store_dwordx4 v[204:207], v40, s[28:31], s92 offen offset:1024 sc1
    buffer_store_dwordx4 v[208:211], v40, s[28:31], s92 offen offset:2048 sc1
    buffer_store_dwordx4 v[212:215], v40, s[28:31], s92 offen offset:3072 sc1
    s_add_u32 s92, s92, 4096
    buffer_store_dwordx4 v[216:219], v40, s[28:31], s92 offen sc1
L_H_nopst_1:
    s_waitcnt vmcnt(0)
    s_sub_u32 s62, s48, 4
    s_lshl_b32 s57, s62, 2
    s_add_u32 s57, s57, 161392
    v_mov_b32 v8, s57
    v_mov_b32 v9, 1
    ds_write_b32 v8, v9
    s_branch L_H_q11skip
L_H_w4pub:
    s_lshl_b32 s62, s49, 8
    s_add_u32 s62, s62, 22364160
    v_and_b32 v8, 31, v1
    v_lshlrev_b32 v8, 3, v8
    s_mov_b32 s61, 0
L_H_xpoll:
    buffer_load_dwordx2 v[10:11], v8, s[28:31], s62 offen sc1
    s_waitcnt vmcnt(0)
    v_subrev_u32 v10, s94, v10
    v_xor_b32 v11, s95, v11
    v_cmp_le_u32 vcc, 128, v10
    v_cmp_ne_u32 s[86:87], 0, v11
    s_nop 3
    s_or_b64 vcc, vcc, s[86:87]
    s_add_u32 s61, s61, 1
    s_cmp_gt_u32 s61, 200000
    s_cbranch_scc1 L_H_xdone
    s_cbranch_vccz L_H_xdone
    s_sleep 1
    s_branch L_H_xpoll
L_H_xdone:
    v_and_b32 v10, 31, v10
    v_cmp_ne_u32 vcc, s51, v10
    s_nop 3
    s_cmp_eq_u64 vcc, 0
    s_cselect_b32 s52, 1, 0
    v_mov_b32 v16, 161392
    s_mov_b32 s93, 0
L_lw_1:
    ds_read_b128 v[12:15], v16
    s_waitcnt lgkmcnt(0)
    v_min_u32 v12, v12, v13
    v_min3_u32 v12, v12, v14, v15
    s_nop 0
    v_readfirstlane_b32 s57, v12
    s_add_u32 s93, s93, 1
    s_cmp_gt_u32 s93, 200000
    s_cbranch_scc1 L_lw_1_x
    s_nop 0
    s_cmp_ge_u32 s57, 1
    s_cbranch_scc1 L_lw_1_x
    s_sleep 1
    s_branch L_lw_1
L_lw_1_x:
    v_mov_b32 v16, 161312
    s_mov_b32 s93, 0
L_lw_2:
    ds_read_b128 v[12:15], v16
    s_waitcnt lgkmcnt(0)
    v_min_u32 v12, v12, v13
    v_min3_u32 v12, v12, v14, v15
    s_nop 0
    v_readfirstlane_b32 s57, v12
    s_add_u32 s93, s93, 1
    s_cmp_gt_u32 s93, 200000
    s_cbranch_scc1 L_lw_2_x
    s_nop 0
    s_cmp_lt_u32 s57, 1
    s_cbranch_scc1 L_lw_2
L_lw_2_x:
    s_waitcnt vmcnt(0)
    s_lshl_b32 s62, s53, 7
    s_lshl_b32 s63, s54, 3
    s_add_u32 s62, s62, s63
    s_add_u32 s62, s62, 22347776
    s_add_u32 s63, s94, 1
    v_mov_b32 v8, s63
    v_mov_b32 v9, s95
    v_mov_b32 v10, 0
    s_mov_b64 exec, 1
    buffer_store_dwordx2 v[8:9], v10, s[28:31], s62 offen sc1
    s_mov_b64 exec, -1
L_H_q11skip:
    s_cmp_lg_u32 s48, 4
    s_cbranch_scc1 L_H_b1skip
    s_lshl_b32 s60, s49, 7
    s_add_u32 s60, s60, 22368256
    s_cmp_lg_u32 s50, 0
    s_cbranch_scc1 L_H_b1follow
    v_lshlrev_b32 v8, 4, v1
    s_mov_b32 s62, 22347776
    s_add_u32 s63, s94, 1
    s_mov_b32 s61, 0
L_H_b1poll:
    buffer_load_dwordx4 v[12:15], v8, s[28:31], s62 offen sc1
    buffer_load_dwordx4 v[16:19], v8, s[28:31], s62 offen offset:1024 sc1
    s_waitcnt vmcnt(0)
    v_xor_b32 v12, s63, v12
    v_xor_b32 v14, s63, v14
    v_xor_b32 v16, s63, v16
    v_xor_b32 v18, s63, v18
    v_xor_b32 v13, s95, v13
    v_xor_b32 v15, s95, v15
    v_xor_b32 v17, s95, v17
    v_xor_b32 v19, s95, v19
    v_or3_b32 v12, v12, v13, v14
    v_or3_b32 v15, v15, v16, v17
    v_or3_b32 v12, v12, v18, v19
    v_or_b32 v10, v12, v15
    v_cmp_ne_u32 vcc, 0, v10
    s_add_u32 s61, s61, 1
    s_cmp_gt_u32 s61, 200000
    s_cbranch_scc1 L_H_b1lead
    s_cbranch_vccnz L_H_b1poll
L_H_b1lead:
    v_mov_b32 v8, s63
    v_mov_b32 v9, s95
    v_mov_b32 v10, 0
    s_mov_b64 exec, 1
    s_cmp_lg_u32 s52, 0
    s_cbranch_scc1 L_H_b1lf
    buffer_store_dwordx2 v[8:9], v10, s[28:31], s60 offen sc1
    s_branch L_H_b1ld
L_H_b1lf:
    buffer_store_dwordx2 v[8:9], v10, s[28:31], s60 offen
L_H_b1ld:
    s_mov_b64 exec, -1
    s_branch L_H_b1done
L_H_b1follow:
    v_mov_b32 v8, 0
    s_add_u32 s63, s94, 1
    s_mov_b32 s61, 0
L_H_b1fp:
    buffer_load_dwordx2 v[10:11], v8, s[28:31], s60 offen sc1
    s_waitcnt vmcnt(0)
    v_xor_b32 v10, s63, v10
    v_xor_b32 v11, s95, v11
    v_or_b32 v10, v10, v11
    v_cmp_ne_u32 vcc, 0, v10
    s_add_u32 s61, s61, 1
    s_cmp_gt_u32 s61, 200000
    s_cbranch_scc1 L_H_b1done
    s_cbranch_vccz L_H_b1done
    s_sleep 1
    s_branch L_H_b1fp
L_H_b1done:
    s_mov_b32 s62, s52
    v_mov_b32 v10, s62
    v_mov_b32 v8, 161288
    ds_write_b32 v8, v10
    s_waitcnt lgkmcnt(0)
L_H_b1skip:
    s_barrier
    s_branch L_ATT
L_H_W:
    s_cmp_lg_u32 s48, 4
    s_cbranch_scc1 L_H_pub1skip
    s_lshl_b32 s70, s49, 8
    s_lshl_b32 s71, s50, 3
    s_add_u32 s70, s70, s71
    s_add_u32 s70, s70, 22364160
    s_add_u32 s71, s94, s51
    s_add_u32 s71, s71, 32
    v_mov_b32 v24, s71
    v_mov_b32 v25, s95
    v_mov_b32 v26, 0
    s_mov_b64 exec, 1
    s_cmp_lg_u32 s52, 0
    s_cbranch_scc1 L_pub_a_fast
    buffer_store_dwordx2 v[24:25], v26, s[28:31], s70 offen sc1
    s_branch L_pub_a_done
L_pub_a_fast:
    buffer_store_dwordx2 v[24:25], v26, s[28:31], s70 offen
L_pub_a_done:
    s_mov_b64 exec, -1
L_H_pub1skip:
    s_cmp_lg_u32 s48, 4
    s_cbranch_scc1 L_H_W_load
    s_mov_b32 s63, 0
    s_lshl_b32 s72, s49, 8
    s_lshl_b32 s63, s63, 3
    s_add_u32 s72, s72, s63
    s_add_u32 s72, s72, 22364160
    v_min_u32 v28, 31, v1
    v_lshlrev_b32 v28, 3, v28
    s_add_u32 s73, s94, 32
    s_mov_b32 s61, 0
L_wait_b2:
    buffer_load_dwordx2 v[10:11], v28, s[28:31], s72 offen sc1
    s_waitcnt vmcnt(0)
    v_subrev_u32 v10, s73, v10
    v_xor_b32 v11, s95, v11
    v_cmp_le_u32 vcc, 96, v10
    v_cmp_ne_u32 s[86:87], 0, v11
    s_nop 3
    s_or_b64 vcc, vcc, s[86:87]
    s_add_u32 s61, s61, 1
    s_cmp_gt_u32 s61, 200000
    s_cbranch_scc1 L_wait_b2_x
    s_cbranch_vccz L_wait_b2_x
    s_sleep 1
    s_branch L_wait_b2
L_wait_b2_x:
    v_mov_b32 v8, 161376
    v_mov_b32 v9, 1
    ds_write_b32 v8, v9
    s_lshl_b32 s70, s49, 8
    s_lshl_b32 s71, s50, 3
    s_add_u32 s70, s70, s71
    s_add_u32 s70, s70, 22364160
    s_add_u32 s71, s94, s51
    s_add_u32 s71, s71, 64
    v_mov_b32 v24, s71
    v_mov_b32 v25, s95
    v_mov_b32 v26, 0
    s_lshr_b32 s63, s50, 4
    s_lshl_b32 s63, s63, 4
    s_lshl_b32 s72, s49, 8
    s_lshl_b32 s63, s63, 3
    s_add_u32 s72, s72, s63
    s_add_u32 s72, s72, 22364160
    v_min_u32 v28, 15, v1
    v_lshlrev_b32 v28, 3, v28
    s_add_u32 s73, s94, 64
    v_mov_b32 v16, 161312
    s_mov_b32 s93, 0
L_lw_3:
    ds_read_b128 v[12:15], v16
    s_waitcnt lgkmcnt(0)
    v_min_u32 v12, v12, v13
    v_min3_u32 v12, v12, v14, v15
    s_nop 0
    v_readfirstlane_b32 s57, v12
    s_add_u32 s93, s93, 1
    s_cmp_gt_u32 s93, 200000
    s_cbranch_scc1 L_lw_3_x
    s_nop 0
    s_cmp_lt_u32 s57, 2
    s_cbranch_scc1 L_lw_3
L_lw_3_x:
    s_mov_b64 exec, 1
    s_cmp_lg_u32 s52, 0
    s_cbranch_scc1 L_pub_w_fast
    buffer_store_dwordx2 v[24:25], v26, s[28:31], s70 offen sc1
    s_branch L_pub_w_done
L_pub_w_fast:
    buffer_store_dwordx2 v[24:25], v26, s[28:31], s70 offen
L_pub_w_done:
    s_mov_b64 exec, -1
    s_branch L_H4_F
L_H_W_load:
    s_and_b32 s62, s50, 15
    s_cmp_ge_u32 s62, 14
    s_cbranch_scc1 L_H_F_idle
    s_lshl_b32 s58, s62, 8
    s_mul_i32 s86, s62, 0
    s_sub_u32 s63, s48, 5
    v_lshrrev_b32 v6, 4, v1
    v_lshlrev_b32 v7, 2, v6
    v_sub_u32 v7, v1, v7
    v_and_b32 v7, 15, v7
    v_mul_u32_u24 v5, 3456, v6
    v_lshl_add_u32 v4, v7, 4, v5
    v_mov_b32 v12, 161376
    s_mov_b32 s93, 0
L_lw_4:
    ds_read_b32 v8, v12
    s_waitcnt lgkmcnt(0)
    v_readfirstlane_b32 s57, v8
    s_add_u32 s93, s93, 1
    s_cmp_gt_u32 s93, 200000
    s_cbranch_scc1 L_lw_4_x
    s_nop 0
    s_cmp_ge_u32 s57, 1
    s_cbranch_scc1 L_lw_4_x
    s_sleep 1
    s_branch L_lw_4
L_lw_4_x:
    s_mov_b32 s59, s63
L_w1_p1:
    s_lshl_b32 s60, s59, 10
    s_add_u32 m0, s60, 122880
    s_lshl_b32 s61, s59, 2
    s_add_u32 s61, s61, s86
    s_add_u32 s61, s61, 0
    s_cmp_ge_u32 s61, 640
    s_cselect_b32 s60, 640, 0
    s_sub_u32 s61, s61, s60
    s_mul_i32 s61, s61, 3456
    s_add_u32 s61, s61, s58
    buffer_load_dwordx4 v4, s[20:23], s61 offen lds
    s_add_u32 s59, s59, 3
    s_cmp_lt_u32 s59, 36
    s_cbranch_scc1 L_w1_p1
    s_waitcnt vmcnt(0)
    s_sub_u32 s62, s48, 4
    s_lshl_b32 s57, s62, 2
    s_add_u32 s57, s57, 161328
    v_mov_b32 v8, s57
    v_mov_b32 v9, 1
    ds_write_b32 v8, v9
    v_mov_b32 v12, 161344
    s_mov_b32 s93, 0
L_lw_5:
    ds_read_b128 v[8:11], v12
    s_waitcnt lgkmcnt(0)
    v_min_u32 v8, v8, v9
    v_min3_u32 v8, v8, v10, v11
    s_nop 0
    v_readfirstlane_b32 s57, v8
    s_add_u32 s93, s93, 1
    s_cmp_gt_u32 s93, 200000
    s_cbranch_scc1 L_lw_5_x
    s_nop 0
    s_cmp_ge_u32 s57, 1
    s_cbranch_scc1 L_lw_5_x
    s_sleep 1
    s_branch L_lw_5
L_lw_5_x:
    s_mov_b32 s59, s63
L_w1_pa:
    s_lshl_b32 s60, s59, 10
    s_add_u32 m0, s60, 0
    s_lshl_b32 s61, s59, 2
    s_add_u32 s61, s61, s86
    s_add_u32 s61, s61, 144
    s_cmp_ge_u32 s61, 640
    s_cselect_b32 s60, 640, 0
    s_sub_u32 s61, s61, s60
    s_mul_i32 s61, s61, 3456
    s_add_u32 s61, s61, s58
    buffer_load_dwordx4 v4, s[20:23], s61 offen lds
    s_add_u32 s59, s59, 3
    s_cmp_lt_u32 s59, 32
    s_cbranch_scc1 L_w1_pa
    s_mov_b32 s59, s63
L_w1_pb:
    s_lshl_b32 s60, s59, 10
    s_add_u32 m0, s60, 32768
    s_lshl_b32 s61, s59, 2
    s_add_u32 s61, s61, s86
    s_add_u32 s61, s61, 272
    s_cmp_ge_u32 s61, 640
    s_cselect_b32 s60, 640, 0
    s_sub_u32 s61, s61, s60
    s_mul_i32 s61, s61, 3456
    s_add_u32 s61, s61, s58
    buffer_load_dwordx4 v4, s[20:23], s61 offen lds
    s_add_u32 s59, s59, 3
    s_cmp_lt_u32 s59, 32
    s_cbranch_scc1 L_w1_pb
    s_waitcnt vmcnt(10)
    s_lshl_b32 s57, s62, 2
    s_add_u32 s57, s57, 161328
    v_mov_b32 v8, s57
    v_mov_b32 v9, 2
    ds_write_b32 v8, v9
    s_mov_b32 s59, s63
L_w1_pc:
    s_lshl_b32 s60, s59, 10
    s_add_u32 m0, s60, 65536
    s_lshl_b32 s61, s59, 2
    s_add_u32 s61, s61, s86
    s_add_u32 s61, s61, 400
    s_cmp_ge_u32 s61, 640
    s_cselect_b32 s60, 640, 0
    s_sub_u32 s61, s61, s60
    s_mul_i32 s61, s61, 3456
    s_add_u32 s61, s61, s58
    buffer_load_dwordx4 v4, s[20:23], s61 offen lds
    s_add_u32 s59, s59, 3
    s_cmp_lt_u32 s59, 36
    s_cbranch_scc1 L_w1_pc
    s_waitcnt vmcnt(12)
    s_lshl_b32 s57, s62, 2
    s_add_u32 s57, s57, 161328
    v_mov_b32 v8, s57
    v_mov_b32 v9, 3
    ds_write_b32 v8, v9
    v_mov_b32 v12, 161344
    s_mov_b32 s93, 0
L_lw_6:
    ds_read_b128 v[8:11], v12
    s_waitcnt lgkmcnt(0)
    v_min_u32 v8, v8, v9
    v_min3_u32 v8, v8, v10, v11
    s_nop 0
    v_readfirstlane_b32 s57, v8
    s_add_u32 s93, s93, 1
    s_cmp_gt_u32 s93, 200000
    s_cbranch_scc1 L_lw_6_x
    s_nop 0
    s_cmp_ge_u32 s57, 2
    s_cbranch_scc1 L_lw_6_x
    s_sleep 1
    s_branch L_lw_6
L_lw_6_x:
    s_mov_b32 s59, s63
L_w1_pd:
    s_lshl_b32 s60, s59, 10
    s_add_u32 m0, s60, 102400
    s_lshl_b32 s61, s59, 2
    s_add_u32 s61, s61, s86
    s_add_u32 s61, s61, 544
    s_cmp_ge_u32 s61, 640
    s_cselect_b32 s60, 640, 0
    s_sub_u32 s61, s61, s60
    s_mul_i32 s61, s61, 3456
    s_add_u32 s61, s61, s58
    buffer_load_dwordx4 v4, s[20:23], s61 offen lds
    s_add_u32 s59, s59, 3
    s_cmp_lt_u32 s59, 20
    s_cbranch_scc1 L_w1_pd
    s_waitcnt vmcnt(6)
    s_lshl_b32 s57, s62, 2
    s_add_u32 s57, s57, 161328
    v_mov_b32 v8, s57
    v_mov_b32 v9, 4
    ds_write_b32 v8, v9
    s_waitcnt vmcnt(0)
    s_lshl_b32 s57, s62, 2
    s_add_u32 s57, s57, 161328
    v_mov_b32 v8, s57
    v_mov_b32 v9, 5
    ds_write_b32 v8, v9
    v_mov_b32 v12, 161344
    s_mov_b32 s93, 0
L_lw_7:
    ds_read_b128 v[8:11], v12
    s_waitcnt lgkmcnt(0)
    v_min_u32 v8, v8, v9
    v_min3_u32 v8, v8, v10, v11
    s_nop 0
    v_readfirstlane_b32 s57, v8
    s_add_u32 s93, s93, 1
    s_cmp_gt_u32 s93, 200000
    s_cbranch_scc1 L_lw_7_x
    s_nop 0
    s_cmp_ge_u32 s57, 3
    s_cbranch_scc1 L_lw_7_x
    s_sleep 1
    s_branch L_lw_7
L_lw_7_x:
    s_mov_b32 s59, s63
L_w1_pe:
    s_lshl_b32 s60, s59, 10
    s_add_u32 m0, s60, 122880
    s_lshl_b32 s61, s59, 2
    s_add_u32 s61, s61, s86
    s_add_u32 s61, s61, 624
    s_cmp_ge_u32 s61, 640
    s_cselect_b32 s60, 640, 0
    s_sub_u32 s61, s61, s60
    s_mul_i32 s61, s61, 3456
    s_add_u32 s61, s61, s58
    buffer_load_dwordx4 v4, s[20:23], s61 offen lds
    s_add_u32 s59, s59, 3
    s_cmp_lt_u32 s59, 4
    s_cbranch_scc1 L_w1_pe
    s_waitcnt vmcnt(0)
    s_lshl_b32 s57, s62, 2
    s_add_u32 s57, s57, 161328
    v_mov_b32 v8, s57
    v_mov_b32 v9, 6
    ds_write_b32 v8, v9
L_H_F_idle:
    s_branch L_H_G_load
L_H4_F:
    s_mov_b32 s61, 0
L_wait_b3:
    buffer_load_dwordx2 v[10:11], v28, s[28:31], s72 offen sc1
    s_waitcnt vmcnt(0)
    v_subrev_u32 v10, s73, v10
    v_xor_b32 v11, s95, v11
    v_cmp_le_u32 vcc, 64, v10
    v_cmp_ne_u32 s[86:87], 0, v11
    s_nop 3
    s_or_b64 vcc, vcc, s[86:87]
    s_add_u32 s61, s61, 1
    s_cmp_gt_u32 s61, 200000
    s_cbranch_scc1 L_wait_b3_x
    s_cbranch_vccz L_wait_b3_x
    s_sleep 1
    s_branch L_wait_b3
L_wait_b3_x:
    v_mov_b32 v8, 161376
    v_mov_b32 v9, 2
    ds_write_b32 v8, v9
    v_mov_b32 v8, 161380
    v_mov_b32 v9, 1
    ds_write_b32 v8, v9
    s_lshl_b32 s70, s49, 8
    s_lshl_b32 s71, s50, 3
    s_add_u32 s70, s70, s71
    s_add_u32 s70, s70, 22364160
    s_add_u32 s71, s94, s51
    s_add_u32 s71, s71, 96
    v_mov_b32 v24, s71
    v_mov_b32 v25, s95
    v_mov_b32 v26, 0
    s_lshr_b32 s63, s50, 4
    s_lshl_b32 s63, s63, 4
    s_lshl_b32 s72, s49, 8
    s_lshl_b32 s63, s63, 3
    s_add_u32 s72, s72, s63
    s_add_u32 s72, s72, 22364160
    v_min_u32 v28, 13, v1
    v_lshlrev_b32 v28, 3, v28
    s_add_u32 s73, s94, 96
    v_mov_b32 v16, 161312
    s_mov_b32 s93, 0
L_lw_10:
    ds_read_b128 v[12:15], v16
    s_waitcnt lgkmcnt(0)
    v_min_u32 v12, v12, v13
    v_min3_u32 v12, v12, v14, v15
    s_nop 0
    v_readfirstlane_b32 s57, v12
    s_add_u32 s93, s93, 1
    s_cmp_gt_u32 s93, 200000
    s_cbranch_scc1 L_lw_10_x
    s_nop 0
    s_cmp_lt_u32 s57, 3
    s_cbranch_scc1 L_lw_10
L_lw_10_x:
    s_mov_b64 exec, 1
    s_cmp_lg_u32 s52, 0
    s_cbranch_scc1 L_pub_f_fast
    buffer_store_dwordx2 v[24:25], v26, s[28:31], s70 offen sc1
    s_branch L_pub_f_done
L_pub_f_fast:
    buffer_store_dwordx2 v[24:25], v26, s[28:31], s70 offen
L_pub_f_done:
    s_mov_b64 exec, -1
    s_mov_b32 s61, 0
L_wait_b4:
    buffer_load_dwordx2 v[10:11], v28, s[28:31], s72 offen sc1
    s_waitcnt vmcnt(0)
    v_subrev_u32 v10, s73, v10
    v_xor_b32 v11, s95, v11
    v_cmp_le_u32 vcc, 32, v10
    v_cmp_ne_u32 s[86:87], 0, v11
    s_nop 3
    s_or_b64 vcc, vcc, s[86:87]
    s_add_u32 s61, s61, 1
    s_cmp_gt_u32 s61, 200000
    s_cbranch_scc1 L_wait_b4_x
    s_cbranch_vccz L_wait_b4_x
    s_sleep 1
    s_branch L_wait_b4
L_wait_b4_x:
    v_mov_b32 v8, 161376
    v_mov_b32 v9, 3
    ds_write_b32 v8, v9
    s_barrier
    s_barrier
    s_barrier
    s_barrier
    s_barrier
    s_barrier
    s_barrier
    s_barrier
    s_barrier
    s_branch L_H_end
L_H_G_load:
    s_sub_u32 s63, s48, 5
    s_and_b32 s58, s50, 7
    s_mul_i32 s58, s58, 276480
    s_add_u32 s58, s58, 24117248
    s_mul_i32 s59, s63, 5120
    s_add_u32 s58, s58, s59
    v_lshlrev_b32 v10, 4, v1
    v_mov_b32 v20, 161380
    s_mov_b32 s93, 0
L_lw_18:
    ds_read_b32 v16, v20
    s_waitcnt lgkmcnt(0)
    v_readfirstlane_b32 s57, v16
    s_add_u32 s93, s93, 1
    s_cmp_gt_u32 s93, 200000
    s_cbranch_scc1 L_lw_18_x
    s_nop 0
    s_cmp_ge_u32 s57, 1
    s_cbranch_scc1 L_lw_18_x
    s_sleep 1
    s_branch L_lw_18
L_lw_18_x:
    s_mov_b32 s86, 153600
    s_add_u32 s61, s58, s86
    s_add_u32 s60, s61, 0
    buffer_load_dwordx4 v[64:67], v10, s[28:31], s60 offen sc1
    s_add_u32 s60, s61, 1024
    buffer_load_dwordx4 v[68:71], v10, s[28:31], s60 offen sc1
    s_add_u32 s60, s61, 2048
    buffer_load_dwordx4 v[72:75], v10, s[28:31], s60 offen sc1
    s_add_u32 s60, s61, 3072
    buffer_load_dwordx4 v[76:79], v10, s[28:31], s60 offen sc1
    s_add_u32 s60, s61, 4096
    buffer_load_dwordx4 v[80:83], v10, s[28:31], s60 offen sc1
    s_add_u32 s60, s61, 15360
    buffer_load_dwordx4 v[84:87], v10, s[28:31], s60 offen sc1
    s_add_u32 s60, s61, 16384
    buffer_load_dwordx4 v[88:91], v10, s[28:31], s60 offen sc1
    s_add_u32 s60, s61, 17408
    buffer_load_dwordx4 v[92:95], v10, s[28:31], s60 offen sc1
    s_add_u32 s60, s61, 18432
    buffer_load_dwordx4 v[96:99], v10, s[28:31], s60 offen sc1
    s_add_u32 s60, s61, 19456
    buffer_load_dwordx4 v[100:103], v10, s[28:31], s60 offen sc1
    s_mov_b32 s86, 215040
    s_add_u32 s61, s58, s86
    s_add_u32 s60, s61, 0
    buffer_load_dwordx4 v[104:107], v10, s[28:31], s60 offen sc1
    s_add_u32 s60, s61, 1024
    buffer_load_dwordx4 v[108:111], v10, s[28:31], s60 offen sc1
    s_add_u32 s60, s61, 2048
    buffer_load_dwordx4 v[112:115], v10, s[28:31], s60 offen sc1
    s_add_u32 s60, s61, 3072
    buffer_load_dwordx4 v[116:119], v10, s[28:31], s60 offen sc1
    s_add_u32 s60, s61, 4096
    buffer_load_dwordx4 v[120:123], v10, s[28:31], s60 offen sc1
    s_add_u32 s60, s61, 15360
    buffer_load_dwordx4 v[124:127], v10, s[28:31], s60 offen sc1
    s_add_u32 s60, s61, 16384
    buffer_load_dwordx4 v[128:131], v10, s[28:31], s60 offen sc1
    s_add_u32 s60, s61, 17408
    buffer_load_dwordx4 v[132:135], v10, s[28:31], s60 offen sc1
    s_add_u32 s60, s61, 18432
    buffer_load_dwordx4 v[136:139], v10, s[28:31], s60 offen sc1
    s_add_u32 s60, s61, 19456
    buffer_load_dwordx4 v[140:143], v10, s[28:31], s60 offen sc1
    v_add_u32 v11, s59, v10
    v_add_u32 v12, 61440, v11
    v_add_u32 v13, 122880, v11
    v_mov_b32 v20, 161504
    s_mov_b32 s93, 0
L_lw_19:
    ds_read_b128 v[16:19], v20
    s_waitcnt lgkmcnt(0)
    v_min_u32 v16, v16, v17
    v_min3_u32 v16, v16, v18, v19
    s_nop 0
    v_readfirstlane_b32 s57, v16
    s_add_u32 s93, s93, 1
    s_cmp_gt_u32 s93, 200000
    s_cbranch_scc1 L_lw_19_x
    s_nop 0
    s_cmp_ge_u32 s57, 1
    s_cbranch_scc1 L_lw_19_x
    s_sleep 1
    s_branch L_lw_19
L_lw_19_x:
    s_mov_b32 s86, 0
    s_add_u32 s61, s58, s86
    s_add_u32 m0, s59, 0
    s_add_u32 s60, s61, 0
    buffer_load_dwordx4 v10, s[28:31], s60 offen sc1 lds
    s_add_u32 m0, s59, 1024
    s_add_u32 s60, s61, 1024
    buffer_load_dwordx4 v10, s[28:31], s60 offen sc1 lds
    s_add_u32 m0, s59, 2048
    s_add_u32 s60, s61, 2048
    buffer_load_dwordx4 v10, s[28:31], s60 offen sc1 lds
    s_add_u32 m0, s59, 3072
    s_add_u32 s60, s61, 3072
    buffer_load_dwordx4 v10, s[28:31], s60 offen sc1 lds
    s_add_u32 m0, s59, 4096
    s_add_u32 s60, s61, 4096
    buffer_load_dwordx4 v10, s[28:31], s60 offen sc1 lds
    s_add_u32 m0, s59, 15360
    s_add_u32 s60, s61, 15360
    buffer_load_dwordx4 v10, s[28:31], s60 offen sc1 lds
    s_add_u32 m0, s59, 16384
    s_add_u32 s60, s61, 16384
    buffer_load_dwordx4 v10, s[28:31], s60 offen sc1 lds
    s_add_u32 m0, s59, 17408
    s_add_u32 s60, s61, 17408
    buffer_load_dwordx4 v10, s[28:31], s60 offen sc1 lds
    s_add_u32 m0, s59, 18432
    s_add_u32 s60, s61, 18432
    buffer_load_dwordx4 v10, s[28:31], s60 offen sc1 lds
    s_add_u32 m0, s59, 19456
    s_add_u32 s60, s61, 19456
    buffer_load_dwordx4 v10, s[28:31], s60 offen sc1 lds
    v_mov_b32 v20, 161504
    s_mov_b32 s93, 0
L_lw_20:
    ds_read_b128 v[16:19], v20
    s_waitcnt lgkmcnt(0)
    v_min_u32 v16, v16, v17
    v_min3_u32 v16, v16, v18, v19
    s_nop 0
    v_readfirstlane_b32 s57, v16
    s_add_u32 s93, s93, 1
    s_cmp_gt_u32 s93, 200000
    s_cbranch_scc1 L_lw_20_x
    s_nop 0
    s_cmp_ge_u32 s57, 2
    s_cbranch_scc1 L_lw_20_x
    s_sleep 1
    s_branch L_lw_20
L_lw_20_x:
    s_mov_b32 s86, 30720
    s_add_u32 s61, s58, s86
    s_add_u32 m0, s59, 30720
    s_add_u32 s60, s61, 0
    buffer_load_dwordx4 v10, s[28:31], s60 offen sc1 lds
    s_add_u32 m0, s59, 31744
    s_add_u32 s60, s61, 1024
    buffer_load_dwordx4 v10, s[28:31], s60 offen sc1 lds
    s_add_u32 m0, s59, 32768
    s_add_u32 s60, s61, 2048
    buffer_load_dwordx4 v10, s[28:31], s60 offen sc1 lds
    s_add_u32 m0, s59, 33792
    s_add_u32 s60, s61, 3072
    buffer_load_dwordx4 v10, s[28:31], s60 offen sc1 lds
    s_add_u32 m0, s59, 34816
    s_add_u32 s60, s61, 4096
    buffer_load_dwordx4 v10, s[28:31], s60 offen sc1 lds
    s_add_u32 m0, s59, 46080
    s_add_u32 s60, s61, 15360
    buffer_load_dwordx4 v10, s[28:31], s60 offen sc1 lds
    s_add_u32 m0, s59, 47104
    s_add_u32 s60, s61, 16384
    buffer_load_dwordx4 v10, s[28:31], s60 offen sc1 lds
    s_add_u32 m0, s59, 48128
    s_add_u32 s60, s61, 17408
    buffer_load_dwordx4 v10, s[28:31], s60 offen sc1 lds
    s_add_u32 m0, s59, 49152
    s_add_u32 s60, s61, 18432
    buffer_load_dwordx4 v10, s[28:31], s60 offen sc1 lds
    s_add_u32 m0, s59, 50176
    s_add_u32 s60, s61, 19456
    buffer_load_dwordx4 v10, s[28:31], s60 offen sc1 lds
    v_mov_b32 v20, 161504
    s_mov_b32 s93, 0
L_lw_21:
    ds_read_b128 v[16:19], v20
    s_waitcnt lgkmcnt(0)
    v_min_u32 v16, v16, v17
    v_min3_u32 v16, v16, v18, v19
    s_nop 0
    v_readfirstlane_b32 s57, v16
    s_add_u32 s93, s93, 1
    s_cmp_gt_u32 s93, 200000
    s_cbranch_scc1 L_lw_21_x
    s_nop 0
    s_cmp_ge_u32 s57, 3
    s_cbranch_scc1 L_lw_21_x
    s_sleep 1
    s_branch L_lw_21
L_lw_21_x:
    s_mov_b32 s86, 61440
    s_add_u32 s61, s58, s86
    s_add_u32 m0, s59, 61440
    s_add_u32 s60, s61, 0
    buffer_load_dwordx4 v10, s[28:31], s60 offen sc1 lds
    s_add_u32 m0, s59, 62464
    s_add_u32 s60, s61, 1024
    buffer_load_dwordx4 v10, s[28:31], s60 offen sc1 lds
    s_add_u32 m0, s59, 63488
    s_add_u32 s60, s61, 2048
    buffer_load_dwordx4 v10, s[28:31], s60 offen sc1 lds
    s_add_u32 m0, s59, 64512
    s_add_u32 s60, s61, 3072
    buffer_load_dwordx4 v10, s[28:31], s60 offen sc1 lds
    s_add_u32 m0, s59, 65536
    s_add_u32 s60, s61, 4096
    buffer_load_dwordx4 v10, s[28:31], s60 offen sc1 lds
    s_add_u32 m0, s59, 76800
    s_add_u32 s60, s61, 15360
    buffer_load_dwordx4 v10, s[28:31], s60 offen sc1 lds
    s_add_u32 m0, s59, 77824
    s_add_u32 s60, s61, 16384
    buffer_load_dwordx4 v10, s[28:31], s60 offen sc1 lds
    s_add_u32 m0, s59, 78848
    s_add_u32 s60, s61, 17408
    buffer_load_dwordx4 v10, s[28:31], s60 offen sc1 lds
    s_add_u32 m0, s59, 79872
    s_add_u32 s60, s61, 18432
    buffer_load_dwordx4 v10, s[28:31], s60 offen sc1 lds
    s_add_u32 m0, s59, 80896
    s_add_u32 s60, s61, 19456
    buffer_load_dwordx4 v10, s[28:31], s60 offen sc1 lds
    v_mov_b32 v20, 161344
    s_mov_b32 s93, 0
L_lw_22:
    ds_read_b128 v[16:19], v20
    s_waitcnt lgkmcnt(0)
    v_min_u32 v16, v16, v17
    v_min3_u32 v16, v16, v18, v19
    s_nop 0
    v_readfirstlane_b32 s57, v16
    s_add_u32 s93, s93, 1
    s_cmp_gt_u32 s93, 200000
    s_cbranch_scc1 L_lw_22_x
    s_nop 0
    s_cmp_ge_u32 s57, 4
    s_cbranch_scc1 L_lw_22_x
    s_sleep 1
    s_branch L_lw_22
L_lw_22_x:
    s_mov_b32 s86, 92160
    s_add_u32 s61, s58, s86
    s_add_u32 m0, s59, 92160
    s_add_u32 s60, s61, 0
    buffer_load_dwordx4 v10, s[28:31], s60 offen sc1 lds
    s_add_u32 m0, s59, 93184
    s_add_u32 s60, s61, 1024
    buffer_load_dwordx4 v10, s[28:31], s60 offen sc1 lds
    s_add_u32 m0, s59, 94208
    s_add_u32 s60, s61, 2048
    buffer_load_dwordx4 v10, s[28:31], s60 offen sc1 lds
    s_add_u32 m0, s59, 95232
    s_add_u32 s60, s61, 3072
    buffer_load_dwordx4 v10, s[28:31], s60 offen sc1 lds
    s_add_u32 m0, s59, 96256
    s_add_u32 s60, s61, 4096
    buffer_load_dwordx4 v10, s[28:31], s60 offen sc1 lds
    s_add_u32 m0, s59, 107520
    s_add_u32 s60, s61, 15360
    buffer_load_dwordx4 v10, s[28:31], s60 offen sc1 lds
    s_add_u32 m0, s59, 108544
    s_add_u32 s60, s61, 16384
    buffer_load_dwordx4 v10, s[28:31], s60 offen sc1 lds
    s_add_u32 m0, s59, 109568
    s_add_u32 s60, s61, 17408
    buffer_load_dwordx4 v10, s[28:31], s60 offen sc1 lds
    s_add_u32 m0, s59, 110592
    s_add_u32 s60, s61, 18432
    buffer_load_dwordx4 v10, s[28:31], s60 offen sc1 lds
    s_add_u32 m0, s59, 111616
    s_add_u32 s60, s61, 19456
    buffer_load_dwordx4 v10, s[28:31], s60 offen sc1 lds
    s_mov_b32 s86, 122880
    s_add_u32 s61, s58, s86
    s_add_u32 m0, s59, 122880
    s_add_u32 s60, s61, 0
    buffer_load_dwordx4 v10, s[28:31], s60 offen sc1 lds
    s_add_u32 m0, s59, 123904
    s_add_u32 s60, s61, 1024
    buffer_load_dwordx4 v10, s[28:31], s60 offen sc1 lds
    s_add_u32 m0, s59, 124928
    s_add_u32 s60, s61, 2048
    buffer_load_dwordx4 v10, s[28:31], s60 offen sc1 lds
    s_add_u32 m0, s59, 125952
    s_add_u32 s60, s61, 3072
    buffer_load_dwordx4 v10, s[28:31], s60 offen sc1 lds
    s_add_u32 m0, s59, 126976
    s_add_u32 s60, s61, 4096
    buffer_load_dwordx4 v10, s[28:31], s60 offen sc1 lds
    s_add_u32 m0, s59, 138240
    s_add_u32 s60, s61, 15360
    buffer_load_dwordx4 v10, s[28:31], s60 offen sc1 lds
    s_add_u32 m0, s59, 139264
    s_add_u32 s60, s61, 16384
    buffer_load_dwordx4 v10, s[28:31], s60 offen sc1 lds
    s_add_u32 m0, s59, 140288
    s_add_u32 s60, s61, 17408
    buffer_load_dwordx4 v10, s[28:31], s60 offen sc1 lds
    s_add_u32 m0, s59, 141312
    s_add_u32 s60, s61, 18432
    buffer_load_dwordx4 v10, s[28:31], s60 offen sc1 lds
    s_add_u32 m0, s59, 142336
    s_add_u32 s60, s61, 19456
    buffer_load_dwordx4 v10, s[28:31], s60 offen sc1 lds
    s_waitcnt vmcnt(40) lgkmcnt(0)
    s_barrier
    s_waitcnt vmcnt(30) lgkmcnt(0)
    s_barrier
    s_waitcnt vmcnt(20) lgkmcnt(0)
    s_barrier
    ds_write_b128 v11, v[64:67] offset:0
    ds_write_b128 v11, v[68:71] offset:1024
    ds_write_b128 v11, v[72:75] offset:2048
    ds_write_b128 v11, v[76:79] offset:3072
    ds_write_b128 v11, v[80:83] offset:4096
    ds_write_b128 v11, v[84:87] offset:15360
    ds_write_b128 v11, v[88:91] offset:16384
    ds_write_b128 v11, v[92:95] offset:17408
    ds_write_b128 v11, v[96:99] offset:18432
    ds_write_b128 v11, v[100:103] offset:19456
    s_waitcnt vmcnt(10) lgkmcnt(0)
    s_barrier
    s_mov_b32 s86, 184320
    s_add_u32 s61, s58, s86
    s_add_u32 m0, s59, 30720
    s_add_u32 s60, s61, 0
    buffer_load_dwordx4 v10, s[28:31], s60 offen sc1 lds
    s_add_u32 m0, s59, 31744
    s_add_u32 s60, s61, 1024
    buffer_load_dwordx4 v10, s[28:31], s60 offen sc1 lds
    s_add_u32 m0, s59, 32768
    s_add_u32 s60, s61, 2048
    buffer_load_dwordx4 v10, s[28:31], s60 offen sc1 lds
    s_add_u32 m0, s59, 33792
    s_add_u32 s60, s61, 3072
    buffer_load_dwordx4 v10, s[28:31], s60 offen sc1 lds
    s_add_u32 m0, s59, 34816
    s_add_u32 s60, s61, 4096
    buffer_load_dwordx4 v10, s[28:31], s60 offen sc1 lds
    s_add_u32 m0, s59, 46080
    s_add_u32 s60, s61, 15360
    buffer_load_dwordx4 v10, s[28:31], s60 offen sc1 lds
    s_add_u32 m0, s59, 47104
    s_add_u32 s60, s61, 16384
    buffer_load_dwordx4 v10, s[28:31], s60 offen sc1 lds
    s_add_u32 m0, s59, 48128
    s_add_u32 s60, s61, 17408
    buffer_load_dwordx4 v10, s[28:31], s60 offen sc1 lds
    s_add_u32 m0, s59, 49152
    s_add_u32 s60, s61, 18432
    buffer_load_dwordx4 v10, s[28:31], s60 offen sc1 lds
    s_add_u32 m0, s59, 50176
    s_add_u32 s60, s61, 19456
    buffer_load_dwordx4 v10, s[28:31], s60 offen sc1 lds
    s_waitcnt vmcnt(10) lgkmcnt(0)
    s_barrier
    ds_write_b128 v12, v[104:107] offset:0
    ds_write_b128 v12, v[108:111] offset:1024
    ds_write_b128 v12, v[112:115] offset:2048
    ds_write_b128 v12, v[116:119] offset:3072
    ds_write_b128 v12, v[120:123] offset:4096
    ds_write_b128 v12, v[124:127] offset:15360
    ds_write_b128 v12, v[128:131] offset:16384
    ds_write_b128 v12, v[132:135] offset:17408
    ds_write_b128 v12, v[136:139] offset:18432
    ds_write_b128 v12, v[140:143] offset:19456
    s_waitcnt vmcnt(63) lgkmcnt(0)
    s_barrier
    s_mov_b32 s86, 245760
    s_add_u32 s61, s58, s86
    s_add_u32 m0, s59, 92160
    s_add_u32 s60, s61, 0
    buffer_load_dwordx4 v10, s[28:31], s60 offen sc1 lds
    s_add_u32 m0, s59, 93184
    s_add_u32 s60, s61, 1024
    buffer_load_dwordx4 v10, s[28:31], s60 offen sc1 lds
    s_add_u32 m0, s59, 94208
    s_add_u32 s60, s61, 2048
    buffer_load_dwordx4 v10, s[28:31], s60 offen sc1 lds
    s_add_u32 m0, s59, 95232
    s_add_u32 s60, s61, 3072
    buffer_load_dwordx4 v10, s[28:31], s60 offen sc1 lds
    s_add_u32 m0, s59, 96256
    s_add_u32 s60, s61, 4096
    buffer_load_dwordx4 v10, s[28:31], s60 offen sc1 lds
    s_add_u32 m0, s59, 107520
    s_add_u32 s60, s61, 15360
    buffer_load_dwordx4 v10, s[28:31], s60 offen sc1 lds
    s_add_u32 m0, s59, 108544
    s_add_u32 s60, s61, 16384
    buffer_load_dwordx4 v10, s[28:31], s60 offen sc1 lds
    s_add_u32 m0, s59, 109568
    s_add_u32 s60, s61, 17408
    buffer_load_dwordx4 v10, s[28:31], s60 offen sc1 lds
    s_add_u32 m0, s59, 110592
    s_add_u32 s60, s61, 18432
    buffer_load_dwordx4 v10, s[28:31], s60 offen sc1 lds
    s_add_u32 m0, s59, 111616
    s_add_u32 s60, s61, 19456
    buffer_load_dwordx4 v10, s[28:31], s60 offen sc1 lds
    s_waitcnt vmcnt(10) lgkmcnt(0)
    s_barrier
    s_waitcnt vmcnt(63) lgkmcnt(0)
    s_barrier
    s_waitcnt vmcnt(0) lgkmcnt(0)
    s_barrier
L_H_end:
    s_endpgm
L_M_start:
    s_or_b32 s57, s2, s48
    s_cmp_lg_u32 s57, 0
    s_cbranch_scc1 L_M_zskip
    v_mov_b32 v6, 0
    s_memrealtime s[58:59]
    s_waitcnt lgkmcnt(0)
    s_or_b32 s59, s59, 0x40000000
    v_mov_b32 v8, s58
    v_mov_b32 v9, s59
    s_mov_b64 exec, 1
    buffer_store_dwordx2 v[8:9], v6, s[36:39], 0 offen sc1
    s_mov_b64 exec, -1
L_M_zskip:
    s_mov_b32 s57, s48
    s_lshr_b32 s58, s49, 1
    s_lshl_b32 s58, s58, 9
    s_lshl_b32 s59, s50, 4
    s_add_u32 s58, s58, s59
    s_mul_i32 s58, s58, 1280
    s_lshl_b32 s59, s57, 7
    s_add_u32 s58, s58, s59
    v_and_b32 v40, 15, v1
    v_mul_u32_u24 v41, 1280, v40
    s_mov_b32 exec_lo, 0xffff
    s_mov_b32 exec_hi, 0
    buffer_load_dword v250, v41, s[8:11], s58 offen
    s_mov_b32 exec_lo, -1
    s_lshl_b32 s58, s57, 6
    s_lshl_b32 s59, s50, 1
    s_add_u32 s58, s58, s59
    s_mul_i32 s58, s58, 3840
    s_and_b32 s59, s49, 1
    s_lshl_b32 s59, s59, 11
    s_add_u32 s58, s58, s59
    v_bfe_u32 v41, v1, 4, 1
    v_mul_u32_u24 v41, 3840, v41
    v_lshl_add_u32 v41, v40, 7, v41
    s_mov_b32 s60, s66
    s_mov_b32 s61, s67
    s_mov_b32 s62, 2457600
    s_mov_b32 s63, 0x20000
    buffer_load_dword v251, v41, s[60:63], s58 offen
    s_mov_b64 exec, -1
    v_lshrrev_b32 v2, 5, v1
    v_and_b32 v3, 31, v1
    s_lshr_b32 s57, s49, 1
    s_lshl_b32 s57, s57, 6
    s_and_b32 s58, s49, 1
    s_lshl_b32 s58, s58, 5
    s_add_u32 s57, s57, s58
    s_add_u32 s57, s57, s50
    s_lshl_b32 s57, s57, 3
    s_lshl_b32 s58, s48, 1
    s_add_u32 s57, s57, s58
    v_add_u32 v4, s57, v2
    v_mul_u32_u24 v5, 1280, v4
    v_lshl_add_u32 v5, v3, 3, v5
    buffer_load_dwordx2 v[16:17], v5, s[8:11], 0 offen offset:0
    buffer_load_dwordx2 v[18:19], v5, s[8:11], 0 offen offset:256
    buffer_load_dwordx2 v[20:21], v5, s[8:11], 0 offen offset:512
    buffer_load_dwordx2 v[22:23], v5, s[8:11], 0 offen offset:768
    buffer_load_dwordx2 v[24:25], v5, s[8:11], 0 offen offset:1024
    s_mov_b32 s16, s68
    s_mov_b32 s17, s69
    s_mov_b32 s18, 819200
    s_mov_b32 s19, 0x20000
    s_mov_b32 s20, s72
    s_mov_b32 s21, s73
    s_mov_b32 s22, 2211840
    s_mov_b32 s23, 0x20000
    s_mov_b32 s24, s76
    s_mov_b32 s25, s77
    s_mov_b32 s26, 2211840
    s_mov_b32 s27, 0x20000
    s_mov_b32 s32, s80
    s_mov_b32 s33, s81
    s_mov_b32 s34, 2621440
    s_mov_b32 s35, 0x20000
    s_mov_b32 s40, s74
    s_mov_b32 s41, s75
    s_mov_b32 s42, 3456
    s_mov_b32 s43, 0x20000
    s_mov_b32 s44, s78
    s_mov_b32 s45, s79
    s_mov_b32 s46, 1280
    s_mov_b32 s47, 0x20000
    v_bfe_u32 v30, v1, 2, 2
    v_and_b32 v31, 3, v1
    v_bfe_u32 v32, v1, 4, 1
    v_lshrrev_b32 v33, 5, v1
    v_lshl_add_u32 v34, v33, 3, v30
    v_lshlrev_b32 v34, 8, v34
    v_lshrrev_b32 v35, 1, v31
    v_lshl_add_u32 v34, v35, 3, v34
    v_add_u32 v34, 16384, v34
    v_and_b32 v35, 1, v31
    v_lshl_add_u32 v35, v32, 1, v35
    v_lshl_add_u32 v35, v30, 2, v35
    s_add_u32 s57, s48, 0
    s_and_b32 s57, s57, 3
    s_lshl_b32 s57, s57, 2
    v_add_u32 v36, s57, v35
    v_and_b32 v36, 15, v36
    v_lshl_add_u32 v8, v36, 4, v34
    s_add_u32 s57, s48, 1
    s_and_b32 s57, s57, 3
    s_lshl_b32 s57, s57, 2
    v_add_u32 v36, s57, v35
    v_and_b32 v36, 15, v36
    v_lshl_add_u32 v9, v36, 4, v34
    s_add_u32 s57, s48, 2
    s_and_b32 s57, s57, 3
    s_lshl_b32 s57, s57, 2
    v_add_u32 v36, s57, v35
    v_and_b32 v36, 15, v36
    v_lshl_add_u32 v10, v36, 4, v34
    s_add_u32 s57, s48, 3
    s_and_b32 s57, s57, 3
    s_lshl_b32 s57, s57, 2
    v_add_u32 v36, s57, v35
    v_and_b32 v36, 15, v36
    v_lshl_add_u32 v11, v36, 4, v34
    s_lshl_b32 s57, s48, 5
    v_add_u32 v36, s57, v3
    v_bfe_u32 v37, v36, 1, 3
    v_xor_b32 v37, v37, v2
    v_lshlrev_b32 v36, 7, v36
    v_lshl_add_u32 v12, v37, 4, v36
    v_xor_b32 v13, 32, v12
    v_xor_b32 v14, 64, v12
    v_xor_b32 v15, 96, v12
    v_add_u32 v48, 65536, v8
    v_add_u32 v49, 65536, v9
    v_add_u32 v50, 65536, v10
    v_add_u32 v51, 65536, v11
    v_add_u32 v52, 65536, v12
    v_add_u32 v53, 65536, v13
    v_add_u32 v54, 65536, v14
    v_add_u32 v55, 65536, v15
    v_mov_b32 v64, 0
    v_mov_b32 v65, 0
    v_mov_b32 v66, 0
    v_mov_b32 v67, 0
    v_mov_b32 v68, 0
    v_mov_b32 v69, 0
    v_mov_b32 v70, 0
    v_mov_b32 v71, 0
    v_mov_b32 v72, 0
    v_mov_b32 v73, 0
    v_mov_b32 v74, 0
    v_mov_b32 v75, 0
    v_mov_b32 v76, 0
    v_mov_b32 v77, 0
    v_mov_b32 v78, 0
    v_mov_b32 v79, 0
    v_mov_b32 v80, 0
    v_mov_b32 v81, 0
    v_mov_b32 v82, 0
    v_mov_b32 v83, 0
    v_mov_b32 v84, 0
    v_mov_b32 v85, 0
    v_mov_b32 v86, 0
    v_mov_b32 v87, 0
    v_mov_b32 v88, 0
    v_mov_b32 v89, 0
    v_mov_b32 v90, 0
    v_mov_b32 v91, 0
    v_mov_b32 v92, 0
    v_mov_b32 v93, 0
    v_mov_b32 v94, 0
    v_mov_b32 v95, 0
    v_mov_b32 v96, 0
    v_mov_b32 v97, 0
    v_mov_b32 v98, 0
    v_mov_b32 v99, 0
    v_mov_b32 v100, 0
    v_mov_b32 v101, 0
    v_mov_b32 v102, 0
    v_mov_b32 v103, 0
    v_mov_b32 v104, 0
    v_mov_b32 v105, 0
    v_mov_b32 v106, 0
    v_mov_b32 v107, 0
    v_mov_b32 v108, 0
    v_mov_b32 v109, 0
    v_mov_b32 v110, 0
    v_mov_b32 v111, 0
    v_mov_b32 v112, 0
    v_mov_b32 v113, 0
    v_mov_b32 v114, 0
    v_mov_b32 v115, 0
    v_mov_b32 v116, 0
    v_mov_b32 v117, 0
    v_mov_b32 v118, 0
    v_mov_b32 v119, 0
    v_mov_b32 v120, 0
    v_mov_b32 v121, 0
    v_mov_b32 v122, 0
    v_mov_b32 v123, 0
    v_mov_b32 v124, 0
    v_mov_b32 v125, 0
    v_mov_b32 v126, 0
    v_mov_b32 v127, 0
    v_mov_b32 v128, 0
    v_mov_b32 v129, 0
    v_mov_b32 v130, 0
    v_mov_b32 v131, 0
    v_mov_b32 v132, 0
    v_mov_b32 v133, 0
    v_mov_b32 v134, 0
    v_mov_b32 v135, 0
    v_mov_b32 v136, 0
    v_mov_b32 v137, 0
    v_mov_b32 v138, 0
    v_mov_b32 v139, 0
    v_mov_b32 v140, 0
    v_mov_b32 v141, 0
    v_mov_b32 v142, 0
    v_mov_b32 v143, 0
    v_and_b32 v36, 15, v1
    v_bfe_u32 v37, v1, 4, 1
    v_cmp_eq_u32 vcc, v36, v37
    v_mov_b32 v36, 0
    v_mov_b32 v37, 0x3f803f80
    v_cndmask_b32 v36, v36, v37, vcc
    v_mov_b32 v184, v36
    v_mov_b32 v185, v36
    v_mov_b32 v186, v36
    v_mov_b32 v187, v36
    v_mov_b32 v192, 0
    v_mov_b32 v193, 0
    v_mov_b32 v194, 0
    v_mov_b32 v195, 0
    v_mov_b32 v196, 0
    v_mov_b32 v197, 0
    v_mov_b32 v198, 0
    v_mov_b32 v199, 0
    v_mov_b32 v200, 0
    v_mov_b32 v201, 0
    v_mov_b32 v202, 0
    v_mov_b32 v203, 0
    v_mov_b32 v204, 0
    v_mov_b32 v205, 0
    v_mov_b32 v206, 0
    v_mov_b32 v207, 0
    v_mov_b32 v208, 0
    v_mov_b32 v209, 0
    v_mov_b32 v210, 0
    v_mov_b32 v211, 0
    s_lshl_b32 s57, s48, 7
    s_add_u32 s57, s57, 160768
    v_and_b32 v212, 15, v1
    v_lshlrev_b32 v212, 6, v212
    v_lshrrev_b32 v213, 4, v1
    v_lshl_add_u32 v212, v213, 4, v212
    v_add_u32 v213, s57, v212
    s_add_u32 s57, s48, 0
    s_and_b32 s57, s57, 3
    s_lshl_b32 s57, s57, 7
    s_add_u32 s57, s57, 160768
    v_lshlrev_b32 v214, 2, v3
    v_add_u32 v214, s57, v214
    s_add_u32 s57, s48, 1
    s_and_b32 s57, s57, 3
    s_lshl_b32 s57, s57, 7
    s_add_u32 s57, s57, 160768
    v_lshlrev_b32 v215, 2, v3
    v_add_u32 v215, s57, v215
    s_add_u32 s57, s48, 2
    s_and_b32 s57, s57, 3
    s_lshl_b32 s57, s57, 7
    s_add_u32 s57, s57, 160768
    v_lshlrev_b32 v216, 2, v3
    v_add_u32 v216, s57, v216
    s_add_u32 s57, s48, 3
    s_and_b32 s57, s57, 3
    s_lshl_b32 s57, s57, 7
    s_add_u32 s57, s57, 160768
    v_lshlrev_b32 v217, 2, v3
    v_add_u32 v217, s57, v217
    s_lshl_b32 s57, s48, 8
    s_add_u32 s57, s57, 159744
    v_lshlrev_b32 v218, 3, v3
    v_add_u32 v218, s57, v218
    v_lshlrev_b32 v219, 4, v1
    s_lshl_b32 s59, s53, 2
    s_add_u32 s59, s59, s48
    s_mul_i32 s59, s59, 122880
    s_add_u32 s57, s48, 0
    s_and_b32 s57, s57, 3
    s_lshl_b32 s57, s57, 2
    s_lshl_b32 s58, s54, 4
    s_add_u32 s57, s57, s58
    s_lshl_b32 s57, s57, 9
    s_add_u32 s86, s57, s59
    s_add_u32 s57, s48, 1
    s_and_b32 s57, s57, 3
    s_lshl_b32 s57, s57, 2
    s_lshl_b32 s58, s54, 4
    s_add_u32 s57, s57, s58
    s_lshl_b32 s57, s57, 9
    s_add_u32 s87, s57, s59
    s_add_u32 s57, s48, 2
    s_and_b32 s57, s57, 3
    s_lshl_b32 s57, s57, 2
    s_lshl_b32 s58, s54, 4
    s_add_u32 s57, s57, s58
    s_lshl_b32 s57, s57, 9
    s_add_u32 s88, s57, s59
    s_add_u32 s57, s48, 3
    s_and_b32 s57, s57, 3
    s_lshl_b32 s57, s57, 2
    s_lshl_b32 s58, s54, 4
    s_add_u32 s57, s57, s58
    s_lshl_b32 s57, s57, 9
    s_add_u32 s89, s57, s59
    s_mov_b32 s90, 1.0
    s_mov_b32 s58, 0x3ea52b5c
    s_cmp_lt_u32 s54, 5
    s_cselect_b32 s90, s58, s90
    s_waitcnt vmcnt(0)
    s_cmp_ge_u32 s48, 4
    s_cbranch_scc1 L_M_t2skip
    s_add_u32 s57, s48, 4
    s_lshr_b32 s58, s49, 1
    s_lshl_b32 s58, s58, 9
    s_lshl_b32 s59, s50, 4
    s_add_u32 s58, s58, s59
    s_mul_i32 s58, s58, 1280
    s_lshl_b32 s59, s57, 7
    s_add_u32 s58, s58, s59
    v_and_b32 v40, 15, v1
    v_mul_u32_u24 v41, 1280, v40
    s_mov_b32 exec_lo, 0xffff
    s_mov_b32 exec_hi, 0
    buffer_load_dword v250, v41, s[8:11], s58 offen
    s_mov_b32 exec_lo, -1
    s_lshl_b32 s58, s57, 6
    s_lshl_b32 s59, s50, 1
    s_add_u32 s58, s58, s59
    s_mul_i32 s58, s58, 3840
    s_and_b32 s59, s49, 1
    s_lshl_b32 s59, s59, 11
    s_add_u32 s58, s58, s59
    v_bfe_u32 v41, v1, 4, 1
    v_mul_u32_u24 v41, 3840, v41
    v_lshl_add_u32 v41, v40, 7, v41
    s_mov_b32 s60, s66
    s_mov_b32 s61, s67
    s_mov_b32 s62, 2457600
    s_mov_b32 s63, 0x20000
    buffer_load_dword v251, v41, s[60:63], s58 offen
    s_mov_b64 exec, -1
L_M_t2skip:
    v_mov_b32 v26, 0
    v_mov_b32 v27, 0
    v_lshlrev_b32 v28, 16, v16
    v_and_b32 v29, 0xffff0000, v16
    v_add_f32 v26, v26, v28
    v_fmac_f32 v27, v28, v28
    v_add_f32 v26, v26, v29
    v_fmac_f32 v27, v29, v29
    v_lshlrev_b32 v28, 16, v17
    v_and_b32 v29, 0xffff0000, v17
    v_add_f32 v26, v26, v28
    v_fmac_f32 v27, v28, v28
    v_add_f32 v26, v26, v29
    v_fmac_f32 v27, v29, v29
    v_lshlrev_b32 v28, 16, v18
    v_and_b32 v29, 0xffff0000, v18
    v_add_f32 v26, v26, v28
    v_fmac_f32 v27, v28, v28
    v_add_f32 v26, v26, v29
    v_fmac_f32 v27, v29, v29
    v_lshlrev_b32 v28, 16, v19
    v_and_b32 v29, 0xffff0000, v19
    v_add_f32 v26, v26, v28
    v_fmac_f32 v27, v28, v28
    v_add_f32 v26, v26, v29
    v_fmac_f32 v27, v29, v29
    v_lshlrev_b32 v28, 16, v20
    v_and_b32 v29, 0xffff0000, v20
    v_add_f32 v26, v26, v28
    v_fmac_f32 v27, v28, v28
    v_add_f32 v26, v26, v29
    v_fmac_f32 v27, v29, v29
    v_lshlrev_b32 v28, 16, v21
    v_and_b32 v29, 0xffff0000, v21
    v_add_f32 v26, v26, v28
    v_fmac_f32 v27, v28, v28
    v_add_f32 v26, v26, v29
    v_fmac_f32 v27, v29, v29
    v_lshlrev_b32 v28, 16, v22
    v_and_b32 v29, 0xffff0000, v22
    v_add_f32 v26, v26, v28
    v_fmac_f32 v27, v28, v28
    v_add_f32 v26, v26, v29
    v_fmac_f32 v27, v29, v29
    v_lshlrev_b32 v28, 16, v23
    v_and_b32 v29, 0xffff0000, v23
    v_add_f32 v26, v26, v28
    v_fmac_f32 v27, v28, v28
    v_add_f32 v26, v26, v29
    v_fmac_f32 v27, v29, v29
    v_lshlrev_b32 v28, 16, v24
    v_and_b32 v29, 0xffff0000, v24
    v_add_f32 v26, v26, v28
    v_fmac_f32 v27, v28, v28
    v_add_f32 v26, v26, v29
    v_fmac_f32 v27, v29, v29
    v_lshlrev_b32 v28, 16, v25
    v_and_b32 v29, 0xffff0000, v25
    v_add_f32 v26, v26, v28
    v_fmac_f32 v27, v28, v28
    v_add_f32 v26, v26, v29
    v_fmac_f32 v27, v29, v29
    s_nop 0
    v_add_f32_dpp v26, v26, v26 row_shr:1 row_mask:0xf bank_mask:0xf bound_ctrl:0
    v_add_f32_dpp v27, v27, v27 row_shr:1 row_mask:0xf bank_mask:0xf bound_ctrl:0
    s_nop 0
    v_add_f32_dpp v26, v26, v26 row_shr:2 row_mask:0xf bank_mask:0xf bound_ctrl:0
    v_add_f32_dpp v27, v27, v27 row_shr:2 row_mask:0xf bank_mask:0xf bound_ctrl:0
    s_nop 0
    v_add_f32_dpp v26, v26, v26 row_shr:4 row_mask:0xf bank_mask:0xf bound_ctrl:0
    v_add_f32_dpp v27, v27, v27 row_shr:4 row_mask:0xf bank_mask:0xf bound_ctrl:0
    s_nop 0
    v_add_f32_dpp v26, v26, v26 row_shr:8 row_mask:0xf bank_mask:0xf bound_ctrl:0
    v_add_f32_dpp v27, v27, v27 row_shr:8 row_mask:0xf bank_mask:0xf bound_ctrl:0
    s_nop 0
    v_add_f32_dpp v26, v26, v26 row_bcast:15 row_mask:0xa bank_mask:0xf
    v_add_f32_dpp v27, v27, v27 row_bcast:15 row_mask:0xa bank_mask:0xf
    v_mul_f32 v26, 0x3acccccd, v26
    v_mul_f32 v27, 0x3acccccd, v27
    v_fma_f32 v27, -v26, v26, v27
    v_max_f32 v27, 0, v27
    v_add_f32 v27, 0x3727c5ac, v27
    v_rsq_f32 v27, v27
    s_lshl_b32 s57, s48, 4
    s_add_u32 s57, s57, 161424
    v_lshlrev_b32 v5, 3, v2
    v_add_u32 v5, s57, v5
    s_mov_b32 exec_lo, 0x80000000
    s_mov_b32 exec_hi, 0x80000000
    ds_write_b64 v5, v[26:27]
    s_mov_b64 exec, -1
    s_waitcnt lgkmcnt(0)
    s_barrier
    ds_read_b128 v[176:179], v12 offset:0
    ds_read_b64_tr_b16 v[144:145], v8 offset:0
    ds_read_b64_tr_b16 v[146:147], v8 offset:1024
    ds_read_b64_tr_b16 v[148:149], v9 offset:0
    ds_read_b64_tr_b16 v[150:151], v9 offset:1024
    ds_read_b64_tr_b16 v[152:153], v10 offset:0
    ds_read_b64_tr_b16 v[154:155], v10 offset:1024
    ds_read_b64_tr_b16 v[156:157], v11 offset:0
    ds_read_b64_tr_b16 v[158:159], v11 offset:1024
    s_waitcnt lgkmcnt(6)
    v_mfma_f32_32x32x16_bf16 v[64:79], v[144:147], v[176:179], v[64:79]
    ds_read_b128 v[180:183], v13 offset:0
    ds_read_b64_tr_b16 v[160:161], v8 offset:4096
    ds_read_b64_tr_b16 v[162:163], v8 offset:5120
    s_waitcnt lgkmcnt(7)
    v_mfma_f32_32x32x16_bf16 v[80:95], v[148:151], v[176:179], v[80:95]
    ds_read_b64_tr_b16 v[164:165], v9 offset:4096
    ds_read_b64_tr_b16 v[166:167], v9 offset:5120
    ds_read_b64_tr_b16 v[168:169], v10 offset:4096
    s_waitcnt lgkmcnt(8)
    v_mfma_f32_32x32x16_bf16 v[96:111], v[152:155], v[176:179], v[96:111]
    ds_read_b64_tr_b16 v[170:171], v10 offset:5120
    ds_read_b64_tr_b16 v[172:173], v11 offset:4096
    ds_read_b64_tr_b16 v[174:175], v11 offset:5120
    s_waitcnt lgkmcnt(9)
    v_mfma_f32_32x32x16_bf16 v[112:127], v[156:159], v[176:179], v[112:127]
    v_mfma_f32_16x16x32_bf16 v[128:131], v[144:147], v[184:187], v[128:131]
    s_waitcnt lgkmcnt(6)
    v_mfma_f32_32x32x16_bf16 v[64:79], v[160:163], v[180:183], v[64:79]
    ds_read_b128 v[176:179], v14 offset:0
    ds_read_b64_tr_b16 v[144:145], v8 offset:8192
    ds_read_b64_tr_b16 v[146:147], v8 offset:9216
    s_waitcnt lgkmcnt(7)
    v_mfma_f32_32x32x16_bf16 v[80:95], v[164:167], v[180:183], v[80:95]
    ds_read_b64_tr_b16 v[148:149], v9 offset:8192
    ds_read_b64_tr_b16 v[150:151], v9 offset:9216
    ds_read_b64_tr_b16 v[152:153], v10 offset:8192
    s_waitcnt lgkmcnt(8)
    v_mfma_f32_32x32x16_bf16 v[96:111], v[168:171], v[180:183], v[96:111]
    ds_read_b64_tr_b16 v[154:155], v10 offset:9216
    ds_read_b64_tr_b16 v[156:157], v11 offset:8192
    ds_read_b64_tr_b16 v[158:159], v11 offset:9216
    s_waitcnt lgkmcnt(9)
    v_mfma_f32_32x32x16_bf16 v[112:127], v[172:175], v[180:183], v[112:127]
    s_barrier
    v_mfma_f32_16x16x32_bf16 v[128:131], v[160:163], v[184:187], v[128:131]
    s_waitcnt lgkmcnt(6)
    v_mfma_f32_32x32x16_bf16 v[64:79], v[144:147], v[176:179], v[64:79]
    ds_read_b128 v[180:183], v15 offset:0
    ds_read_b64_tr_b16 v[160:161], v8 offset:12288
    ds_read_b64_tr_b16 v[162:163], v8 offset:13312
    s_waitcnt lgkmcnt(7)
    v_mfma_f32_32x32x16_bf16 v[80:95], v[148:151], v[176:179], v[80:95]
    ds_read_b64_tr_b16 v[164:165], v9 offset:12288
    ds_read_b64_tr_b16 v[166:167], v9 offset:13312
    ds_read_b64_tr_b16 v[168:169], v10 offset:12288
    s_waitcnt lgkmcnt(8)
    v_mfma_f32_32x32x16_bf16 v[96:111], v[152:155], v[176:179], v[96:111]
    ds_read_b64_tr_b16 v[170:171], v10 offset:13312
    ds_read_b64_tr_b16 v[172:173], v11 offset:12288
    ds_read_b64_tr_b16 v[174:175], v11 offset:13312
    s_waitcnt lgkmcnt(9)
    v_mfma_f32_32x32x16_bf16 v[112:127], v[156:159], v[176:179], v[112:127]
    v_mfma_f32_16x16x32_bf16 v[128:131], v[144:147], v[184:187], v[128:131]
    s_waitcnt lgkmcnt(6)
    v_mfma_f32_32x32x16_bf16 v[64:79], v[160:163], v[180:183], v[64:79]
    ds_read_b128 v[176:179], v12 offset:32768
    ds_read_b64_tr_b16 v[144:145], v8 offset:32768
    ds_read_b64_tr_b16 v[146:147], v8 offset:33792
    s_waitcnt lgkmcnt(7)
    v_mfma_f32_32x32x16_bf16 v[80:95], v[164:167], v[180:183], v[80:95]
    ds_read_b64_tr_b16 v[148:149], v9 offset:32768
    ds_read_b64_tr_b16 v[150:151], v9 offset:33792
    ds_read_b64_tr_b16 v[152:153], v10 offset:32768
    s_waitcnt lgkmcnt(8)
    v_mfma_f32_32x32x16_bf16 v[96:111], v[168:171], v[180:183], v[96:111]
    ds_read_b64_tr_b16 v[154:155], v10 offset:33792
    ds_read_b64_tr_b16 v[156:157], v11 offset:32768
    ds_read_b64_tr_b16 v[158:159], v11 offset:33792
    s_waitcnt lgkmcnt(9)
    v_mfma_f32_32x32x16_bf16 v[112:127], v[172:175], v[180:183], v[112:127]
    s_cmp_ge_u32 s48, 2
    s_cbranch_scc1 L_M_t4skip
    s_add_u32 s57, s48, 8
    s_lshr_b32 s58, s49, 1
    s_lshl_b32 s58, s58, 9
    s_lshl_b32 s59, s50, 4
    s_add_u32 s58, s58, s59
    s_mul_i32 s58, s58, 1280
    s_lshl_b32 s59, s57, 7
    s_add_u32 s58, s58, s59
    v_and_b32 v40, 15, v1
    v_mul_u32_u24 v41, 1280, v40
    s_mov_b32 exec_lo, 0xffff
    s_mov_b32 exec_hi, 0
    buffer_load_dword v250, v41, s[8:11], s58 offen
    s_mov_b32 exec_lo, -1
    s_lshl_b32 s58, s57, 6
    s_lshl_b32 s59, s50, 1
    s_add_u32 s58, s58, s59
    s_mul_i32 s58, s58, 3840
    s_and_b32 s59, s49, 1
    s_lshl_b32 s59, s59, 11
    s_add_u32 s58, s58, s59
    v_bfe_u32 v41, v1, 4, 1
    v_mul_u32_u24 v41, 3840, v41
    v_lshl_add_u32 v41, v40, 7, v41
    s_mov_b32 s60, s66
    s_mov_b32 s61, s67
    s_mov_b32 s62, 2457600
    s_mov_b32 s63, 0x20000
    buffer_load_dword v251, v41, s[60:63], s58 offen
    s_mov_b64 exec, -1
L_M_t4skip:
    v_mfma_f32_16x16x32_bf16 v[128:131], v[160:163], v[184:187], v[128:131]
    s_waitcnt lgkmcnt(6)
    v_mfma_f32_32x32x16_bf16 v[64:79], v[144:147], v[176:179], v[64:79]
    ds_read_b128 v[180:183], v13 offset:32768
    ds_read_b64_tr_b16 v[160:161], v8 offset:36864
    ds_read_b64_tr_b16 v[162:163], v8 offset:37888
    s_waitcnt lgkmcnt(7)
    v_mfma_f32_32x32x16_bf16 v[80:95], v[148:151], v[176:179], v[80:95]
    ds_read_b64_tr_b16 v[164:165], v9 offset:36864
    ds_read_b64_tr_b16 v[166:167], v9 offset:37888
    ds_read_b64_tr_b16 v[168:169], v10 offset:36864
    s_waitcnt lgkmcnt(8)
    v_mfma_f32_32x32x16_bf16 v[96:111], v[152:155], v[176:179], v[96:111]
    ds_read_b64_tr_b16 v[170:171], v10 offset:37888
    ds_read_b64_tr_b16 v[172:173], v11 offset:36864
    ds_read_b64_tr_b16 v[174:175], v11 offset:37888
    s_waitcnt lgkmcnt(9)
    v_mfma_f32_32x32x16_bf16 v[112:127], v[156:159], v[176:179], v[112:127]
    v_mfma_f32_16x16x32_bf16 v[128:131], v[144:147], v[184:187], v[128:131]
    s_waitcnt lgkmcnt(6)
    v_mfma_f32_32x32x16_bf16 v[64:79], v[160:163], v[180:183], v[64:79]
    ds_read_b128 v[176:179], v14 offset:32768
    ds_read_b64_tr_b16 v[144:145], v8 offset:40960
    ds_read_b64_tr_b16 v[146:147], v8 offset:41984
    s_waitcnt lgkmcnt(7)
    v_mfma_f32_32x32x16_bf16 v[80:95], v[164:167], v[180:183], v[80:95]
    ds_read_b64_tr_b16 v[148:149], v9 offset:40960
    ds_read_b64_tr_b16 v[150:151], v9 offset:41984
    ds_read_b64_tr_b16 v[152:153], v10 offset:40960
    s_waitcnt lgkmcnt(8)
    v_mfma_f32_32x32x16_bf16 v[96:111], v[168:171], v[180:183], v[96:111]
    ds_read_b64_tr_b16 v[154:155], v10 offset:41984
    ds_read_b64_tr_b16 v[156:157], v11 offset:40960
    ds_read_b64_tr_b16 v[158:159], v11 offset:41984
    s_waitcnt lgkmcnt(9)
    v_mfma_f32_32x32x16_bf16 v[112:127], v[172:175], v[180:183], v[112:127]
    s_barrier
    v_mfma_f32_16x16x32_bf16 v[128:131], v[160:163], v[184:187], v[128:131]
    s_waitcnt lgkmcnt(6)
    v_mfma_f32_32x32x16_bf16 v[64:79], v[144:147], v[176:179], v[64:79]
    ds_read_b128 v[180:183], v15 offset:32768
    ds_read_b64_tr_b16 v[160:161], v8 offset:45056
    ds_read_b64_tr_b16 v[162:163], v8 offset:46080
    s_waitcnt lgkmcnt(7)
    v_mfma_f32_32x32x16_bf16 v[80:95], v[148:151], v[176:179], v[80:95]
    ds_read_b64_tr_b16 v[164:165], v9 offset:45056
    ds_read_b64_tr_b16 v[166:167], v9 offset:46080
    ds_read_b64_tr_b16 v[168:169], v10 offset:45056
    s_waitcnt lgkmcnt(8)
    v_mfma_f32_32x32x16_bf16 v[96:111], v[152:155], v[176:179], v[96:111]
    ds_read_b64_tr_b16 v[170:171], v10 offset:46080
    ds_read_b64_tr_b16 v[172:173], v11 offset:45056
    ds_read_b64_tr_b16 v[174:175], v11 offset:46080
    s_waitcnt lgkmcnt(9)
    v_mfma_f32_32x32x16_bf16 v[112:127], v[156:159], v[176:179], v[112:127]
    v_mfma_f32_16x16x32_bf16 v[128:131], v[144:147], v[184:187], v[128:131]
    s_waitcnt lgkmcnt(6)
    v_mfma_f32_32x32x16_bf16 v[64:79], v[160:163], v[180:183], v[64:79]
    ds_read_b128 v[176:179], v52 offset:0
    ds_read_b64_tr_b16 v[144:145], v48 offset:0
    ds_read_b64_tr_b16 v[146:147], v48 offset:1024
    s_waitcnt lgkmcnt(7)
    v_mfma_f32_32x32x16_bf16 v[80:95], v[164:167], v[180:183], v[80:95]
    ds_read_b64_tr_b16 v[148:149], v49 offset:0
    ds_read_b64_tr_b16 v[150:151], v49 offset:1024
    ds_read_b64_tr_b16 v[152:153], v50 offset:0
    s_waitcnt lgkmcnt(8)
    v_mfma_f32_32x32x16_bf16 v[96:111], v[168:171], v[180:183], v[96:111]
    ds_read_b64_tr_b16 v[154:155], v50 offset:1024
    ds_read_b64_tr_b16 v[156:157], v51 offset:0
    ds_read_b64_tr_b16 v[158:159], v51 offset:1024
    s_waitcnt lgkmcnt(9)
    v_mfma_f32_32x32x16_bf16 v[112:127], v[172:175], v[180:183], v[112:127]
    v_mfma_f32_16x16x32_bf16 v[128:131], v[160:163], v[184:187], v[128:131]
    s_waitcnt lgkmcnt(6)
    v_mfma_f32_32x32x16_bf16 v[64:79], v[144:147], v[176:179], v[64:79]
    ds_read_b128 v[180:183], v53 offset:0
    ds_read_b64_tr_b16 v[160:161], v48 offset:4096
    ds_read_b64_tr_b16 v[162:163], v48 offset:5120
    s_waitcnt lgkmcnt(7)
    v_mfma_f32_32x32x16_bf16 v[80:95], v[148:151], v[176:179], v[80:95]
    ds_read_b64_tr_b16 v[164:165], v49 offset:4096
    ds_read_b64_tr_b16 v[166:167], v49 offset:5120
    ds_read_b64_tr_b16 v[168:169], v50 offset:4096
    s_waitcnt lgkmcnt(8)
    v_mfma_f32_32x32x16_bf16 v[96:111], v[152:155], v[176:179], v[96:111]
    ds_read_b64_tr_b16 v[170:171], v50 offset:5120
    ds_read_b64_tr_b16 v[172:173], v51 offset:4096
    ds_read_b64_tr_b16 v[174:175], v51 offset:5120
    s_waitcnt lgkmcnt(9)
    v_mfma_f32_32x32x16_bf16 v[112:127], v[156:159], v[176:179], v[112:127]
    v_mfma_f32_16x16x32_bf16 v[128:131], v[144:147], v[184:187], v[128:131]
    s_waitcnt lgkmcnt(6)
    v_mfma_f32_32x32x16_bf16 v[64:79], v[160:163], v[180:183], v[64:79]
    ds_read_b128 v[176:179], v54 offset:0
    ds_read_b64_tr_b16 v[144:145], v48 offset:8192
    ds_read_b64_tr_b16 v[146:147], v48 offset:9216
    s_waitcnt lgkmcnt(7)
    v_mfma_f32_32x32x16_bf16 v[80:95], v[164:167], v[180:183], v[80:95]
    ds_read_b64_tr_b16 v[148:149], v49 offset:8192
    ds_read_b64_tr_b16 v[150:151], v49 offset:9216
    ds_read_b64_tr_b16 v[152:153], v50 offset:8192
    s_waitcnt lgkmcnt(8)
    v_mfma_f32_32x32x16_bf16 v[96:111], v[168:171], v[180:183], v[96:111]
    ds_read_b64_tr_b16 v[154:155], v50 offset:9216
    ds_read_b64_tr_b16 v[156:157], v51 offset:8192
    ds_read_b64_tr_b16 v[158:159], v51 offset:9216
    s_waitcnt lgkmcnt(9)
    v_mfma_f32_32x32x16_bf16 v[112:127], v[172:175], v[180:183], v[112:127]
    s_barrier
    v_mfma_f32_16x16x32_bf16 v[128:131], v[160:163], v[184:187], v[128:131]
    s_waitcnt lgkmcnt(6)
    v_mfma_f32_32x32x16_bf16 v[64:79], v[144:147], v[176:179], v[64:79]
    ds_read_b128 v[180:183], v55 offset:0
    ds_read_b64_tr_b16 v[160:161], v48 offset:12288
    ds_read_b64_tr_b16 v[162:163], v48 offset:13312
    s_waitcnt lgkmcnt(7)
    v_mfma_f32_32x32x16_bf16 v[80:95], v[148:151], v[176:179], v[80:95]
    ds_read_b64_tr_b16 v[164:165], v49 offset:12288
    ds_read_b64_tr_b16 v[166:167], v49 offset:13312
    ds_read_b64_tr_b16 v[168:169], v50 offset:12288
    s_waitcnt lgkmcnt(8)
    v_mfma_f32_32x32x16_bf16 v[96:111], v[152:155], v[176:179], v[96:111]
    ds_read_b64_tr_b16 v[170:171], v50 offset:13312
    ds_read_b64_tr_b16 v[172:173], v51 offset:12288
    ds_read_b64_tr_b16 v[174:175], v51 offset:13312
    s_waitcnt lgkmcnt(9)
    v_mfma_f32_32x32x16_bf16 v[112:127], v[156:159], v[176:179], v[112:127]
    v_mfma_f32_16x16x32_bf16 v[128:131], v[144:147], v[184:187], v[128:131]
    s_waitcnt lgkmcnt(6)
    v_mfma_f32_32x32x16_bf16 v[64:79], v[160:163], v[180:183], v[64:79]
    ds_read_b128 v[176:179], v52 offset:32768
    ds_read_b64_tr_b16 v[144:145], v48 offset:32768
    ds_read_b64_tr_b16 v[146:147], v48 offset:33792
    s_waitcnt lgkmcnt(7)
    v_mfma_f32_32x32x16_bf16 v[80:95], v[164:167], v[180:183], v[80:95]
    ds_read_b64_tr_b16 v[148:149], v49 offset:32768
    ds_read_b64_tr_b16 v[150:151], v49 offset:33792
    ds_read_b64_tr_b16 v[152:153], v50 offset:32768
    s_waitcnt lgkmcnt(8)
    v_mfma_f32_32x32x16_bf16 v[96:111], v[168:171], v[180:183], v[96:111]
    ds_read_b64_tr_b16 v[154:155], v50 offset:33792
    ds_read_b64_tr_b16 v[156:157], v51 offset:32768
    ds_read_b64_tr_b16 v[158:159], v51 offset:33792
    s_waitcnt lgkmcnt(9)
    v_mfma_f32_32x32x16_bf16 v[112:127], v[172:175], v[180:183], v[112:127]
    v_mfma_f32_16x16x32_bf16 v[128:131], v[160:163], v[184:187], v[128:131]
    s_waitcnt lgkmcnt(6)
    v_mfma_f32_32x32x16_bf16 v[64:79], v[144:147], v[176:179], v[64:79]
    ds_read_b128 v[180:183], v53 offset:32768
    ds_read_b64_tr_b16 v[160:161], v48 offset:36864
    ds_read_b64_tr_b16 v[162:163], v48 offset:37888
    s_waitcnt lgkmcnt(7)
    v_mfma_f32_32x32x16_bf16 v[80:95], v[148:151], v[176:179], v[80:95]
    ds_read_b64_tr_b16 v[164:165], v49 offset:36864
    ds_read_b64_tr_b16 v[166:167], v49 offset:37888
    ds_read_b64_tr_b16 v[168:169], v50 offset:36864
    s_waitcnt lgkmcnt(8)
    v_mfma_f32_32x32x16_bf16 v[96:111], v[152:155], v[176:179], v[96:111]
    ds_read_b64_tr_b16 v[170:171], v50 offset:37888
    ds_read_b64_tr_b16 v[172:173], v51 offset:36864
    ds_read_b64_tr_b16 v[174:175], v51 offset:37888
    s_waitcnt lgkmcnt(9)
    v_mfma_f32_32x32x16_bf16 v[112:127], v[156:159], v[176:179], v[112:127]
    v_mfma_f32_16x16x32_bf16 v[128:131], v[144:147], v[184:187], v[128:131]
    s_waitcnt lgkmcnt(6)
    v_mfma_f32_32x32x16_bf16 v[64:79], v[160:163], v[180:183], v[64:79]
    ds_read_b128 v[176:179], v54 offset:32768
    ds_read_b64_tr_b16 v[144:145], v48 offset:40960
    ds_read_b64_tr_b16 v[146:147], v48 offset:41984
    s_waitcnt lgkmcnt(7)
    v_mfma_f32_32x32x16_bf16 v[80:95], v[164:167], v[180:183], v[80:95]
    ds_read_b64_tr_b16 v[148:149], v49 offset:40960
    ds_read_b64_tr_b16 v[150:151], v49 offset:41984
    ds_read_b64_tr_b16 v[152:153], v50 offset:40960
    s_waitcnt lgkmcnt(8)
    v_mfma_f32_32x32x16_bf16 v[96:111], v[168:171], v[180:183], v[96:111]
    ds_read_b64_tr_b16 v[154:155], v50 offset:41984
    ds_read_b64_tr_b16 v[156:157], v51 offset:40960
    ds_read_b64_tr_b16 v[158:159], v51 offset:41984
    s_waitcnt lgkmcnt(9)
    v_mfma_f32_32x32x16_bf16 v[112:127], v[172:175], v[180:183], v[112:127]
    s_barrier
    v_mfma_f32_16x16x32_bf16 v[128:131], v[160:163], v[184:187], v[128:131]
    s_waitcnt lgkmcnt(6)
    v_mfma_f32_32x32x16_bf16 v[64:79], v[144:147], v[176:179], v[64:79]
    ds_read_b128 v[180:183], v55 offset:32768
    ds_read_b64_tr_b16 v[160:161], v48 offset:45056
    ds_read_b64_tr_b16 v[162:163], v48 offset:46080
    s_waitcnt lgkmcnt(7)
    v_mfma_f32_32x32x16_bf16 v[80:95], v[148:151], v[176:179], v[80:95]
    ds_read_b64_tr_b16 v[164:165], v49 offset:45056
    ds_read_b64_tr_b16 v[166:167], v49 offset:46080
    ds_read_b64_tr_b16 v[168:169], v50 offset:45056
    s_waitcnt lgkmcnt(8)
    v_mfma_f32_32x32x16_bf16 v[96:111], v[152:155], v[176:179], v[96:111]
    ds_read_b64_tr_b16 v[170:171], v50 offset:46080
    ds_read_b64_tr_b16 v[172:173], v51 offset:45056
    ds_read_b64_tr_b16 v[174:175], v51 offset:46080
    s_waitcnt lgkmcnt(9)
    v_mfma_f32_32x32x16_bf16 v[112:127], v[156:159], v[176:179], v[112:127]
    v_mfma_f32_16x16x32_bf16 v[128:131], v[144:147], v[184:187], v[128:131]
    s_waitcnt lgkmcnt(6)
    v_mfma_f32_32x32x16_bf16 v[64:79], v[160:163], v[180:183], v[64:79]
    ds_read_b128 v[176:179], v12 offset:0
    ds_read_b64_tr_b16 v[144:145], v8 offset:0
    ds_read_b64_tr_b16 v[146:147], v8 offset:1024
    s_waitcnt lgkmcnt(7)
    v_mfma_f32_32x32x16_bf16 v[80:95], v[164:167], v[180:183], v[80:95]
    ds_read_b64_tr_b16 v[148:149], v9 offset:0
    ds_read_b64_tr_b16 v[150:151], v9 offset:1024
    ds_read_b64_tr_b16 v[152:153], v10 offset:0
    s_waitcnt lgkmcnt(8)
    v_mfma_f32_32x32x16_bf16 v[96:111], v[168:171], v[180:183], v[96:111]
    ds_read_b64_tr_b16 v[154:155], v10 offset:1024
    ds_read_b64_tr_b16 v[156:157], v11 offset:0
    ds_read_b64_tr_b16 v[158:159], v11 offset:1024
    s_waitcnt lgkmcnt(9)
    v_mfma_f32_32x32x16_bf16 v[112:127], v[172:175], v[180:183], v[112:127]
    v_mfma_f32_16x16x32_bf16 v[128:131], v[160:163], v[184:187], v[128:131]
    s_waitcnt lgkmcnt(6)
    v_mfma_f32_32x32x16_bf16 v[64:79], v[144:147], v[176:179], v[64:79]
    ds_read_b128 v[180:183], v13 offset:0
    ds_read_b64_tr_b16 v[160:161], v8 offset:4096
    ds_read_b64_tr_b16 v[162:163], v8 offset:5120
    s_waitcnt lgkmcnt(7)
    v_mfma_f32_32x32x16_bf16 v[80:95], v[148:151], v[176:179], v[80:95]
    ds_read_b64_tr_b16 v[164:165], v9 offset:4096
    ds_read_b64_tr_b16 v[166:167], v9 offset:5120
    ds_read_b64_tr_b16 v[168:169], v10 offset:4096
    s_waitcnt lgkmcnt(8)
    v_mfma_f32_32x32x16_bf16 v[96:111], v[152:155], v[176:179], v[96:111]
    ds_read_b64_tr_b16 v[170:171], v10 offset:5120
    ds_read_b64_tr_b16 v[172:173], v11 offset:4096
    ds_read_b64_tr_b16 v[174:175], v11 offset:5120
    s_waitcnt lgkmcnt(9)
    v_mfma_f32_32x32x16_bf16 v[112:127], v[156:159], v[176:179], v[112:127]
    v_mfma_f32_16x16x32_bf16 v[128:131], v[144:147], v[184:187], v[128:131]
    s_waitcnt lgkmcnt(6)
    v_mfma_f32_32x32x16_bf16 v[64:79], v[160:163], v[180:183], v[64:79]
    ds_read_b128 v[176:179], v14 offset:0
    ds_read_b64_tr_b16 v[144:145], v8 offset:8192
    ds_read_b64_tr_b16 v[146:147], v8 offset:9216
    s_waitcnt lgkmcnt(7)
    v_mfma_f32_32x32x16_bf16 v[80:95], v[164:167], v[180:183], v[80:95]
    ds_read_b64_tr_b16 v[148:149], v9 offset:8192
    ds_read_b64_tr_b16 v[150:151], v9 offset:9216
    ds_read_b64_tr_b16 v[152:153], v10 offset:8192
    s_waitcnt lgkmcnt(8)
    v_mfma_f32_32x32x16_bf16 v[96:111], v[168:171], v[180:183], v[96:111]
    ds_read_b64_tr_b16 v[154:155], v10 offset:9216
    ds_read_b64_tr_b16 v[156:157], v11 offset:8192
    ds_read_b64_tr_b16 v[158:159], v11 offset:9216
    s_waitcnt lgkmcnt(9)
    v_mfma_f32_32x32x16_bf16 v[112:127], v[172:175], v[180:183], v[112:127]
    s_barrier
    v_mfma_f32_16x16x32_bf16 v[128:131], v[160:163], v[184:187], v[128:131]
    s_waitcnt lgkmcnt(6)
    v_mfma_f32_32x32x16_bf16 v[64:79], v[144:147], v[176:179], v[64:79]
    ds_read_b128 v[180:183], v15 offset:0
    ds_read_b64_tr_b16 v[160:161], v8 offset:12288
    ds_read_b64_tr_b16 v[162:163], v8 offset:13312
    s_waitcnt lgkmcnt(7)
    v_mfma_f32_32x32x16_bf16 v[80:95], v[148:151], v[176:179], v[80:95]
    ds_read_b64_tr_b16 v[164:165], v9 offset:12288
    ds_read_b64_tr_b16 v[166:167], v9 offset:13312
    ds_read_b64_tr_b16 v[168:169], v10 offset:12288
    s_waitcnt lgkmcnt(8)
    v_mfma_f32_32x32x16_bf16 v[96:111], v[152:155], v[176:179], v[96:111]
    ds_read_b64_tr_b16 v[170:171], v10 offset:13312
    ds_read_b64_tr_b16 v[172:173], v11 offset:12288
    ds_read_b64_tr_b16 v[174:175], v11 offset:13312
    s_waitcnt lgkmcnt(9)
    v_mfma_f32_32x32x16_bf16 v[112:127], v[156:159], v[176:179], v[112:127]
    v_mfma_f32_16x16x32_bf16 v[128:131], v[144:147], v[184:187], v[128:131]
    s_waitcnt lgkmcnt(6)
    v_mfma_f32_32x32x16_bf16 v[64:79], v[160:163], v[180:183], v[64:79]
    ds_read_b128 v[176:179], v12 offset:32768
    ds_read_b64_tr_b16 v[144:145], v8 offset:32768
    ds_read_b64_tr_b16 v[146:147], v8 offset:33792
    s_waitcnt lgkmcnt(7)
    v_mfma_f32_32x32x16_bf16 v[80:95], v[164:167], v[180:183], v[80:95]
    ds_read_b64_tr_b16 v[148:149], v9 offset:32768
    ds_read_b64_tr_b16 v[150:151], v9 offset:33792
    ds_read_b64_tr_b16 v[152:153], v10 offset:32768
    s_waitcnt lgkmcnt(8)
    v_mfma_f32_32x32x16_bf16 v[96:111], v[168:171], v[180:183], v[96:111]
    ds_read_b64_tr_b16 v[154:155], v10 offset:33792
    ds_read_b64_tr_b16 v[156:157], v11 offset:32768
    ds_read_b64_tr_b16 v[158:159], v11 offset:33792
    s_waitcnt lgkmcnt(9)
    v_mfma_f32_32x32x16_bf16 v[112:127], v[172:175], v[180:183], v[112:127]
    v_mfma_f32_16x16x32_bf16 v[128:131], v[160:163], v[184:187], v[128:131]
    s_waitcnt lgkmcnt(6)
    v_mfma_f32_32x32x16_bf16 v[64:79], v[144:147], v[176:179], v[64:79]
    ds_read_b128 v[180:183], v13 offset:32768
    ds_read_b64_tr_b16 v[160:161], v8 offset:36864
    ds_read_b64_tr_b16 v[162:163], v8 offset:37888
    s_waitcnt lgkmcnt(7)
    v_mfma_f32_32x32x16_bf16 v[80:95], v[148:151], v[176:179], v[80:95]
    ds_read_b64_tr_b16 v[164:165], v9 offset:36864
    ds_read_b64_tr_b16 v[166:167], v9 offset:37888
    ds_read_b64_tr_b16 v[168:169], v10 offset:36864
    s_waitcnt lgkmcnt(8)
    v_mfma_f32_32x32x16_bf16 v[96:111], v[152:155], v[176:179], v[96:111]
    ds_read_b64_tr_b16 v[170:171], v10 offset:37888
    ds_read_b64_tr_b16 v[172:173], v11 offset:36864
    ds_read_b64_tr_b16 v[174:175], v11 offset:37888
    s_waitcnt lgkmcnt(9)
    v_mfma_f32_32x32x16_bf16 v[112:127], v[156:159], v[176:179], v[112:127]
    v_mfma_f32_16x16x32_bf16 v[128:131], v[144:147], v[184:187], v[128:131]
    s_waitcnt lgkmcnt(6)
    v_mfma_f32_32x32x16_bf16 v[64:79], v[160:163], v[180:183], v[64:79]
    ds_read_b128 v[176:179], v14 offset:32768
    ds_read_b64_tr_b16 v[144:145], v8 offset:40960
    ds_read_b64_tr_b16 v[146:147], v8 offset:41984
    s_waitcnt lgkmcnt(7)
    v_mfma_f32_32x32x16_bf16 v[80:95], v[164:167], v[180:183], v[80:95]
    ds_read_b64_tr_b16 v[148:149], v9 offset:40960
    ds_read_b64_tr_b16 v[150:151], v9 offset:41984
    ds_read_b64_tr_b16 v[152:153], v10 offset:40960
    s_waitcnt lgkmcnt(8)
    v_mfma_f32_32x32x16_bf16 v[96:111], v[168:171], v[180:183], v[96:111]
    ds_read_b64_tr_b16 v[154:155], v10 offset:41984
    ds_read_b64_tr_b16 v[156:157], v11 offset:40960
    ds_read_b64_tr_b16 v[158:159], v11 offset:41984
    s_waitcnt lgkmcnt(9)
    v_mfma_f32_32x32x16_bf16 v[112:127], v[172:175], v[180:183], v[112:127]
    s_barrier
    v_mfma_f32_16x16x32_bf16 v[128:131], v[160:163], v[184:187], v[128:131]
    s_waitcnt lgkmcnt(6)
    v_mfma_f32_32x32x16_bf16 v[64:79], v[144:147], v[176:179], v[64:79]
    ds_read_b128 v[180:183], v15 offset:32768
    ds_read_b64_tr_b16 v[160:161], v8 offset:45056
    ds_read_b64_tr_b16 v[162:163], v8 offset:46080
    s_waitcnt lgkmcnt(7)
    v_mfma_f32_32x32x16_bf16 v[80:95], v[148:151], v[176:179], v[80:95]
    ds_read_b64_tr_b16 v[164:165], v9 offset:45056
    ds_read_b64_tr_b16 v[166:167], v9 offset:46080
    ds_read_b64_tr_b16 v[168:169], v10 offset:45056
    s_waitcnt lgkmcnt(8)
    v_mfma_f32_32x32x16_bf16 v[96:111], v[152:155], v[176:179], v[96:111]
    ds_read_b64_tr_b16 v[170:171], v10 offset:46080
    ds_read_b64_tr_b16 v[172:173], v11 offset:45056
    ds_read_b64_tr_b16 v[174:175], v11 offset:46080
    s_waitcnt lgkmcnt(9)
    v_mfma_f32_32x32x16_bf16 v[112:127], v[156:159], v[176:179], v[112:127]
    v_mfma_f32_16x16x32_bf16 v[128:131], v[144:147], v[184:187], v[128:131]
    s_waitcnt lgkmcnt(6)
    v_mfma_f32_32x32x16_bf16 v[64:79], v[160:163], v[180:183], v[64:79]
    ds_read_b128 v[176:179], v52 offset:0
    ds_read_b64_tr_b16 v[144:145], v48 offset:0
    ds_read_b64_tr_b16 v[146:147], v48 offset:1024
    s_waitcnt lgkmcnt(7)
    v_mfma_f32_32x32x16_bf16 v[80:95], v[164:167], v[180:183], v[80:95]
    ds_read_b64_tr_b16 v[148:149], v49 offset:0
    ds_read_b64_tr_b16 v[150:151], v49 offset:1024
    ds_read_b64_tr_b16 v[152:153], v50 offset:0
    s_waitcnt lgkmcnt(8)
    v_mfma_f32_32x32x16_bf16 v[96:111], v[168:171], v[180:183], v[96:111]
    ds_read_b64_tr_b16 v[154:155], v50 offset:1024
    ds_read_b64_tr_b16 v[156:157], v51 offset:0
    ds_read_b64_tr_b16 v[158:159], v51 offset:1024
    s_waitcnt lgkmcnt(9)
    v_mfma_f32_32x32x16_bf16 v[112:127], v[172:175], v[180:183], v[112:127]
    v_mfma_f32_16x16x32_bf16 v[128:131], v[160:163], v[184:187], v[128:131]
    s_waitcnt lgkmcnt(6)
    v_mfma_f32_32x32x16_bf16 v[64:79], v[144:147], v[176:179], v[64:79]
    ds_read_b128 v[180:183], v53 offset:0
    ds_read_b64_tr_b16 v[160:161], v48 offset:4096
    ds_read_b64_tr_b16 v[162:163], v48 offset:5120
    s_waitcnt lgkmcnt(7)
    v_mfma_f32_32x32x16_bf16 v[80:95], v[148:151], v[176:179], v[80:95]
    ds_read_b64_tr_b16 v[164:165], v49 offset:4096
    ds_read_b64_tr_b16 v[166:167], v49 offset:5120
    ds_read_b64_tr_b16 v[168:169], v50 offset:4096
    s_waitcnt lgkmcnt(8)
    v_mfma_f32_32x32x16_bf16 v[96:111], v[152:155], v[176:179], v[96:111]
    ds_read_b64_tr_b16 v[170:171], v50 offset:5120
    ds_read_b64_tr_b16 v[172:173], v51 offset:4096
    ds_read_b64_tr_b16 v[174:175], v51 offset:5120
    s_waitcnt lgkmcnt(9)
    v_mfma_f32_32x32x16_bf16 v[112:127], v[156:159], v[176:179], v[112:127]
    v_mfma_f32_16x16x32_bf16 v[128:131], v[144:147], v[184:187], v[128:131]
    s_waitcnt lgkmcnt(6)
    v_mfma_f32_32x32x16_bf16 v[64:79], v[160:163], v[180:183], v[64:79]
    ds_read_b128 v[176:179], v54 offset:0
    ds_read_b64_tr_b16 v[144:145], v48 offset:8192
    ds_read_b64_tr_b16 v[146:147], v48 offset:9216
    s_waitcnt lgkmcnt(7)
    v_mfma_f32_32x32x16_bf16 v[80:95], v[164:167], v[180:183], v[80:95]
    ds_read_b64_tr_b16 v[148:149], v49 offset:8192
    ds_read_b64_tr_b16 v[150:151], v49 offset:9216
    ds_read_b64_tr_b16 v[152:153], v50 offset:8192
    s_waitcnt lgkmcnt(8)
    v_mfma_f32_32x32x16_bf16 v[96:111], v[168:171], v[180:183], v[96:111]
    ds_read_b64_tr_b16 v[154:155], v50 offset:9216
    ds_read_b64_tr_b16 v[156:157], v51 offset:8192
    ds_read_b64_tr_b16 v[158:159], v51 offset:9216
    s_waitcnt lgkmcnt(9)
    v_mfma_f32_32x32x16_bf16 v[112:127], v[172:175], v[180:183], v[112:127]
    s_barrier
    v_mfma_f32_16x16x32_bf16 v[128:131], v[160:163], v[184:187], v[128:131]
    s_waitcnt lgkmcnt(6)
    v_mfma_f32_32x32x16_bf16 v[64:79], v[144:147], v[176:179], v[64:79]
    ds_read_b128 v[180:183], v55 offset:0
    ds_read_b64_tr_b16 v[160:161], v48 offset:12288
    ds_read_b64_tr_b16 v[162:163], v48 offset:13312
    s_waitcnt lgkmcnt(7)
    v_mfma_f32_32x32x16_bf16 v[80:95], v[148:151], v[176:179], v[80:95]
    ds_read_b64_tr_b16 v[164:165], v49 offset:12288
    ds_read_b64_tr_b16 v[166:167], v49 offset:13312
    ds_read_b64_tr_b16 v[168:169], v50 offset:12288
    s_waitcnt lgkmcnt(8)
    v_mfma_f32_32x32x16_bf16 v[96:111], v[152:155], v[176:179], v[96:111]
    ds_read_b64_tr_b16 v[170:171], v50 offset:13312
    ds_read_b64_tr_b16 v[172:173], v51 offset:12288
    ds_read_b64_tr_b16 v[174:175], v51 offset:13312
    s_waitcnt lgkmcnt(9)
    v_mfma_f32_32x32x16_bf16 v[112:127], v[156:159], v[176:179], v[112:127]
    v_mfma_f32_16x16x32_bf16 v[128:131], v[144:147], v[184:187], v[128:131]
    s_waitcnt lgkmcnt(6)
    v_mfma_f32_32x32x16_bf16 v[64:79], v[160:163], v[180:183], v[64:79]
    ds_read_b128 v[176:179], v52 offset:32768
    ds_read_b64_tr_b16 v[144:145], v48 offset:32768
    ds_read_b64_tr_b16 v[146:147], v48 offset:33792
    s_waitcnt lgkmcnt(7)
    v_mfma_f32_32x32x16_bf16 v[80:95], v[164:167], v[180:183], v[80:95]
    ds_read_b64_tr_b16 v[148:149], v49 offset:32768
    ds_read_b64_tr_b16 v[150:151], v49 offset:33792
    ds_read_b64_tr_b16 v[152:153], v50 offset:32768
    s_waitcnt lgkmcnt(8)
    v_mfma_f32_32x32x16_bf16 v[96:111], v[168:171], v[180:183], v[96:111]
    ds_read_b64_tr_b16 v[154:155], v50 offset:33792
    ds_read_b64_tr_b16 v[156:157], v51 offset:32768
    ds_read_b64_tr_b16 v[158:159], v51 offset:33792
    s_waitcnt lgkmcnt(9)
    v_mfma_f32_32x32x16_bf16 v[112:127], v[172:175], v[180:183], v[112:127]
    v_mfma_f32_16x16x32_bf16 v[128:131], v[160:163], v[184:187], v[128:131]
    s_waitcnt lgkmcnt(6)
    v_mfma_f32_32x32x16_bf16 v[64:79], v[144:147], v[176:179], v[64:79]
    ds_read_b128 v[180:183], v53 offset:32768
    ds_read_b64_tr_b16 v[160:161], v48 offset:36864
    ds_read_b64_tr_b16 v[162:163], v48 offset:37888
    s_waitcnt lgkmcnt(7)
    v_mfma_f32_32x32x16_bf16 v[80:95], v[148:151], v[176:179], v[80:95]
    ds_read_b64_tr_b16 v[164:165], v49 offset:36864
    ds_read_b64_tr_b16 v[166:167], v49 offset:37888
    ds_read_b64_tr_b16 v[168:169], v50 offset:36864
    s_waitcnt lgkmcnt(8)
    v_mfma_f32_32x32x16_bf16 v[96:111], v[152:155], v[176:179], v[96:111]
    ds_read_b64_tr_b16 v[170:171], v50 offset:37888
    ds_read_b64_tr_b16 v[172:173], v51 offset:36864
    ds_read_b64_tr_b16 v[174:175], v51 offset:37888
    s_waitcnt lgkmcnt(9)
    v_mfma_f32_32x32x16_bf16 v[112:127], v[156:159], v[176:179], v[112:127]
    v_mfma_f32_16x16x32_bf16 v[128:131], v[144:147], v[184:187], v[128:131]
    s_waitcnt lgkmcnt(6)
    v_mfma_f32_32x32x16_bf16 v[64:79], v[160:163], v[180:183], v[64:79]
    ds_read_b128 v[176:179], v54 offset:32768
    ds_read_b64_tr_b16 v[144:145], v48 offset:40960
    ds_read_b64_tr_b16 v[146:147], v48 offset:41984
    s_waitcnt lgkmcnt(7)
    v_mfma_f32_32x32x16_bf16 v[80:95], v[164:167], v[180:183], v[80:95]
    ds_read_b64_tr_b16 v[148:149], v49 offset:40960
    ds_read_b64_tr_b16 v[150:151], v49 offset:41984
    ds_read_b64_tr_b16 v[152:153], v50 offset:40960
    s_waitcnt lgkmcnt(8)
    v_mfma_f32_32x32x16_bf16 v[96:111], v[168:171], v[180:183], v[96:111]
    ds_read_b64_tr_b16 v[154:155], v50 offset:41984
    ds_read_b64_tr_b16 v[156:157], v51 offset:40960
    ds_read_b64_tr_b16 v[158:159], v51 offset:41984
    s_waitcnt lgkmcnt(9)
    v_mfma_f32_32x32x16_bf16 v[112:127], v[172:175], v[180:183], v[112:127]
    s_barrier
    v_mfma_f32_16x16x32_bf16 v[128:131], v[160:163], v[184:187], v[128:131]
    s_waitcnt lgkmcnt(6)
    v_mfma_f32_32x32x16_bf16 v[64:79], v[144:147], v[176:179], v[64:79]
    ds_read_b128 v[180:183], v55 offset:32768
    ds_read_b64_tr_b16 v[160:161], v48 offset:45056
    ds_read_b64_tr_b16 v[162:163], v48 offset:46080
    s_waitcnt lgkmcnt(7)
    v_mfma_f32_32x32x16_bf16 v[80:95], v[148:151], v[176:179], v[80:95]
    ds_read_b64_tr_b16 v[164:165], v49 offset:45056
    ds_read_b64_tr_b16 v[166:167], v49 offset:46080
    ds_read_b64_tr_b16 v[168:169], v50 offset:45056
    s_waitcnt lgkmcnt(8)
    v_mfma_f32_32x32x16_bf16 v[96:111], v[152:155], v[176:179], v[96:111]
    ds_read_b64_tr_b16 v[170:171], v50 offset:46080
    ds_read_b64_tr_b16 v[172:173], v51 offset:45056
    ds_read_b64_tr_b16 v[174:175], v51 offset:46080
    s_waitcnt lgkmcnt(9)
    v_mfma_f32_32x32x16_bf16 v[112:127], v[156:159], v[176:179], v[112:127]
    v_mfma_f32_16x16x32_bf16 v[128:131], v[144:147], v[184:187], v[128:131]
    s_waitcnt lgkmcnt(6)
    v_mfma_f32_32x32x16_bf16 v[64:79], v[160:163], v[180:183], v[64:79]
    ds_read_b128 v[176:179], v12 offset:0
    ds_read_b64_tr_b16 v[144:145], v8 offset:0
    ds_read_b64_tr_b16 v[146:147], v8 offset:1024
    s_waitcnt lgkmcnt(7)
    v_mfma_f32_32x32x16_bf16 v[80:95], v[164:167], v[180:183], v[80:95]
    ds_read_b64_tr_b16 v[148:149], v9 offset:0
    ds_read_b64_tr_b16 v[150:151], v9 offset:1024
    ds_read_b64_tr_b16 v[152:153], v10 offset:0
    s_waitcnt lgkmcnt(8)
    v_mfma_f32_32x32x16_bf16 v[96:111], v[168:171], v[180:183], v[96:111]
    ds_read_b64_tr_b16 v[154:155], v10 offset:1024
    ds_read_b64_tr_b16 v[156:157], v11 offset:0
    ds_read_b64_tr_b16 v[158:159], v11 offset:1024
    s_waitcnt lgkmcnt(9)
    v_mfma_f32_32x32x16_bf16 v[112:127], v[172:175], v[180:183], v[112:127]
    v_mfma_f32_16x16x32_bf16 v[128:131], v[160:163], v[184:187], v[128:131]
    s_waitcnt lgkmcnt(6)
    v_mfma_f32_32x32x16_bf16 v[64:79], v[144:147], v[176:179], v[64:79]
    ds_read_b128 v[180:183], v13 offset:0
    ds_read_b64_tr_b16 v[160:161], v8 offset:4096
    ds_read_b64_tr_b16 v[162:163], v8 offset:5120
    s_waitcnt lgkmcnt(7)
    v_mfma_f32_32x32x16_bf16 v[80:95], v[148:151], v[176:179], v[80:95]
    ds_read_b64_tr_b16 v[164:165], v9 offset:4096
    ds_read_b64_tr_b16 v[166:167], v9 offset:5120
    ds_read_b64_tr_b16 v[168:169], v10 offset:4096
    s_waitcnt lgkmcnt(8)
    v_mfma_f32_32x32x16_bf16 v[96:111], v[152:155], v[176:179], v[96:111]
    ds_read_b64_tr_b16 v[170:171], v10 offset:5120
    ds_read_b64_tr_b16 v[172:173], v11 offset:4096
    ds_read_b64_tr_b16 v[174:175], v11 offset:5120
    s_waitcnt lgkmcnt(9)
    v_mfma_f32_32x32x16_bf16 v[112:127], v[156:159], v[176:179], v[112:127]
    v_mfma_f32_16x16x32_bf16 v[128:131], v[144:147], v[184:187], v[128:131]
    s_waitcnt lgkmcnt(6)
    v_mfma_f32_32x32x16_bf16 v[64:79], v[160:163], v[180:183], v[64:79]
    ds_read_b128 v[176:179], v14 offset:0
    ds_read_b64_tr_b16 v[144:145], v8 offset:8192
    ds_read_b64_tr_b16 v[146:147], v8 offset:9216
    s_waitcnt lgkmcnt(7)
    v_mfma_f32_32x32x16_bf16 v[80:95], v[164:167], v[180:183], v[80:95]
    ds_read_b64_tr_b16 v[148:149], v9 offset:8192
    ds_read_b64_tr_b16 v[150:151], v9 offset:9216
    ds_read_b64_tr_b16 v[152:153], v10 offset:8192
    s_waitcnt lgkmcnt(8)
    v_mfma_f32_32x32x16_bf16 v[96:111], v[168:171], v[180:183], v[96:111]
    ds_read_b64_tr_b16 v[154:155], v10 offset:9216
    ds_read_b64_tr_b16 v[156:157], v11 offset:8192
    ds_read_b64_tr_b16 v[158:159], v11 offset:9216
    s_waitcnt lgkmcnt(9)
    v_mfma_f32_32x32x16_bf16 v[112:127], v[172:175], v[180:183], v[112:127]
    s_barrier
    v_mfma_f32_16x16x32_bf16 v[128:131], v[160:163], v[184:187], v[128:131]
    s_waitcnt lgkmcnt(6)
    v_mfma_f32_32x32x16_bf16 v[64:79], v[144:147], v[176:179], v[64:79]
    ds_read_b128 v[180:183], v15 offset:0
    ds_read_b64_tr_b16 v[160:161], v8 offset:12288
    ds_read_b64_tr_b16 v[162:163], v8 offset:13312
    s_waitcnt lgkmcnt(7)
    v_mfma_f32_32x32x16_bf16 v[80:95], v[148:151], v[176:179], v[80:95]
    ds_read_b64_tr_b16 v[164:165], v9 offset:12288
    ds_read_b64_tr_b16 v[166:167], v9 offset:13312
    ds_read_b64_tr_b16 v[168:169], v10 offset:12288
    s_waitcnt lgkmcnt(8)
    v_mfma_f32_32x32x16_bf16 v[96:111], v[152:155], v[176:179], v[96:111]
    ds_read_b64_tr_b16 v[170:171], v10 offset:13312
    ds_read_b64_tr_b16 v[172:173], v11 offset:12288
    ds_read_b64_tr_b16 v[174:175], v11 offset:13312
    s_waitcnt lgkmcnt(9)
    v_mfma_f32_32x32x16_bf16 v[112:127], v[156:159], v[176:179], v[112:127]
    v_mfma_f32_16x16x32_bf16 v[128:131], v[144:147], v[184:187], v[128:131]
    s_waitcnt lgkmcnt(6)
    v_mfma_f32_32x32x16_bf16 v[64:79], v[160:163], v[180:183], v[64:79]
    ds_read_b128 v[176:179], v12 offset:32768
    ds_read_b64_tr_b16 v[144:145], v8 offset:32768
    ds_read_b64_tr_b16 v[146:147], v8 offset:33792
    s_waitcnt lgkmcnt(7)
    v_mfma_f32_32x32x16_bf16 v[80:95], v[164:167], v[180:183], v[80:95]
    ds_read_b64_tr_b16 v[148:149], v9 offset:32768
    ds_read_b64_tr_b16 v[150:151], v9 offset:33792
    ds_read_b64_tr_b16 v[152:153], v10 offset:32768
    s_waitcnt lgkmcnt(8)
    v_mfma_f32_32x32x16_bf16 v[96:111], v[168:171], v[180:183], v[96:111]
    ds_read_b64_tr_b16 v[154:155], v10 offset:33792
    ds_read_b64_tr_b16 v[156:157], v11 offset:32768
    ds_read_b64_tr_b16 v[158:159], v11 offset:33792
    s_waitcnt lgkmcnt(9)
    v_mfma_f32_32x32x16_bf16 v[112:127], v[172:175], v[180:183], v[112:127]
    ds_read_b64 v[220:221], v218
    v_mfma_f32_16x16x32_bf16 v[128:131], v[160:163], v[184:187], v[128:131]
    s_waitcnt lgkmcnt(6)
    v_mfma_f32_32x32x16_bf16 v[64:79], v[144:147], v[176:179], v[64:79]
    ds_read_b128 v[180:183], v13 offset:32768
    ds_read_b64_tr_b16 v[160:161], v8 offset:36864
    ds_read_b64_tr_b16 v[162:163], v8 offset:37888
    s_waitcnt lgkmcnt(7)
    v_mfma_f32_32x32x16_bf16 v[80:95], v[148:151], v[176:179], v[80:95]
    ds_read_b64_tr_b16 v[164:165], v9 offset:36864
    ds_read_b64_tr_b16 v[166:167], v9 offset:37888
    ds_read_b64_tr_b16 v[168:169], v10 offset:36864
    s_waitcnt lgkmcnt(8)
    v_mfma_f32_32x32x16_bf16 v[96:111], v[152:155], v[176:179], v[96:111]
    ds_read_b64_tr_b16 v[170:171], v10 offset:37888
    ds_read_b64_tr_b16 v[172:173], v11 offset:36864
    ds_read_b64_tr_b16 v[174:175], v11 offset:37888
    s_waitcnt lgkmcnt(9)
    v_mfma_f32_32x32x16_bf16 v[112:127], v[156:159], v[176:179], v[112:127]
    v_mfma_f32_16x16x32_bf16 v[128:131], v[144:147], v[184:187], v[128:131]
    s_waitcnt lgkmcnt(6)
    v_mfma_f32_32x32x16_bf16 v[64:79], v[160:163], v[180:183], v[64:79]
    ds_read_b128 v[176:179], v14 offset:32768
    ds_read_b64_tr_b16 v[144:145], v8 offset:40960
    ds_read_b64_tr_b16 v[146:147], v8 offset:41984
    s_waitcnt lgkmcnt(7)
    v_mfma_f32_32x32x16_bf16 v[80:95], v[164:167], v[180:183], v[80:95]
    ds_read_b64_tr_b16 v[148:149], v9 offset:40960
    ds_read_b64_tr_b16 v[150:151], v9 offset:41984
    ds_read_b64_tr_b16 v[152:153], v10 offset:40960
    s_waitcnt lgkmcnt(8)
    v_mfma_f32_32x32x16_bf16 v[96:111], v[168:171], v[180:183], v[96:111]
    ds_read_b64_tr_b16 v[154:155], v10 offset:41984
    ds_read_b64_tr_b16 v[156:157], v11 offset:40960
    ds_read_b64_tr_b16 v[158:159], v11 offset:41984
    s_waitcnt lgkmcnt(9)
    v_mfma_f32_32x32x16_bf16 v[112:127], v[172:175], v[180:183], v[112:127]
    s_mov_b32 exec_hi, 0
    v_sub_f32 v222, 0, v220
    v_cvt_pk_bf16_f32 v208, v222, v222
    v_lshlrev_b32 v223, 16, v208
    v_sub_f32 v223, v222, v223
    v_cvt_pk_bf16_f32 v209, v223, 0
    s_mov_b32 exec_hi, -1
    v_mul_f32 v222, s90, v221
    v_mfma_f32_16x16x32_bf16 v[128:131], v[160:163], v[184:187], v[128:131]
    s_waitcnt lgkmcnt(6)
    v_mfma_f32_32x32x16_bf16 v[64:79], v[144:147], v[176:179], v[64:79]
    ds_read_b128 v[180:183], v15 offset:32768
    ds_read_b64_tr_b16 v[160:161], v8 offset:45056
    ds_read_b64_tr_b16 v[162:163], v8 offset:46080
    s_waitcnt lgkmcnt(7)
    v_mfma_f32_32x32x16_bf16 v[80:95], v[148:151], v[176:179], v[80:95]
    ds_read_b64_tr_b16 v[164:165], v9 offset:45056
    ds_read_b64_tr_b16 v[166:167], v9 offset:46080
    ds_read_b64_tr_b16 v[168:169], v10 offset:45056
    s_waitcnt lgkmcnt(8)
    v_mfma_f32_32x32x16_bf16 v[96:111], v[152:155], v[176:179], v[96:111]
    ds_read_b64_tr_b16 v[170:171], v10 offset:46080
    ds_read_b64_tr_b16 v[172:173], v11 offset:45056
    ds_read_b64_tr_b16 v[174:175], v11 offset:46080
    s_waitcnt lgkmcnt(9)
    v_mfma_f32_32x32x16_bf16 v[112:127], v[156:159], v[176:179], v[112:127]
    v_mfma_f32_16x16x32_bf16 v[128:131], v[144:147], v[184:187], v[128:131]
    s_waitcnt lgkmcnt(6)
    v_mfma_f32_32x32x16_bf16 v[64:79], v[160:163], v[180:183], v[64:79]
    s_waitcnt lgkmcnt(4)
    v_mfma_f32_32x32x16_bf16 v[80:95], v[164:167], v[180:183], v[80:95]
    s_waitcnt lgkmcnt(2)
    v_mfma_f32_32x32x16_bf16 v[96:111], v[168:171], v[180:183], v[96:111]
    s_waitcnt lgkmcnt(0)
    v_mfma_f32_32x32x16_bf16 v[112:127], v[172:175], v[180:183], v[112:127]
    v_mfma_f32_16x16x32_bf16 v[128:131], v[160:163], v[184:187], v[128:131]
    s_mov_b32 exec_lo, 0x00030003
    s_mov_b32 exec_hi, 0x00030003
    s_nop 5
    ds_write_b128 v213, v[128:131]
    s_mov_b64 exec, -1
    s_waitcnt lgkmcnt(0)
    s_barrier
    s_cmp_lt_u32 s54, 15
    s_cbranch_scc0 L_M_cs_store
    ds_read_b32 v36, v214
    ds_read_b32 v37, v215
    ds_read_b32 v38, v216
    ds_read_b32 v39, v217
    s_mov_b32 exec_hi, 0
    s_waitcnt lgkmcnt(3)
    v_cvt_pk_bf16_f32 v40, v36, v36
    s_waitcnt lgkmcnt(2)
    v_cvt_pk_bf16_f32 v41, v37, v37
    s_waitcnt lgkmcnt(1)
    v_cvt_pk_bf16_f32 v42, v38, v38
    s_waitcnt lgkmcnt(0)
    v_cvt_pk_bf16_f32 v43, v39, v39
    v_lshlrev_b32 v44, 16, v40
    v_lshlrev_b32 v45, 16, v41
    v_lshlrev_b32 v46, 16, v42
    v_lshlrev_b32 v47, 16, v43
    v_sub_f32 v44, v36, v44
    v_and_b32 v193, 0xffff, v40
    v_sub_f32 v45, v37, v45
    v_and_b32 v197, 0xffff, v41
    v_sub_f32 v46, v38, v46
    v_and_b32 v201, 0xffff, v42
    v_sub_f32 v47, v39, v47
    v_and_b32 v205, 0xffff, v43
    v_cvt_pk_bf16_f32 v192, v36, v44
    v_cvt_pk_bf16_f32 v196, v37, v45
    v_cvt_pk_bf16_f32 v200, v38, v46
    v_cvt_pk_bf16_f32 v204, v39, v47
    s_mov_b32 exec_hi, -1
    v_mfma_f32_32x32x16_bf16 v[64:79], v[192:195], v[208:211], v[64:79]
    v_mfma_f32_32x32x16_bf16 v[80:95], v[196:199], v[208:211], v[80:95]
    v_mfma_f32_32x32x16_bf16 v[96:111], v[200:203], v[208:211], v[96:111]
    v_mfma_f32_32x32x16_bf16 v[112:127], v[204:207], v[208:211], v[112:127]
    s_nop 8
    v_pk_mul_f32 v[64:65], v[64:65], v[222:223] op_sel_hi:[1,0]
    v_pk_mul_f32 v[66:67], v[66:67], v[222:223] op_sel_hi:[1,0]
    v_pk_mul_f32 v[68:69], v[68:69], v[222:223] op_sel_hi:[1,0]
    v_pk_mul_f32 v[70:71], v[70:71], v[222:223] op_sel_hi:[1,0]
    v_cvt_pk_bf16_f32 v40, v64, v65
    v_cvt_pk_bf16_f32 v41, v66, v67
    v_cvt_pk_bf16_f32 v42, v68, v69
    v_cvt_pk_bf16_f32 v43, v70, v71
    buffer_store_dwordx4 v[40:43], v219, s[28:31], s86 offen offset:0 sc1
    v_pk_mul_f32 v[72:73], v[72:73], v[222:223] op_sel_hi:[1,0]
    v_pk_mul_f32 v[74:75], v[74:75], v[222:223] op_sel_hi:[1,0]
    v_pk_mul_f32 v[76:77], v[76:77], v[222:223] op_sel_hi:[1,0]
    v_pk_mul_f32 v[78:79], v[78:79], v[222:223] op_sel_hi:[1,0]
    v_cvt_pk_bf16_f32 v44, v72, v73
    v_cvt_pk_bf16_f32 v45, v74, v75
    v_cvt_pk_bf16_f32 v46, v76, v77
    v_cvt_pk_bf16_f32 v47, v78, v79
    buffer_store_dwordx4 v[44:47], v219, s[28:31], s86 offen offset:1024 sc1
    v_pk_mul_f32 v[80:81], v[80:81], v[222:223] op_sel_hi:[1,0]
    v_pk_mul_f32 v[82:83], v[82:83], v[222:223] op_sel_hi:[1,0]
    v_pk_mul_f32 v[84:85], v[84:85], v[222:223] op_sel_hi:[1,0]
    v_pk_mul_f32 v[86:87], v[86:87], v[222:223] op_sel_hi:[1,0]
    v_cvt_pk_bf16_f32 v48, v80, v81
    v_cvt_pk_bf16_f32 v49, v82, v83
    v_cvt_pk_bf16_f32 v50, v84, v85
    v_cvt_pk_bf16_f32 v51, v86, v87
    buffer_store_dwordx4 v[48:51], v219, s[28:31], s87 offen offset:0 sc1
    v_pk_mul_f32 v[88:89], v[88:89], v[222:223] op_sel_hi:[1,0]
    v_pk_mul_f32 v[90:91], v[90:91], v[222:223] op_sel_hi:[1,0]
    v_pk_mul_f32 v[92:93], v[92:93], v[222:223] op_sel_hi:[1,0]
    v_pk_mul_f32 v[94:95], v[94:95], v[222:223] op_sel_hi:[1,0]
    v_cvt_pk_bf16_f32 v52, v88, v89
    v_cvt_pk_bf16_f32 v53, v90, v91
    v_cvt_pk_bf16_f32 v54, v92, v93
    v_cvt_pk_bf16_f32 v55, v94, v95
    buffer_store_dwordx4 v[52:55], v219, s[28:31], s87 offen offset:1024 sc1
    v_pk_mul_f32 v[96:97], v[96:97], v[222:223] op_sel_hi:[1,0]
    v_pk_mul_f32 v[98:99], v[98:99], v[222:223] op_sel_hi:[1,0]
    v_pk_mul_f32 v[100:101], v[100:101], v[222:223] op_sel_hi:[1,0]
    v_pk_mul_f32 v[102:103], v[102:103], v[222:223] op_sel_hi:[1,0]
    v_cvt_pk_bf16_f32 v40, v96, v97
    v_cvt_pk_bf16_f32 v41, v98, v99
    v_cvt_pk_bf16_f32 v42, v100, v101
    v_cvt_pk_bf16_f32 v43, v102, v103
    buffer_store_dwordx4 v[40:43], v219, s[28:31], s88 offen offset:0 sc1
    v_pk_mul_f32 v[104:105], v[104:105], v[222:223] op_sel_hi:[1,0]
    v_pk_mul_f32 v[106:107], v[106:107], v[222:223] op_sel_hi:[1,0]
    v_pk_mul_f32 v[108:109], v[108:109], v[222:223] op_sel_hi:[1,0]
    v_pk_mul_f32 v[110:111], v[110:111], v[222:223] op_sel_hi:[1,0]
    v_cvt_pk_bf16_f32 v44, v104, v105
    v_cvt_pk_bf16_f32 v45, v106, v107
    v_cvt_pk_bf16_f32 v46, v108, v109
    v_cvt_pk_bf16_f32 v47, v110, v111
    buffer_store_dwordx4 v[44:47], v219, s[28:31], s88 offen offset:1024 sc1
    v_pk_mul_f32 v[112:113], v[112:113], v[222:223] op_sel_hi:[1,0]
    v_pk_mul_f32 v[114:115], v[114:115], v[222:223] op_sel_hi:[1,0]
    v_pk_mul_f32 v[116:117], v[116:117], v[222:223] op_sel_hi:[1,0]
    v_pk_mul_f32 v[118:119], v[118:119], v[222:223] op_sel_hi:[1,0]
    v_cvt_pk_bf16_f32 v48, v112, v113
    v_cvt_pk_bf16_f32 v49, v114, v115
    v_cvt_pk_bf16_f32 v50, v116, v117
    v_cvt_pk_bf16_f32 v51, v118, v119
    buffer_store_dwordx4 v[48:51], v219, s[28:31], s89 offen offset:0 sc1
    v_pk_mul_f32 v[120:121], v[120:121], v[222:223] op_sel_hi:[1,0]
    v_pk_mul_f32 v[122:123], v[122:123], v[222:223] op_sel_hi:[1,0]
    v_pk_mul_f32 v[124:125], v[124:125], v[222:223] op_sel_hi:[1,0]
    v_pk_mul_f32 v[126:127], v[126:127], v[222:223] op_sel_hi:[1,0]
    v_cvt_pk_bf16_f32 v52, v120, v121
    v_cvt_pk_bf16_f32 v53, v122, v123
    v_cvt_pk_bf16_f32 v54, v124, v125
    v_cvt_pk_bf16_f32 v55, v126, v127
    buffer_store_dwordx4 v[52:55], v219, s[28:31], s89 offen offset:1024 sc1
    s_branch L_M_q_done
L_M_cs_store:
    s_lshl_b32 s57, s56, 9
    s_lshl_b32 s58, s48, 7
    s_add_u32 s57, s57, s58
    s_add_u32 s57, s57, 22282240
    s_mov_b32 exec_lo, 0x00030003
    s_mov_b32 exec_hi, 0x00030003
    buffer_store_dwordx4 v[128:131], v212, s[28:31], s57 offen sc1
    s_mov_b64 exec, -1
L_M_q_done:
    s_waitcnt vmcnt(0)
    s_lshl_b32 s57, s48, 2
    s_add_u32 s57, s57, 161312
    v_mov_b32 v4, s57
    v_mov_b32 v5, 1
    ds_write_b32 v4, v5
    s_barrier
    s_branch L_ATT
L_M_W:
    v_lshrrev_b32 v2, 4, v1
    v_and_b32 v3, 15, v1
    s_lshr_b32 s86, s48, 1
    s_and_b32 s87, s48, 1
    s_lshl_b32 s88, s49, 2
    s_lshr_b32 s89, s50, 3
    s_add_u32 s88, s88, s89
    s_and_b32 s89, s50, 7
    s_lshl_b32 s90, s88, 6
    s_lshl_b32 s57, s86, 5
    s_add_u32 s90, s90, s57
    s_lshl_b32 s57, s87, 4
    s_add_u32 s90, s90, s57
    v_add_u32 v4, s90, v3
    v_mul_u32_u24 v5, 1280, v4
    v_mul_u32_u24 v6, 40, v2
    v_add_u32 v5, v5, v6
    s_mul_i32 s57, s89, 160
    buffer_load_dwordx4 v[20:23], v5, s[8:11], s57 offen
    buffer_load_dwordx4 v[24:27], v5, s[8:11], s57 offen offset:16
    buffer_load_dwordx2 v[28:29], v5, s[8:11], s57 offen offset:32
    v_lshlrev_b32 v8, 4, v1
    s_mul_i32 s57, s87, 5120
    v_add_u32 v8, s57, v8
    v_add_u32 v9, 61440, v8
    v_lshlrev_b32 v10, 4, v1
    v_mov_b32 v84, 0
    v_mov_b32 v85, 0
    v_mov_b32 v86, 0
    v_mov_b32 v87, 0
    v_mov_b32 v88, 0
    v_mov_b32 v89, 0
    v_mov_b32 v90, 0
    v_mov_b32 v91, 0
    v_mov_b32 v92, 0
    v_mov_b32 v93, 0
    v_mov_b32 v94, 0
    v_mov_b32 v95, 0
    v_mov_b32 v96, 0
    v_mov_b32 v97, 0
    v_mov_b32 v98, 0
    v_mov_b32 v99, 0
    v_mov_b32 v100, 0
    v_mov_b32 v101, 0
    v_mov_b32 v102, 0
    v_mov_b32 v103, 0
    s_waitcnt vmcnt(0)
    v_lshlrev_b32 v64, 16, v20
    v_and_b32 v65, 0xffff0000, v20
    v_lshlrev_b32 v66, 16, v21
    v_and_b32 v67, 0xffff0000, v21
    v_lshlrev_b32 v68, 16, v22
    v_and_b32 v69, 0xffff0000, v22
    v_lshlrev_b32 v70, 16, v23
    v_and_b32 v71, 0xffff0000, v23
    v_lshlrev_b32 v72, 16, v24
    v_and_b32 v73, 0xffff0000, v24
    v_lshlrev_b32 v74, 16, v25
    v_and_b32 v75, 0xffff0000, v25
    v_lshlrev_b32 v76, 16, v26
    v_and_b32 v77, 0xffff0000, v26
    v_lshlrev_b32 v78, 16, v27
    v_and_b32 v79, 0xffff0000, v27
    v_lshlrev_b32 v80, 16, v28
    v_and_b32 v81, 0xffff0000, v28
    v_lshlrev_b32 v82, 16, v29
    v_and_b32 v83, 0xffff0000, v29
    s_lshl_b32 s57, s88, 2
    s_lshl_b32 s58, s86, 1
    s_add_u32 s57, s57, s58
    s_add_u32 s58, s57, s87
    s_mul_i32 s58, s58, 20480
    s_lshl_b32 s59, s87, 10
    s_add_u32 s58, s58, s59
    s_add_u32 s58, s58, 8388608
    s_xor_b32 s59, s87, 1
    s_add_u32 s59, s57, s59
    s_mul_i32 s59, s59, 20480
    s_lshl_b32 s60, s87, 10
    s_add_u32 s59, s59, s60
    s_add_u32 s59, s59, 8388608
    ds_read_b128 v[208:211], v8 offset:0
    ds_read_b128 v[212:215], v8 offset:1024
    ds_read_b128 v[216:219], v8 offset:2048
    ds_read_b128 v[220:223], v8 offset:3072
    ds_read_b128 v[224:227], v8 offset:4096
    v_mov_b32 v16, 161376
    s_mov_b32 s93, 0
L_lw_8:
    ds_read_b32 v12, v16
    s_waitcnt lgkmcnt(0)
    v_readfirstlane_b32 s57, v12
    s_add_u32 s93, s93, 1
    s_cmp_gt_u32 s93, 200000
    s_cbranch_scc1 L_lw_8_x
    s_nop 0
    s_cmp_lt_u32 s57, 1
    s_cbranch_scc1 L_lw_8
L_lw_8_x:
    s_lshl_b32 s60, s89, 11
    s_add_u32 s61, s58, 0
    s_add_u32 s62, s59, 0
    buffer_load_dwordx4 v[128:131], v10, s[28:31], s61 offen offset:0 sc1
    buffer_load_dwordx4 v[132:135], v10, s[28:31], s62 offen offset:0 sc1
    buffer_load_dwordx4 v[136:139], v10, s[28:31], s61 offen offset:2048 sc1
    buffer_load_dwordx4 v[140:143], v10, s[28:31], s62 offen offset:2048 sc1
    s_add_u32 s61, s58, 4096
    s_add_u32 s62, s59, 4096
    buffer_load_dwordx4 v[144:147], v10, s[28:31], s61 offen offset:0 sc1
    buffer_load_dwordx4 v[148:151], v10, s[28:31], s62 offen offset:0 sc1
    buffer_load_dwordx4 v[152:155], v10, s[28:31], s61 offen offset:2048 sc1
    buffer_load_dwordx4 v[156:159], v10, s[28:31], s62 offen offset:2048 sc1
    s_add_u32 s61, s58, 8192
    s_add_u32 s62, s59, 8192
    buffer_load_dwordx4 v[160:163], v10, s[28:31], s61 offen offset:0 sc1
    buffer_load_dwordx4 v[164:167], v10, s[28:31], s62 offen offset:0 sc1
    buffer_load_dwordx4 v[168:171], v10, s[28:31], s61 offen offset:2048 sc1
    buffer_load_dwordx4 v[172:175], v10, s[28:31], s62 offen offset:2048 sc1
    s_add_u32 s61, s58, 12288
    s_add_u32 s62, s59, 12288
    buffer_load_dwordx4 v[176:179], v10, s[28:31], s61 offen offset:0 sc1
    buffer_load_dwordx4 v[180:183], v10, s[28:31], s62 offen offset:0 sc1
    buffer_load_dwordx4 v[184:187], v10, s[28:31], s61 offen offset:2048 sc1
    buffer_load_dwordx4 v[188:191], v10, s[28:31], s62 offen offset:2048 sc1
    s_add_u32 s61, s58, 16384
    s_add_u32 s62, s59, 16384
    buffer_load_dwordx4 v[192:195], v10, s[28:31], s61 offen offset:0 sc1
    buffer_load_dwordx4 v[196:199], v10, s[28:31], s62 offen offset:0 sc1
    buffer_load_dwordx4 v[200:203], v10, s[28:31], s61 offen offset:2048 sc1
    buffer_load_dwordx4 v[204:207], v10, s[28:31], s62 offen offset:2048 sc1
    s_waitcnt vmcnt(18)
    s_waitcnt lgkmcnt(3)
    v_mfma_f32_16x16x32_bf16 v[64:67], v[208:211], v[128:131], v[64:67]
    v_mfma_f32_16x16x32_bf16 v[84:87], v[208:211], v[132:135], v[84:87]
    ds_read_b128 v[228:231], v8 offset:10240
    ds_read_b128 v[232:235], v8 offset:11264
    v_mfma_f32_16x16x32_bf16 v[68:71], v[212:215], v[128:131], v[68:71]
    v_mfma_f32_16x16x32_bf16 v[88:91], v[212:215], v[132:135], v[88:91]
    ds_read_b128 v[236:239], v8 offset:12288
    ds_read_b128 v[240:243], v8 offset:13312
    s_waitcnt lgkmcnt(5)
    v_mfma_f32_16x16x32_bf16 v[72:75], v[216:219], v[128:131], v[72:75]
    v_mfma_f32_16x16x32_bf16 v[92:95], v[216:219], v[132:135], v[92:95]
    ds_read_b128 v[244:247], v8 offset:14336
    v_mfma_f32_16x16x32_bf16 v[76:79], v[220:223], v[128:131], v[76:79]
    v_mfma_f32_16x16x32_bf16 v[96:99], v[220:223], v[132:135], v[96:99]
    s_waitcnt lgkmcnt(5)
    v_mfma_f32_16x16x32_bf16 v[80:83], v[224:227], v[128:131], v[80:83]
    v_mfma_f32_16x16x32_bf16 v[100:103], v[224:227], v[132:135], v[100:103]
    s_waitcnt vmcnt(16)
    s_waitcnt lgkmcnt(3)
    v_mfma_f32_16x16x32_bf16 v[64:67], v[228:231], v[136:139], v[64:67]
    v_mfma_f32_16x16x32_bf16 v[84:87], v[228:231], v[140:143], v[84:87]
    ds_read_b128 v[208:211], v8 offset:20480
    ds_read_b128 v[212:215], v8 offset:21504
    v_mfma_f32_16x16x32_bf16 v[68:71], v[232:235], v[136:139], v[68:71]
    v_mfma_f32_16x16x32_bf16 v[88:91], v[232:235], v[140:143], v[88:91]
    ds_read_b128 v[216:219], v8 offset:22528
    ds_read_b128 v[220:223], v8 offset:23552
    s_waitcnt lgkmcnt(5)
    v_mfma_f32_16x16x32_bf16 v[72:75], v[236:239], v[136:139], v[72:75]
    v_mfma_f32_16x16x32_bf16 v[92:95], v[236:239], v[140:143], v[92:95]
    ds_read_b128 v[224:227], v8 offset:24576
    v_mfma_f32_16x16x32_bf16 v[76:79], v[240:243], v[136:139], v[76:79]
    v_mfma_f32_16x16x32_bf16 v[96:99], v[240:243], v[140:143], v[96:99]
    s_waitcnt lgkmcnt(5)
    v_mfma_f32_16x16x32_bf16 v[80:83], v[244:247], v[136:139], v[80:83]
    v_mfma_f32_16x16x32_bf16 v[100:103], v[244:247], v[140:143], v[100:103]
    s_waitcnt vmcnt(14)
    s_waitcnt lgkmcnt(3)
    v_mfma_f32_16x16x32_bf16 v[64:67], v[208:211], v[144:147], v[64:67]
    v_mfma_f32_16x16x32_bf16 v[84:87], v[208:211], v[148:151], v[84:87]
    ds_read_b128 v[228:231], v8 offset:30720
    ds_read_b128 v[232:235], v8 offset:31744
    v_mfma_f32_16x16x32_bf16 v[68:71], v[212:215], v[144:147], v[68:71]
    v_mfma_f32_16x16x32_bf16 v[88:91], v[212:215], v[148:151], v[88:91]
    ds_read_b128 v[236:239], v8 offset:32768
    ds_read_b128 v[240:243], v8 offset:33792
    s_waitcnt lgkmcnt(5)
    v_mfma_f32_16x16x32_bf16 v[72:75], v[216:219], v[144:147], v[72:75]
    v_mfma_f32_16x16x32_bf16 v[92:95], v[216:219], v[148:151], v[92:95]
    ds_read_b128 v[244:247], v8 offset:34816
    v_mfma_f32_16x16x32_bf16 v[76:79], v[220:223], v[144:147], v[76:79]
    v_mfma_f32_16x16x32_bf16 v[96:99], v[220:223], v[148:151], v[96:99]
    s_waitcnt lgkmcnt(5)
    v_mfma_f32_16x16x32_bf16 v[80:83], v[224:227], v[144:147], v[80:83]
    v_mfma_f32_16x16x32_bf16 v[100:103], v[224:227], v[148:151], v[100:103]
    s_waitcnt vmcnt(12)
    s_waitcnt lgkmcnt(3)
    v_mfma_f32_16x16x32_bf16 v[64:67], v[228:231], v[152:155], v[64:67]
    v_mfma_f32_16x16x32_bf16 v[84:87], v[228:231], v[156:159], v[84:87]
    ds_read_b128 v[208:211], v8 offset:40960
    ds_read_b128 v[212:215], v8 offset:41984
    v_mfma_f32_16x16x32_bf16 v[68:71], v[232:235], v[152:155], v[68:71]
    v_mfma_f32_16x16x32_bf16 v[88:91], v[232:235], v[156:159], v[88:91]
    ds_read_b128 v[216:219], v8 offset:43008
    ds_read_b128 v[220:223], v8 offset:44032
    s_waitcnt lgkmcnt(5)
    v_mfma_f32_16x16x32_bf16 v[72:75], v[236:239], v[152:155], v[72:75]
    v_mfma_f32_16x16x32_bf16 v[92:95], v[236:239], v[156:159], v[92:95]
    ds_read_b128 v[224:227], v8 offset:45056
    v_mfma_f32_16x16x32_bf16 v[76:79], v[240:243], v[152:155], v[76:79]
    v_mfma_f32_16x16x32_bf16 v[96:99], v[240:243], v[156:159], v[96:99]
    s_waitcnt lgkmcnt(5)
    v_mfma_f32_16x16x32_bf16 v[80:83], v[244:247], v[152:155], v[80:83]
    v_mfma_f32_16x16x32_bf16 v[100:103], v[244:247], v[156:159], v[100:103]
    s_waitcnt vmcnt(10)
    s_waitcnt lgkmcnt(3)
    v_mfma_f32_16x16x32_bf16 v[64:67], v[208:211], v[160:163], v[64:67]
    v_mfma_f32_16x16x32_bf16 v[84:87], v[208:211], v[164:167], v[84:87]
    ds_read_b128 v[228:231], v8 offset:51200
    ds_read_b128 v[232:235], v8 offset:52224
    v_mfma_f32_16x16x32_bf16 v[68:71], v[212:215], v[160:163], v[68:71]
    v_mfma_f32_16x16x32_bf16 v[88:91], v[212:215], v[164:167], v[88:91]
    ds_read_b128 v[236:239], v8 offset:53248
    ds_read_b128 v[240:243], v8 offset:54272
    s_waitcnt lgkmcnt(5)
    v_mfma_f32_16x16x32_bf16 v[72:75], v[216:219], v[160:163], v[72:75]
    v_mfma_f32_16x16x32_bf16 v[92:95], v[216:219], v[164:167], v[92:95]
    ds_read_b128 v[244:247], v8 offset:55296
    v_mfma_f32_16x16x32_bf16 v[76:79], v[220:223], v[160:163], v[76:79]
    v_mfma_f32_16x16x32_bf16 v[96:99], v[220:223], v[164:167], v[96:99]
    s_waitcnt lgkmcnt(5)
    v_mfma_f32_16x16x32_bf16 v[80:83], v[224:227], v[160:163], v[80:83]
    v_mfma_f32_16x16x32_bf16 v[100:103], v[224:227], v[164:167], v[100:103]
    s_waitcnt vmcnt(8)
    s_waitcnt lgkmcnt(3)
    v_mfma_f32_16x16x32_bf16 v[64:67], v[228:231], v[168:171], v[64:67]
    v_mfma_f32_16x16x32_bf16 v[84:87], v[228:231], v[172:175], v[84:87]
    ds_read_b128 v[208:211], v9 offset:0
    ds_read_b128 v[212:215], v9 offset:1024
    v_mfma_f32_16x16x32_bf16 v[68:71], v[232:235], v[168:171], v[68:71]
    v_mfma_f32_16x16x32_bf16 v[88:91], v[232:235], v[172:175], v[88:91]
    ds_read_b128 v[216:219], v9 offset:2048
    ds_read_b128 v[220:223], v9 offset:3072
    s_waitcnt lgkmcnt(5)
    v_mfma_f32_16x16x32_bf16 v[72:75], v[236:239], v[168:171], v[72:75]
    v_mfma_f32_16x16x32_bf16 v[92:95], v[236:239], v[172:175], v[92:95]
    ds_read_b128 v[224:227], v9 offset:4096
    v_mfma_f32_16x16x32_bf16 v[76:79], v[240:243], v[168:171], v[76:79]
    v_mfma_f32_16x16x32_bf16 v[96:99], v[240:243], v[172:175], v[96:99]
    s_waitcnt lgkmcnt(5)
    v_mfma_f32_16x16x32_bf16 v[80:83], v[244:247], v[168:171], v[80:83]
    v_mfma_f32_16x16x32_bf16 v[100:103], v[244:247], v[172:175], v[100:103]
    s_waitcnt vmcnt(6)
    s_waitcnt lgkmcnt(3)
    v_mfma_f32_16x16x32_bf16 v[64:67], v[208:211], v[176:179], v[64:67]
    v_mfma_f32_16x16x32_bf16 v[84:87], v[208:211], v[180:183], v[84:87]
    ds_read_b128 v[228:231], v9 offset:10240
    ds_read_b128 v[232:235], v9 offset:11264
    v_mfma_f32_16x16x32_bf16 v[68:71], v[212:215], v[176:179], v[68:71]
    v_mfma_f32_16x16x32_bf16 v[88:91], v[212:215], v[180:183], v[88:91]
    ds_read_b128 v[236:239], v9 offset:12288
    ds_read_b128 v[240:243], v9 offset:13312
    s_waitcnt lgkmcnt(5)
    v_mfma_f32_16x16x32_bf16 v[72:75], v[216:219], v[176:179], v[72:75]
    v_mfma_f32_16x16x32_bf16 v[92:95], v[216:219], v[180:183], v[92:95]
    ds_read_b128 v[244:247], v9 offset:14336
    v_mfma_f32_16x16x32_bf16 v[76:79], v[220:223], v[176:179], v[76:79]
    v_mfma_f32_16x16x32_bf16 v[96:99], v[220:223], v[180:183], v[96:99]
    s_waitcnt lgkmcnt(5)
    v_mfma_f32_16x16x32_bf16 v[80:83], v[224:227], v[176:179], v[80:83]
    v_mfma_f32_16x16x32_bf16 v[100:103], v[224:227], v[180:183], v[100:103]
    s_waitcnt vmcnt(4)
    s_waitcnt lgkmcnt(3)
    v_mfma_f32_16x16x32_bf16 v[64:67], v[228:231], v[184:187], v[64:67]
    v_mfma_f32_16x16x32_bf16 v[84:87], v[228:231], v[188:191], v[84:87]
    ds_read_b128 v[208:211], v9 offset:20480
    ds_read_b128 v[212:215], v9 offset:21504
    v_mfma_f32_16x16x32_bf16 v[68:71], v[232:235], v[184:187], v[68:71]
    v_mfma_f32_16x16x32_bf16 v[88:91], v[232:235], v[188:191], v[88:91]
    ds_read_b128 v[216:219], v9 offset:22528
    ds_read_b128 v[220:223], v9 offset:23552
    s_waitcnt lgkmcnt(5)
    v_mfma_f32_16x16x32_bf16 v[72:75], v[236:239], v[184:187], v[72:75]
    v_mfma_f32_16x16x32_bf16 v[92:95], v[236:239], v[188:191], v[92:95]
    ds_read_b128 v[224:227], v9 offset:24576
    v_mfma_f32_16x16x32_bf16 v[76:79], v[240:243], v[184:187], v[76:79]
    v_mfma_f32_16x16x32_bf16 v[96:99], v[240:243], v[188:191], v[96:99]
    s_waitcnt lgkmcnt(5)
    v_mfma_f32_16x16x32_bf16 v[80:83], v[244:247], v[184:187], v[80:83]
    v_mfma_f32_16x16x32_bf16 v[100:103], v[244:247], v[188:191], v[100:103]
    s_waitcnt vmcnt(2)
    s_waitcnt lgkmcnt(3)
    v_mfma_f32_16x16x32_bf16 v[64:67], v[208:211], v[192:195], v[64:67]
    v_mfma_f32_16x16x32_bf16 v[84:87], v[208:211], v[196:199], v[84:87]
    ds_read_b128 v[228:231], v9 offset:30720
    ds_read_b128 v[232:235], v9 offset:31744
    v_mfma_f32_16x16x32_bf16 v[68:71], v[212:215], v[192:195], v[68:71]
    v_mfma_f32_16x16x32_bf16 v[88:91], v[212:215], v[196:199], v[88:91]
    ds_read_b128 v[236:239], v9 offset:32768
    ds_read_b128 v[240:243], v9 offset:33792
    s_waitcnt lgkmcnt(5)
    v_mfma_f32_16x16x32_bf16 v[72:75], v[216:219], v[192:195], v[72:75]
    v_mfma_f32_16x16x32_bf16 v[92:95], v[216:219], v[196:199], v[92:95]
    ds_read_b128 v[244:247], v9 offset:34816
    v_mfma_f32_16x16x32_bf16 v[76:79], v[220:223], v[192:195], v[76:79]
    v_mfma_f32_16x16x32_bf16 v[96:99], v[220:223], v[196:199], v[96:99]
    s_waitcnt lgkmcnt(5)
    v_mfma_f32_16x16x32_bf16 v[80:83], v[224:227], v[192:195], v[80:83]
    v_mfma_f32_16x16x32_bf16 v[100:103], v[224:227], v[196:199], v[100:103]
    s_waitcnt vmcnt(0)
    s_waitcnt lgkmcnt(3)
    v_mfma_f32_16x16x32_bf16 v[64:67], v[228:231], v[200:203], v[64:67]
    v_mfma_f32_16x16x32_bf16 v[84:87], v[228:231], v[204:207], v[84:87]
    v_mfma_f32_16x16x32_bf16 v[68:71], v[232:235], v[200:203], v[68:71]
    v_mfma_f32_16x16x32_bf16 v[88:91], v[232:235], v[204:207], v[88:91]
    s_waitcnt lgkmcnt(1)
    v_mfma_f32_16x16x32_bf16 v[72:75], v[236:239], v[200:203], v[72:75]
    v_mfma_f32_16x16x32_bf16 v[92:95], v[236:239], v[204:207], v[92:95]
    v_mfma_f32_16x16x32_bf16 v[76:79], v[240:243], v[200:203], v[76:79]
    v_mfma_f32_16x16x32_bf16 v[96:99], v[240:243], v[204:207], v[96:99]
    s_waitcnt lgkmcnt(0)
    v_mfma_f32_16x16x32_bf16 v[80:83], v[244:247], v[200:203], v[80:83]
    v_mfma_f32_16x16x32_bf16 v[100:103], v[244:247], v[204:207], v[100:103]
    s_lshl_b32 s57, s48, 2
    s_add_u32 s57, s57, 161344
    v_mov_b32 v12, s57
    v_mov_b32 v13, 1
    ds_write_b32 v12, v13
    s_mul_i32 s57, s48, 5120
    s_add_u32 s57, s57, 102400
    v_add_u32 v11, s57, v10
    ds_write_b128 v11, v[84:87] offset:0
    ds_write_b128 v11, v[88:91] offset:1024
    ds_write_b128 v11, v[92:95] offset:2048
    ds_write_b128 v11, v[96:99] offset:3072
    ds_write_b128 v11, v[100:103] offset:4096
    s_lshl_b32 s57, s48, 2
    s_add_u32 s57, s57, 161360
    v_mov_b32 v12, s57
    v_mov_b32 v13, 1
    ds_write_b32 v12, v13
    s_xor_b32 s57, s48, 1
    s_lshl_b32 s57, s57, 2
    s_add_u32 s57, s57, 161360
    v_mov_b32 v16, s57
    s_mov_b32 s93, 0
L_lw_9:
    ds_read_b32 v12, v16
    s_waitcnt lgkmcnt(0)
    v_readfirstlane_b32 s57, v12
    s_add_u32 s93, s93, 1
    s_cmp_gt_u32 s93, 200000
    s_cbranch_scc1 L_lw_9_x
    s_nop 0
    s_cmp_lt_u32 s57, 1
    s_cbranch_scc1 L_lw_9
L_lw_9_x:
    s_xor_b32 s57, s48, 1
    s_mul_i32 s57, s57, 5120
    s_add_u32 s57, s57, 102400
    v_add_u32 v11, s57, v10
    ds_read_b128 v[84:87], v11 offset:0
    ds_read_b128 v[88:91], v11 offset:1024
    ds_read_b128 v[92:95], v11 offset:2048
    ds_read_b128 v[96:99], v11 offset:3072
    ds_read_b128 v[100:103], v11 offset:4096
    s_waitcnt lgkmcnt(0)
    s_lshl_b32 s57, s48, 2
    s_add_u32 s57, s57, 161344
    v_mov_b32 v12, s57
    v_mov_b32 v13, 2
    ds_write_b32 v12, v13
    v_add_f32 v64, v64, v84
    v_add_f32 v65, v65, v85
    v_add_f32 v66, v66, v86
    v_add_f32 v67, v67, v87
    v_add_f32 v68, v68, v88
    v_add_f32 v69, v69, v89
    v_add_f32 v70, v70, v90
    v_add_f32 v71, v71, v91
    v_add_f32 v72, v72, v92
    v_add_f32 v73, v73, v93
    v_add_f32 v74, v74, v94
    v_add_f32 v75, v75, v95
    v_add_f32 v76, v76, v96
    v_add_f32 v77, v77, v97
    v_add_f32 v78, v78, v98
    v_add_f32 v79, v79, v99
    v_add_f32 v80, v80, v100
    v_add_f32 v81, v81, v101
    v_add_f32 v82, v82, v102
    v_add_f32 v83, v83, v103
    v_cvt_pk_bf16_f32 v240, v64, v65
    v_cvt_pk_bf16_f32 v241, v66, v67
    v_cvt_pk_bf16_f32 v242, v68, v69
    v_cvt_pk_bf16_f32 v243, v70, v71
    v_cvt_pk_bf16_f32 v244, v72, v73
    v_cvt_pk_bf16_f32 v245, v74, v75
    v_cvt_pk_bf16_f32 v246, v76, v77
    v_cvt_pk_bf16_f32 v247, v78, v79
    v_cvt_pk_bf16_f32 v248, v80, v81
    v_cvt_pk_bf16_f32 v249, v82, v83
    v_mov_b32 v30, v64
    v_mul_f32 v46, v64, v64
    v_mov_b32 v31, v65
    v_mul_f32 v47, v65, v65
    v_mov_b32 v32, v66
    v_mul_f32 v48, v66, v66
    v_mov_b32 v33, v67
    v_mul_f32 v49, v67, v67
    v_add_f32 v30, v30, v68
    v_fmac_f32 v46, v68, v68
    v_add_f32 v31, v31, v69
    v_fmac_f32 v47, v69, v69
    v_add_f32 v32, v32, v70
    v_fmac_f32 v48, v70, v70
    v_add_f32 v33, v33, v71
    v_fmac_f32 v49, v71, v71
    v_add_f32 v30, v30, v72
    v_fmac_f32 v46, v72, v72
    v_add_f32 v31, v31, v73
    v_fmac_f32 v47, v73, v73
    v_add_f32 v32, v32, v74
    v_fmac_f32 v48, v74, v74
    v_add_f32 v33, v33, v75
    v_fmac_f32 v49, v75, v75
    v_add_f32 v30, v30, v76
    v_fmac_f32 v46, v76, v76
    v_add_f32 v31, v31, v77
    v_fmac_f32 v47, v77, v77
    v_add_f32 v32, v32, v78
    v_fmac_f32 v48, v78, v78
    v_add_f32 v33, v33, v79
    v_fmac_f32 v49, v79, v79
    v_add_f32 v30, v30, v80
    v_fmac_f32 v46, v80, v80
    v_add_f32 v31, v31, v81
    v_fmac_f32 v47, v81, v81
    v_add_f32 v32, v32, v82
    v_fmac_f32 v48, v82, v82
    v_add_f32 v33, v33, v83
    v_fmac_f32 v49, v83, v83
    v_add_f32 v30, v30, v31
    v_add_f32 v32, v32, v33
    v_add_f32 v46, v46, v47
    v_add_f32 v48, v48, v49
    v_add_f32 v30, v30, v32
    v_add_f32 v31, v46, v48
    v_and_b32 v6, 1, v2
    v_cmp_eq_u32 vcc, 1, v6
    s_nop 1
    v_cndmask_b32 v36, v240, v242, vcc
    v_cndmask_b32 v40, v244, v246, vcc
    v_cndmask_b32 v37, v241, v243, vcc
    v_cndmask_b32 v41, v245, v247, vcc
    v_cndmask_b32 v38, v242, v244, vcc
    v_cndmask_b32 v42, v246, v248, vcc
    v_cndmask_b32 v39, v243, v245, vcc
    v_cndmask_b32 v43, v247, v249, vcc
    v_cndmask_b32 v44, v248, v240, vcc
    v_cndmask_b32 v45, v249, v241, vcc
    v_mul_u32_u24 v7, 5, v2
    v_lshrrev_b32 v7, 1, v7
    v_lshlrev_b32 v7, 9, v7
    s_lshl_b32 s57, s87, 4
    v_add_u32 v11, s57, v3
    v_lshl_add_u32 v7, v11, 4, v7
    v_lshl_add_u32 v12, v6, 9, v7
    v_mov_b32 v13, 1024
    v_mov_b32 v14, 8
    v_cndmask_b32 v13, v13, v14, vcc
    v_add_u32 v13, v13, v7
    s_lshl_b32 s57, s88, 1
    s_add_u32 s57, s57, s86
    s_mul_i32 s57, s57, 40960
    s_mul_i32 s58, s89, 5120
    s_add_u32 s57, s57, s58
    s_add_u32 s57, s57, 11534336
    buffer_store_dwordx4 v[36:39], v12, s[28:31], s57 offen sc1
    buffer_store_dwordx4 v[40:43], v12, s[28:31], s57 offen offset:512 sc1
    buffer_store_dwordx2 v[44:45], v13, s[28:31], s57 offen sc1
    v_mov_b32 v32, v30
    s_nop 1
    v_permlane16_swap_b32 v30, v32
    v_add_f32 v30, v30, v32
    v_mov_b32 v32, v30
    s_nop 1
    v_permlane32_swap_b32 v30, v32
    v_add_f32 v30, v30, v32
    v_mov_b32 v32, v31
    s_nop 1
    v_permlane16_swap_b32 v31, v32
    v_add_f32 v31, v31, v32
    v_mov_b32 v32, v31
    s_nop 1
    v_permlane32_swap_b32 v31, v32
    v_add_f32 v31, v31, v32
    v_lshlrev_b32 v11, 3, v4
    s_lshl_b32 s57, s89, 14
    s_add_u32 s57, s57, 22085632
    s_mov_b32 exec_lo, 0xffff
    s_mov_b32 exec_hi, 0
    buffer_store_dwordx2 v[30:31], v11, s[28:31], s57 offen sc1
    s_mov_b64 exec, -1
    s_waitcnt vmcnt(0)
    s_lshl_b32 s57, s48, 2
    s_add_u32 s57, s57, 161312
    v_mov_b32 v4, s57
    v_mov_b32 v5, 2
    ds_write_b32 v4, v5
    s_and_b32 s91, s50, 15
    s_cmp_ge_u32 s91, 14
    s_cbranch_scc1 L_M_F_skip
    v_lshrrev_b32 v2, 5, v1
    v_and_b32 v3, 31, v1
    s_lshl_b32 s57, s49, 1
    s_lshr_b32 s58, s50, 4
    s_add_u32 s57, s57, s58
    s_lshl_b32 s57, s57, 2
    s_add_u32 s92, s57, s48
    v_bfe_u32 v30, v1, 2, 2
    v_and_b32 v31, 3, v1
    v_bfe_u32 v32, v1, 4, 1
    v_lshrrev_b32 v33, 5, v1
    v_lshl_add_u32 v34, v33, 3, v30
    v_lshlrev_b32 v34, 8, v34
    v_lshrrev_b32 v35, 1, v31
    v_lshl_add_u32 v34, v35, 3, v34
    v_and_b32 v35, 1, v31
    v_lshl_add_u32 v35, v32, 1, v35
    v_lshl_add_u32 v35, v30, 2, v35
    v_add_u32 v36, 0, v35
    v_and_b32 v36, 15, v36
    v_lshl_add_u32 v12, v36, 4, v34
    v_add_u32 v8, 122880, v12
    v_add_u32 v16, 65536, v12
    v_add_u32 v36, 4, v35
    v_and_b32 v36, 15, v36
    v_lshl_add_u32 v13, v36, 4, v34
    v_add_u32 v9, 122880, v13
    v_add_u32 v17, 65536, v13
    v_add_u32 v36, 8, v35
    v_and_b32 v36, 15, v36
    v_lshl_add_u32 v14, v36, 4, v34
    v_add_u32 v10, 122880, v14
    v_add_u32 v18, 65536, v14
    v_add_u32 v36, 12, v35
    v_and_b32 v36, 15, v36
    v_lshl_add_u32 v15, v36, 4, v34
    v_add_u32 v11, 122880, v15
    v_add_u32 v19, 65536, v15
    v_mov_b32 v64, 0
    v_mov_b32 v65, 0
    v_mov_b32 v66, 0
    v_mov_b32 v67, 0
    v_mov_b32 v68, 0
    v_mov_b32 v69, 0
    v_mov_b32 v70, 0
    v_mov_b32 v71, 0
    v_mov_b32 v72, 0
    v_mov_b32 v73, 0
    v_mov_b32 v74, 0
    v_mov_b32 v75, 0
    v_mov_b32 v76, 0
    v_mov_b32 v77, 0
    v_mov_b32 v78, 0
    v_mov_b32 v79, 0
    v_mov_b32 v80, 0
    v_mov_b32 v81, 0
    v_mov_b32 v82, 0
    v_mov_b32 v83, 0
    v_mov_b32 v84, 0
    v_mov_b32 v85, 0
    v_mov_b32 v86, 0
    v_mov_b32 v87, 0
    v_mov_b32 v88, 0
    v_mov_b32 v89, 0
    v_mov_b32 v90, 0
    v_mov_b32 v91, 0
    v_mov_b32 v92, 0
    v_mov_b32 v93, 0
    v_mov_b32 v94, 0
    v_mov_b32 v95, 0
    v_mov_b32 v96, 0
    v_mov_b32 v97, 0
    v_mov_b32 v98, 0
    v_mov_b32 v99, 0
    v_mov_b32 v100, 0
    v_mov_b32 v101, 0
    v_mov_b32 v102, 0
    v_mov_b32 v103, 0
    v_mov_b32 v104, 0
    v_mov_b32 v105, 0
    v_mov_b32 v106, 0
    v_mov_b32 v107, 0
    v_mov_b32 v108, 0
    v_mov_b32 v109, 0
    v_mov_b32 v110, 0
    v_mov_b32 v111, 0
    v_mov_b32 v112, 0
    v_mov_b32 v113, 0
    v_mov_b32 v114, 0
    v_mov_b32 v115, 0
    v_mov_b32 v116, 0
    v_mov_b32 v117, 0
    v_mov_b32 v118, 0
    v_mov_b32 v119, 0
    v_mov_b32 v120, 0
    v_mov_b32 v121, 0
    v_mov_b32 v122, 0
    v_mov_b32 v123, 0
    v_mov_b32 v124, 0
    v_mov_b32 v125, 0
    v_mov_b32 v126, 0
    v_mov_b32 v127, 0
    v_lshlrev_b32 v20, 4, v1
    s_mul_i32 s58, s92, 40960
    s_add_u32 s58, s58, 11534336
    v_and_b32 v21, 0x13, v3
    v_bfe_u32 v22, v3, 2, 1
    v_lshl_or_b32 v21, v22, 3, v21
    v_bfe_u32 v22, v3, 3, 1
    v_lshl_or_b32 v21, v22, 2, v21
    v_lshlrev_b32 v21, 1, v21
    s_lshl_b32 s57, s91, 8
    buffer_load_ushort v24, v21, s[40:43], s57 offen offset:0
    buffer_load_ushort v25, v21, s[40:43], s57 offen offset:64
    buffer_load_ushort v26, v21, s[40:43], s57 offen offset:128
    buffer_load_ushort v27, v21, s[40:43], s57 offen offset:192
    v_lshlrev_b32 v22, 2, v3
    s_lshl_b32 s57, s91, 9
    s_add_u32 s57, s57, 22282240
    buffer_load_dword v28, v22, s[28:31], s57 offen offset:0 sc1
    buffer_load_dword v29, v22, s[28:31], s57 offen offset:128 sc1
    buffer_load_dword v30, v22, s[28:31], s57 offen offset:256 sc1
    buffer_load_dword v31, v22, s[28:31], s57 offen offset:384 sc1
    s_lshl_b32 s57, s92, 5
    v_add_u32 v23, s57, v3
    v_lshlrev_b32 v23, 3, v23
    v_lshl_add_u32 v23, v2, 16, v23
    v_mov_b32 v60, 161328
    s_mov_b32 s93, 0
L_lw_11:
    ds_read_b128 v[56:59], v60
    s_waitcnt lgkmcnt(0)
    v_min_u32 v56, v56, v57
    v_min3_u32 v56, v56, v58, v59
    s_nop 0
    v_readfirstlane_b32 s57, v56
    s_add_u32 s93, s93, 1
    s_cmp_gt_u32 s93, 200000
    s_cbranch_scc1 L_lw_11_x
    s_nop 0
    s_cmp_ge_u32 s57, 1
    s_cbranch_scc1 L_lw_11_x
    s_sleep 1
    s_branch L_lw_11
L_lw_11_x:
    ds_read_b64_tr_b16 v[128:129], v8 offset:0
    ds_read_b64_tr_b16 v[130:131], v8 offset:1024
    ds_read_b64_tr_b16 v[132:133], v9 offset:0
    ds_read_b64_tr_b16 v[134:135], v9 offset:1024
    ds_read_b64_tr_b16 v[136:137], v10 offset:0
    ds_read_b64_tr_b16 v[138:139], v10 offset:1024
    ds_read_b64_tr_b16 v[140:141], v11 offset:0
    ds_read_b64_tr_b16 v[142:143], v11 offset:1024
    v_mov_b32 v60, 161376
    s_mov_b32 s93, 0
L_lw_12:
    ds_read_b32 v56, v60
    s_waitcnt lgkmcnt(0)
    v_readfirstlane_b32 s57, v56
    s_add_u32 s93, s93, 1
    s_cmp_gt_u32 s93, 200000
    s_cbranch_scc1 L_lw_12_x
    s_nop 0
    s_cmp_lt_u32 s57, 2
    s_cbranch_scc1 L_lw_12
L_lw_12_x:
    s_mul_i32 s60, s91, 3072
    s_add_u32 s59, s58, 0
    buffer_load_dwordx4 v[160:163], v20, s[28:31], s59 offen offset:0 sc1
    buffer_load_dwordx4 v[164:167], v20, s[28:31], s59 offen offset:1024 sc1
    buffer_load_dwordx4 v[168:171], v20, s[28:31], s59 offen offset:2048 sc1
    buffer_load_dwordx4 v[172:175], v20, s[28:31], s59 offen offset:3072 sc1
    s_add_u32 s59, s58, 4096
    buffer_load_dwordx4 v[176:179], v20, s[28:31], s59 offen offset:0 sc1
    buffer_load_dwordx4 v[180:183], v20, s[28:31], s59 offen offset:1024 sc1
    v_mov_b32 v61, 161328
    s_waitcnt vmcnt(5)
    s_waitcnt lgkmcnt(6)
    v_mfma_f32_32x32x16_bf16 v[64:79], v[128:131], v[160:163], v[64:79]
    ds_read_b64_tr_b16 v[144:145], v8 offset:4096
    ds_read_b64_tr_b16 v[146:147], v8 offset:5120
    ds_read_b64_tr_b16 v[148:149], v9 offset:4096
    s_waitcnt lgkmcnt(7)
    v_mfma_f32_32x32x16_bf16 v[80:95], v[132:135], v[160:163], v[80:95]
    ds_read_b64_tr_b16 v[150:151], v9 offset:5120
    ds_read_b64_tr_b16 v[152:153], v10 offset:4096
    ds_read_b64_tr_b16 v[154:155], v10 offset:5120
    s_waitcnt lgkmcnt(8)
    v_mfma_f32_32x32x16_bf16 v[96:111], v[136:139], v[160:163], v[96:111]
    ds_read_b64_tr_b16 v[156:157], v11 offset:4096
    ds_read_b64_tr_b16 v[158:159], v11 offset:5120
    s_waitcnt lgkmcnt(8)
    v_mfma_f32_32x32x16_bf16 v[112:127], v[140:143], v[160:163], v[112:127]
    buffer_load_dwordx4 v[184:187], v20, s[28:31], s59 offen offset:2048 sc1
    buffer_load_dwordx4 v[188:191], v20, s[28:31], s59 offen offset:3072 sc1
    s_waitcnt vmcnt(6)
    s_waitcnt lgkmcnt(6)
    v_mfma_f32_32x32x16_bf16 v[64:79], v[144:147], v[164:167], v[64:79]
    ds_read_b64_tr_b16 v[128:129], v8 offset:8192
    ds_read_b64_tr_b16 v[130:131], v8 offset:9216
    ds_read_b64_tr_b16 v[132:133], v9 offset:8192
    s_waitcnt lgkmcnt(7)
    v_mfma_f32_32x32x16_bf16 v[80:95], v[148:151], v[164:167], v[80:95]
    ds_read_b64_tr_b16 v[134:135], v9 offset:9216
    ds_read_b64_tr_b16 v[136:137], v10 offset:8192
    ds_read_b64_tr_b16 v[138:139], v10 offset:9216
    s_waitcnt lgkmcnt(8)
    v_mfma_f32_32x32x16_bf16 v[96:111], v[152:155], v[164:167], v[96:111]
    ds_read_b64_tr_b16 v[140:141], v11 offset:8192
    ds_read_b64_tr_b16 v[142:143], v11 offset:9216
    s_waitcnt lgkmcnt(8)
    v_mfma_f32_32x32x16_bf16 v[112:127], v[156:159], v[164:167], v[112:127]
    s_add_u32 s59, s58, 8192
    buffer_load_dwordx4 v[192:195], v20, s[28:31], s59 offen offset:0 sc1
    buffer_load_dwordx4 v[196:199], v20, s[28:31], s59 offen offset:1024 sc1
    s_lshl_b32 s57, s48, 2
    s_add_u32 s57, s57, 161344
    v_mov_b32 v40, s57
    v_mov_b32 v41, 3
    ds_write_b32 v40, v41
    s_waitcnt vmcnt(7)
    s_waitcnt lgkmcnt(6)
    v_mfma_f32_32x32x16_bf16 v[64:79], v[128:131], v[168:171], v[64:79]
    ds_read_b64_tr_b16 v[144:145], v8 offset:12288
    ds_read_b64_tr_b16 v[146:147], v8 offset:13312
    ds_read_b64_tr_b16 v[148:149], v9 offset:12288
    s_waitcnt lgkmcnt(7)
    v_mfma_f32_32x32x16_bf16 v[80:95], v[132:135], v[168:171], v[80:95]
    ds_read_b64_tr_b16 v[150:151], v9 offset:13312
    ds_read_b64_tr_b16 v[152:153], v10 offset:12288
    ds_read_b64_tr_b16 v[154:155], v10 offset:13312
    s_waitcnt lgkmcnt(8)
    v_mfma_f32_32x32x16_bf16 v[96:111], v[136:139], v[168:171], v[96:111]
    ds_read_b64_tr_b16 v[156:157], v11 offset:12288
    ds_read_b64_tr_b16 v[158:159], v11 offset:13312
    s_waitcnt lgkmcnt(8)
    v_mfma_f32_32x32x16_bf16 v[112:127], v[140:143], v[168:171], v[112:127]
    v_mov_b32 v224, 0
    v_mov_b32 v225, 0
    v_mov_b32 v226, 0
    v_mov_b32 v227, 0
    v_mov_b32 v228, 0
    v_mov_b32 v229, 0
    v_mov_b32 v230, 0
    v_mov_b32 v231, 0
    v_mov_b32 v232, 0
    v_mov_b32 v233, 0
    v_mov_b32 v234, 0
    v_mov_b32 v235, 0
    v_mov_b32 v236, 0
    v_mov_b32 v237, 0
    v_mov_b32 v238, 0
    v_mov_b32 v239, 0
    buffer_load_dwordx4 v[200:203], v20, s[28:31], s59 offen offset:2048 sc1
    buffer_load_dwordx4 v[204:207], v20, s[28:31], s59 offen offset:3072 sc1
    s_waitcnt vmcnt(8)
    s_waitcnt lgkmcnt(6)
    v_mfma_f32_32x32x16_bf16 v[64:79], v[144:147], v[172:175], v[64:79]
    ds_read_b64_tr_b16 v[128:129], v8 offset:16384
    ds_read_b64_tr_b16 v[130:131], v8 offset:17408
    ds_read_b64_tr_b16 v[132:133], v9 offset:16384
    s_waitcnt lgkmcnt(7)
    v_mfma_f32_32x32x16_bf16 v[80:95], v[148:151], v[172:175], v[80:95]
    ds_read_b64_tr_b16 v[134:135], v9 offset:17408
    ds_read_b64_tr_b16 v[136:137], v10 offset:16384
    ds_read_b64_tr_b16 v[138:139], v10 offset:17408
    s_waitcnt lgkmcnt(8)
    v_mfma_f32_32x32x16_bf16 v[96:111], v[152:155], v[172:175], v[96:111]
    ds_read_b64_tr_b16 v[140:141], v11 offset:16384
    ds_read_b64_tr_b16 v[142:143], v11 offset:17408
    s_waitcnt lgkmcnt(8)
    v_mfma_f32_32x32x16_bf16 v[112:127], v[156:159], v[172:175], v[112:127]
    s_add_u32 s59, s58, 12288
    buffer_load_dwordx4 v[160:163], v20, s[28:31], s59 offen offset:0 sc1
    buffer_load_dwordx4 v[164:167], v20, s[28:31], s59 offen offset:1024 sc1
    s_waitcnt vmcnt(9)
    s_waitcnt lgkmcnt(6)
    v_mfma_f32_32x32x16_bf16 v[64:79], v[128:131], v[176:179], v[64:79]
    ds_read_b64_tr_b16 v[144:145], v8 offset:20480
    ds_read_b64_tr_b16 v[146:147], v8 offset:21504
    ds_read_b64_tr_b16 v[148:149], v9 offset:20480
    s_waitcnt lgkmcnt(7)
    v_mfma_f32_32x32x16_bf16 v[80:95], v[132:135], v[176:179], v[80:95]
    ds_read_b64_tr_b16 v[150:151], v9 offset:21504
    ds_read_b64_tr_b16 v[152:153], v10 offset:20480
    ds_read_b64_tr_b16 v[154:155], v10 offset:21504
    s_waitcnt lgkmcnt(8)
    v_mfma_f32_32x32x16_bf16 v[96:111], v[136:139], v[176:179], v[96:111]
    ds_read_b64_tr_b16 v[156:157], v11 offset:20480
    ds_read_b64_tr_b16 v[158:159], v11 offset:21504
    s_waitcnt lgkmcnt(8)
    v_mfma_f32_32x32x16_bf16 v[112:127], v[140:143], v[176:179], v[112:127]
    s_mov_b32 exec_hi, 0
    v_cvt_pk_bf16_f32 v40, v28, v28
    v_lshlrev_b32 v41, 16, v40
    v_sub_f32 v41, v28, v41
    v_cvt_pk_bf16_f32 v224, v28, v41
    v_and_b32 v40, 0xffff, v40
    v_lshl_or_b32 v225, v24, 16, v40
    v_mov_b32 v226, v24
    s_mov_b32 exec_hi, -1
    buffer_load_dwordx4 v[168:171], v20, s[28:31], s59 offen offset:2048 sc1
    buffer_load_dwordx4 v[172:175], v20, s[28:31], s59 offen offset:3072 sc1
    s_waitcnt vmcnt(10)
    s_waitcnt lgkmcnt(6)
    v_mfma_f32_32x32x16_bf16 v[64:79], v[144:147], v[180:183], v[64:79]
    ds_read_b64_tr_b16 v[128:129], v8 offset:24576
    ds_read_b64_tr_b16 v[130:131], v8 offset:25600
    ds_read_b64_tr_b16 v[132:133], v9 offset:24576
    s_waitcnt lgkmcnt(7)
    v_mfma_f32_32x32x16_bf16 v[80:95], v[148:151], v[180:183], v[80:95]
    ds_read_b64_tr_b16 v[134:135], v9 offset:25600
    ds_read_b64_tr_b16 v[136:137], v10 offset:24576
    ds_read_b64_tr_b16 v[138:139], v10 offset:25600
    s_waitcnt lgkmcnt(8)
    v_mfma_f32_32x32x16_bf16 v[96:111], v[152:155], v[180:183], v[96:111]
    ds_read_b64_tr_b16 v[140:141], v11 offset:24576
    ds_read_b64_tr_b16 v[142:143], v11 offset:25600
    s_waitcnt lgkmcnt(8)
    v_mfma_f32_32x32x16_bf16 v[112:127], v[156:159], v[180:183], v[112:127]
    s_mov_b32 exec_hi, 0
    v_cvt_pk_bf16_f32 v40, v29, v29
    v_lshlrev_b32 v41, 16, v40
    v_sub_f32 v41, v29, v41
    v_cvt_pk_bf16_f32 v228, v29, v41
    v_and_b32 v40, 0xffff, v40
    v_lshl_or_b32 v229, v25, 16, v40
    v_mov_b32 v230, v25
    s_mov_b32 exec_hi, -1
    s_add_u32 s59, s58, 16384
    buffer_load_dwordx4 v[176:179], v20, s[28:31], s59 offen offset:0 sc1
    buffer_load_dwordx4 v[180:183], v20, s[28:31], s59 offen offset:1024 sc1
    s_waitcnt vmcnt(11)
    s_waitcnt lgkmcnt(6)
    v_mfma_f32_32x32x16_bf16 v[64:79], v[128:131], v[184:187], v[64:79]
    ds_read_b64_tr_b16 v[144:145], v8 offset:28672
    ds_read_b64_tr_b16 v[146:147], v8 offset:29696
    ds_read_b64_tr_b16 v[148:149], v9 offset:28672
    s_waitcnt lgkmcnt(7)
    v_mfma_f32_32x32x16_bf16 v[80:95], v[132:135], v[184:187], v[80:95]
    ds_read_b64_tr_b16 v[150:151], v9 offset:29696
    ds_read_b64_tr_b16 v[152:153], v10 offset:28672
    ds_read_b64_tr_b16 v[154:155], v10 offset:29696
    s_waitcnt lgkmcnt(8)
    v_mfma_f32_32x32x16_bf16 v[96:111], v[136:139], v[184:187], v[96:111]
    ds_read_b64_tr_b16 v[156:157], v11 offset:28672
    ds_read_b64_tr_b16 v[158:159], v11 offset:29696
    s_waitcnt lgkmcnt(8)
    v_mfma_f32_32x32x16_bf16 v[112:127], v[140:143], v[184:187], v[112:127]
    s_mov_b32 exec_hi, 0
    v_cvt_pk_bf16_f32 v40, v30, v30
    v_lshlrev_b32 v41, 16, v40
    v_sub_f32 v41, v30, v41
    v_cvt_pk_bf16_f32 v232, v30, v41
    v_and_b32 v40, 0xffff, v40
    v_lshl_or_b32 v233, v26, 16, v40
    v_mov_b32 v234, v26
    s_mov_b32 exec_hi, -1
    buffer_load_dwordx4 v[184:187], v20, s[28:31], s59 offen offset:2048 sc1
    s_waitcnt vmcnt(11)
    s_waitcnt lgkmcnt(6)
    v_mfma_f32_32x32x16_bf16 v[64:79], v[144:147], v[188:191], v[64:79]
    ds_read_b64_tr_b16 v[128:129], v8 offset:32768
    ds_read_b64_tr_b16 v[130:131], v8 offset:33792
    ds_read_b64_tr_b16 v[132:133], v9 offset:32768
    s_waitcnt lgkmcnt(7)
    v_mfma_f32_32x32x16_bf16 v[80:95], v[148:151], v[188:191], v[80:95]
    ds_read_b64_tr_b16 v[134:135], v9 offset:33792
    ds_read_b64_tr_b16 v[136:137], v10 offset:32768
    ds_read_b64_tr_b16 v[138:139], v10 offset:33792
    s_waitcnt lgkmcnt(8)
    v_mfma_f32_32x32x16_bf16 v[96:111], v[152:155], v[188:191], v[96:111]
    ds_read_b64_tr_b16 v[140:141], v11 offset:32768
    ds_read_b64_tr_b16 v[142:143], v11 offset:33792
    s_waitcnt lgkmcnt(8)
    v_mfma_f32_32x32x16_bf16 v[112:127], v[156:159], v[188:191], v[112:127]
    s_mov_b32 exec_hi, 0
    v_cvt_pk_bf16_f32 v40, v31, v31
    v_lshlrev_b32 v41, 16, v40
    v_sub_f32 v41, v31, v41
    v_cvt_pk_bf16_f32 v236, v31, v41
    v_and_b32 v40, 0xffff, v40
    v_lshl_or_b32 v237, v27, 16, v40
    v_mov_b32 v238, v27
    s_mov_b32 exec_hi, -1
    ds_read_b128 v[56:59], v61
    buffer_load_dwordx4 v[188:191], v20, s[28:31], s59 offen offset:3072 sc1
    s_waitcnt vmcnt(11)
    s_waitcnt lgkmcnt(0)
    v_min_u32 v56, v56, v57
    v_min3_u32 v56, v56, v58, v59
    s_nop 0
    v_readfirstlane_b32 s57, v56
    s_nop 3
    s_cmp_ge_u32 s57, 2
    s_cbranch_scc1 L_F_land9
    v_mov_b32 v60, 161328
    s_mov_b32 s93, 0
L_lw_13:
    ds_read_b128 v[56:59], v60
    s_waitcnt lgkmcnt(0)
    v_min_u32 v56, v56, v57
    v_min3_u32 v56, v56, v58, v59
    s_nop 0
    v_readfirstlane_b32 s57, v56
    s_add_u32 s93, s93, 1
    s_cmp_gt_u32 s93, 200000
    s_cbranch_scc1 L_lw_13_x
    s_nop 0
    s_cmp_ge_u32 s57, 2
    s_cbranch_scc1 L_lw_13_x
    s_sleep 1
    s_branch L_lw_13
L_lw_13_x:
L_F_land9:
    v_mfma_f32_32x32x16_bf16 v[64:79], v[128:131], v[192:195], v[64:79]
    ds_read_b64_tr_b16 v[144:145], v12 offset:0
    ds_read_b64_tr_b16 v[146:147], v12 offset:1024
    ds_read_b64_tr_b16 v[148:149], v13 offset:0
    v_mfma_f32_32x32x16_bf16 v[80:95], v[132:135], v[192:195], v[80:95]
    ds_read_b64_tr_b16 v[150:151], v13 offset:1024
    ds_read_b64_tr_b16 v[152:153], v14 offset:0
    ds_read_b64_tr_b16 v[154:155], v14 offset:1024
    v_mfma_f32_32x32x16_bf16 v[96:111], v[136:139], v[192:195], v[96:111]
    ds_read_b64_tr_b16 v[156:157], v15 offset:0
    ds_read_b64_tr_b16 v[158:159], v15 offset:1024
    v_mfma_f32_32x32x16_bf16 v[112:127], v[140:143], v[192:195], v[112:127]
    v_lshrrev_b32 v6, 4, v3
    v_mul_u32_u24 v6, 55296, v6
    v_and_b32 v7, 15, v3
    v_lshl_add_u32 v6, v7, 4, v6
    v_lshl_add_u32 v6, v2, 8, v6
    v_mov_b32 v32, 0
    v_mov_b32 v33, 0
    v_mov_b32 v34, 0
    v_mov_b32 v35, 0
    s_add_u32 s59, s58, 20480
    buffer_load_dwordx4 v[192:195], v20, s[28:31], s59 offen offset:0 sc1
    s_waitcnt vmcnt(11)
    s_waitcnt lgkmcnt(6)
    v_mfma_f32_32x32x16_bf16 v[64:79], v[144:147], v[196:199], v[64:79]
    ds_read_b64_tr_b16 v[128:129], v12 offset:4096
    ds_read_b64_tr_b16 v[130:131], v12 offset:5120
    ds_read_b64_tr_b16 v[132:133], v13 offset:4096
    s_waitcnt lgkmcnt(7)
    v_mfma_f32_32x32x16_bf16 v[80:95], v[148:151], v[196:199], v[80:95]
    ds_read_b64_tr_b16 v[134:135], v13 offset:5120
    ds_read_b64_tr_b16 v[136:137], v14 offset:4096
    ds_read_b64_tr_b16 v[138:139], v14 offset:5120
    s_waitcnt lgkmcnt(8)
    v_mfma_f32_32x32x16_bf16 v[96:111], v[152:155], v[196:199], v[96:111]
    ds_read_b64_tr_b16 v[140:141], v15 offset:4096
    ds_read_b64_tr_b16 v[142:143], v15 offset:5120
    s_waitcnt lgkmcnt(8)
    v_mfma_f32_32x32x16_bf16 v[112:127], v[156:159], v[196:199], v[112:127]
    buffer_load_dwordx4 v[196:199], v20, s[28:31], s59 offen offset:1024 sc1
    s_waitcnt vmcnt(11)
    s_waitcnt lgkmcnt(6)
    v_mfma_f32_32x32x16_bf16 v[64:79], v[128:131], v[200:203], v[64:79]
    ds_read_b64_tr_b16 v[144:145], v12 offset:8192
    ds_read_b64_tr_b16 v[146:147], v12 offset:9216
    ds_read_b64_tr_b16 v[148:149], v13 offset:8192
    s_waitcnt lgkmcnt(7)
    v_mfma_f32_32x32x16_bf16 v[80:95], v[132:135], v[200:203], v[80:95]
    ds_read_b64_tr_b16 v[150:151], v13 offset:9216
    ds_read_b64_tr_b16 v[152:153], v14 offset:8192
    ds_read_b64_tr_b16 v[154:155], v14 offset:9216
    s_waitcnt lgkmcnt(8)
    v_mfma_f32_32x32x16_bf16 v[96:111], v[136:139], v[200:203], v[96:111]
    ds_read_b64_tr_b16 v[156:157], v15 offset:8192
    ds_read_b64_tr_b16 v[158:159], v15 offset:9216
    s_waitcnt lgkmcnt(8)
    v_mfma_f32_32x32x16_bf16 v[112:127], v[140:143], v[200:203], v[112:127]
    buffer_load_dwordx4 v[200:203], v20, s[28:31], s59 offen offset:2048 sc1
    s_waitcnt vmcnt(11)
    s_waitcnt lgkmcnt(6)
    v_mfma_f32_32x32x16_bf16 v[64:79], v[144:147], v[204:207], v[64:79]
    ds_read_b64_tr_b16 v[128:129], v12 offset:12288
    ds_read_b64_tr_b16 v[130:131], v12 offset:13312
    ds_read_b64_tr_b16 v[132:133], v13 offset:12288
    s_waitcnt lgkmcnt(7)
    v_mfma_f32_32x32x16_bf16 v[80:95], v[148:151], v[204:207], v[80:95]
    ds_read_b64_tr_b16 v[134:135], v13 offset:13312
    ds_read_b64_tr_b16 v[136:137], v14 offset:12288
    ds_read_b64_tr_b16 v[138:139], v14 offset:13312
    s_waitcnt lgkmcnt(8)
    v_mfma_f32_32x32x16_bf16 v[96:111], v[152:155], v[204:207], v[96:111]
    ds_read_b64_tr_b16 v[140:141], v15 offset:12288
    ds_read_b64_tr_b16 v[142:143], v15 offset:13312
    s_waitcnt lgkmcnt(8)
    v_mfma_f32_32x32x16_bf16 v[112:127], v[156:159], v[204:207], v[112:127]
    buffer_load_dwordx4 v[204:207], v20, s[28:31], s59 offen offset:3072 sc1
    s_waitcnt vmcnt(11)
    s_waitcnt lgkmcnt(6)
    v_mfma_f32_32x32x16_bf16 v[64:79], v[128:131], v[160:163], v[64:79]
    ds_read_b64_tr_b16 v[144:145], v12 offset:16384
    ds_read_b64_tr_b16 v[146:147], v12 offset:17408
    ds_read_b64_tr_b16 v[148:149], v13 offset:16384
    s_waitcnt lgkmcnt(7)
    v_mfma_f32_32x32x16_bf16 v[80:95], v[132:135], v[160:163], v[80:95]
    ds_read_b64_tr_b16 v[150:151], v13 offset:17408
    ds_read_b64_tr_b16 v[152:153], v14 offset:16384
    ds_read_b64_tr_b16 v[154:155], v14 offset:17408
    s_waitcnt lgkmcnt(8)
    v_mfma_f32_32x32x16_bf16 v[96:111], v[136:139], v[160:163], v[96:111]
    ds_read_b64_tr_b16 v[156:157], v15 offset:16384
    ds_read_b64_tr_b16 v[158:159], v15 offset:17408
    s_waitcnt lgkmcnt(8)
    v_mfma_f32_32x32x16_bf16 v[112:127], v[140:143], v[160:163], v[112:127]
    s_add_u32 s59, s58, 24576
    buffer_load_dwordx4 v[160:163], v20, s[28:31], s59 offen offset:0 sc1
    s_waitcnt vmcnt(11)
    s_waitcnt lgkmcnt(6)
    v_mfma_f32_32x32x16_bf16 v[64:79], v[144:147], v[164:167], v[64:79]
    ds_read_b64_tr_b16 v[128:129], v12 offset:20480
    ds_read_b64_tr_b16 v[130:131], v12 offset:21504
    ds_read_b64_tr_b16 v[132:133], v13 offset:20480
    s_waitcnt lgkmcnt(7)
    v_mfma_f32_32x32x16_bf16 v[80:95], v[148:151], v[164:167], v[80:95]
    ds_read_b64_tr_b16 v[134:135], v13 offset:21504
    ds_read_b64_tr_b16 v[136:137], v14 offset:20480
    ds_read_b64_tr_b16 v[138:139], v14 offset:21504
    s_waitcnt lgkmcnt(8)
    v_mfma_f32_32x32x16_bf16 v[96:111], v[152:155], v[164:167], v[96:111]
    ds_read_b64_tr_b16 v[140:141], v15 offset:20480
    ds_read_b64_tr_b16 v[142:143], v15 offset:21504
    s_waitcnt lgkmcnt(8)
    v_mfma_f32_32x32x16_bf16 v[112:127], v[156:159], v[164:167], v[112:127]
    buffer_load_dwordx4 v[164:167], v20, s[28:31], s59 offen offset:1024 sc1
    s_waitcnt vmcnt(11)
    s_waitcnt lgkmcnt(6)
    v_mfma_f32_32x32x16_bf16 v[64:79], v[128:131], v[168:171], v[64:79]
    ds_read_b64_tr_b16 v[144:145], v12 offset:24576
    ds_read_b64_tr_b16 v[146:147], v12 offset:25600
    ds_read_b64_tr_b16 v[148:149], v13 offset:24576
    s_waitcnt lgkmcnt(7)
    v_mfma_f32_32x32x16_bf16 v[80:95], v[132:135], v[168:171], v[80:95]
    ds_read_b64_tr_b16 v[150:151], v13 offset:25600
    ds_read_b64_tr_b16 v[152:153], v14 offset:24576
    ds_read_b64_tr_b16 v[154:155], v14 offset:25600
    s_waitcnt lgkmcnt(8)
    v_mfma_f32_32x32x16_bf16 v[96:111], v[136:139], v[168:171], v[96:111]
    ds_read_b64_tr_b16 v[156:157], v15 offset:24576
    ds_read_b64_tr_b16 v[158:159], v15 offset:25600
    s_waitcnt lgkmcnt(8)
    v_mfma_f32_32x32x16_bf16 v[112:127], v[140:143], v[168:171], v[112:127]
    buffer_load_dwordx4 v[168:171], v20, s[28:31], s59 offen offset:2048 sc1
    s_waitcnt vmcnt(11)
    s_waitcnt lgkmcnt(6)
    v_mfma_f32_32x32x16_bf16 v[64:79], v[144:147], v[172:175], v[64:79]
    ds_read_b64_tr_b16 v[128:129], v12 offset:28672
    ds_read_b64_tr_b16 v[130:131], v12 offset:29696
    ds_read_b64_tr_b16 v[132:133], v13 offset:28672
    s_waitcnt lgkmcnt(7)
    v_mfma_f32_32x32x16_bf16 v[80:95], v[148:151], v[172:175], v[80:95]
    ds_read_b64_tr_b16 v[134:135], v13 offset:29696
    ds_read_b64_tr_b16 v[136:137], v14 offset:28672
    ds_read_b64_tr_b16 v[138:139], v14 offset:29696
    s_waitcnt lgkmcnt(8)
    v_mfma_f32_32x32x16_bf16 v[96:111], v[152:155], v[172:175], v[96:111]
    ds_read_b64_tr_b16 v[140:141], v15 offset:28672
    ds_read_b64_tr_b16 v[142:143], v15 offset:29696
    s_waitcnt lgkmcnt(8)
    v_mfma_f32_32x32x16_bf16 v[112:127], v[156:159], v[172:175], v[112:127]
    ds_read_b128 v[56:59], v61
    buffer_load_dwordx4 v[172:175], v20, s[28:31], s59 offen offset:3072 sc1
    s_waitcnt vmcnt(11)
    s_waitcnt lgkmcnt(0)
    v_min_u32 v56, v56, v57
    v_min3_u32 v56, v56, v58, v59
    s_nop 0
    v_readfirstlane_b32 s57, v56
    s_nop 3
    s_cmp_ge_u32 s57, 3
    s_cbranch_scc1 L_F_land17
    v_mov_b32 v60, 161328
    s_mov_b32 s93, 0
L_lw_14:
    ds_read_b128 v[56:59], v60
    s_waitcnt lgkmcnt(0)
    v_min_u32 v56, v56, v57
    v_min3_u32 v56, v56, v58, v59
    s_nop 0
    v_readfirstlane_b32 s57, v56
    s_add_u32 s93, s93, 1
    s_cmp_gt_u32 s93, 200000
    s_cbranch_scc1 L_lw_14_x
    s_nop 0
    s_cmp_ge_u32 s57, 3
    s_cbranch_scc1 L_lw_14_x
    s_sleep 1
    s_branch L_lw_14
L_lw_14_x:
L_F_land17:
    v_mfma_f32_32x32x16_bf16 v[64:79], v[128:131], v[176:179], v[64:79]
    ds_read_b64_tr_b16 v[144:145], v12 offset:32768
    ds_read_b64_tr_b16 v[146:147], v12 offset:33792
    ds_read_b64_tr_b16 v[148:149], v13 offset:32768
    v_mfma_f32_32x32x16_bf16 v[80:95], v[132:135], v[176:179], v[80:95]
    ds_read_b64_tr_b16 v[150:151], v13 offset:33792
    ds_read_b64_tr_b16 v[152:153], v14 offset:32768
    ds_read_b64_tr_b16 v[154:155], v14 offset:33792
    v_mfma_f32_32x32x16_bf16 v[96:111], v[136:139], v[176:179], v[96:111]
    ds_read_b64_tr_b16 v[156:157], v15 offset:32768
    ds_read_b64_tr_b16 v[158:159], v15 offset:33792
    v_mfma_f32_32x32x16_bf16 v[112:127], v[140:143], v[176:179], v[112:127]
    s_add_u32 s59, s58, 28672
    buffer_load_dwordx4 v[176:179], v20, s[28:31], s59 offen offset:0 sc1
    s_waitcnt vmcnt(11)
    s_waitcnt lgkmcnt(6)
    v_mfma_f32_32x32x16_bf16 v[64:79], v[144:147], v[180:183], v[64:79]
    ds_read_b64_tr_b16 v[128:129], v12 offset:36864
    ds_read_b64_tr_b16 v[130:131], v12 offset:37888
    ds_read_b64_tr_b16 v[132:133], v13 offset:36864
    s_waitcnt lgkmcnt(7)
    v_mfma_f32_32x32x16_bf16 v[80:95], v[148:151], v[180:183], v[80:95]
    ds_read_b64_tr_b16 v[134:135], v13 offset:37888
    ds_read_b64_tr_b16 v[136:137], v14 offset:36864
    ds_read_b64_tr_b16 v[138:139], v14 offset:37888
    s_waitcnt lgkmcnt(8)
    v_mfma_f32_32x32x16_bf16 v[96:111], v[152:155], v[180:183], v[96:111]
    ds_read_b64_tr_b16 v[140:141], v15 offset:36864
    ds_read_b64_tr_b16 v[142:143], v15 offset:37888
    s_waitcnt lgkmcnt(8)
    v_mfma_f32_32x32x16_bf16 v[112:127], v[156:159], v[180:183], v[112:127]
    buffer_load_dwordx4 v[180:183], v20, s[28:31], s59 offen offset:1024 sc1
    s_lshl_b32 s57, s48, 2
    s_add_u32 s57, s57, 161504
    v_mov_b32 v40, s57
    v_mov_b32 v41, 1
    ds_write_b32 v40, v41
    s_waitcnt vmcnt(11)
    s_waitcnt lgkmcnt(6)
    v_mfma_f32_32x32x16_bf16 v[64:79], v[128:131], v[184:187], v[64:79]
    ds_read_b64_tr_b16 v[144:145], v12 offset:40960
    ds_read_b64_tr_b16 v[146:147], v12 offset:41984
    ds_read_b64_tr_b16 v[148:149], v13 offset:40960
    s_waitcnt lgkmcnt(7)
    v_mfma_f32_32x32x16_bf16 v[80:95], v[132:135], v[184:187], v[80:95]
    ds_read_b64_tr_b16 v[150:151], v13 offset:41984
    ds_read_b64_tr_b16 v[152:153], v14 offset:40960
    ds_read_b64_tr_b16 v[154:155], v14 offset:41984
    s_waitcnt lgkmcnt(8)
    v_mfma_f32_32x32x16_bf16 v[96:111], v[136:139], v[184:187], v[96:111]
    ds_read_b64_tr_b16 v[156:157], v15 offset:40960
    ds_read_b64_tr_b16 v[158:159], v15 offset:41984
    s_waitcnt lgkmcnt(8)
    v_mfma_f32_32x32x16_bf16 v[112:127], v[140:143], v[184:187], v[112:127]
    buffer_load_dwordx4 v[184:187], v20, s[28:31], s59 offen offset:2048 sc1
    s_waitcnt vmcnt(11)
    s_waitcnt lgkmcnt(6)
    v_mfma_f32_32x32x16_bf16 v[64:79], v[144:147], v[188:191], v[64:79]
    ds_read_b64_tr_b16 v[128:129], v12 offset:45056
    ds_read_b64_tr_b16 v[130:131], v12 offset:46080
    ds_read_b64_tr_b16 v[132:133], v13 offset:45056
    s_waitcnt lgkmcnt(7)
    v_mfma_f32_32x32x16_bf16 v[80:95], v[148:151], v[188:191], v[80:95]
    ds_read_b64_tr_b16 v[134:135], v13 offset:46080
    ds_read_b64_tr_b16 v[136:137], v14 offset:45056
    ds_read_b64_tr_b16 v[138:139], v14 offset:46080
    s_waitcnt lgkmcnt(8)
    v_mfma_f32_32x32x16_bf16 v[96:111], v[152:155], v[188:191], v[96:111]
    ds_read_b64_tr_b16 v[140:141], v15 offset:45056
    ds_read_b64_tr_b16 v[142:143], v15 offset:46080
    s_waitcnt lgkmcnt(8)
    v_mfma_f32_32x32x16_bf16 v[112:127], v[156:159], v[188:191], v[112:127]
    buffer_load_dwordx4 v[188:191], v20, s[28:31], s59 offen offset:3072 sc1
    s_waitcnt vmcnt(11)
    s_waitcnt lgkmcnt(6)
    v_mfma_f32_32x32x16_bf16 v[64:79], v[128:131], v[192:195], v[64:79]
    ds_read_b64_tr_b16 v[144:145], v12 offset:49152
    ds_read_b64_tr_b16 v[146:147], v12 offset:50176
    ds_read_b64_tr_b16 v[148:149], v13 offset:49152
    s_waitcnt lgkmcnt(7)
    v_mfma_f32_32x32x16_bf16 v[80:95], v[132:135], v[192:195], v[80:95]
    ds_read_b64_tr_b16 v[150:151], v13 offset:50176
    ds_read_b64_tr_b16 v[152:153], v14 offset:49152
    ds_read_b64_tr_b16 v[154:155], v14 offset:50176
    s_waitcnt lgkmcnt(8)
    v_mfma_f32_32x32x16_bf16 v[96:111], v[136:139], v[192:195], v[96:111]
    ds_read_b64_tr_b16 v[156:157], v15 offset:49152
    ds_read_b64_tr_b16 v[158:159], v15 offset:50176
    s_waitcnt lgkmcnt(8)
    v_mfma_f32_32x32x16_bf16 v[112:127], v[140:143], v[192:195], v[112:127]
    s_add_u32 s59, s58, 32768
    buffer_load_dwordx4 v[192:195], v20, s[28:31], s59 offen offset:0 sc1
    s_waitcnt vmcnt(11)
    s_waitcnt lgkmcnt(6)
    v_mfma_f32_32x32x16_bf16 v[64:79], v[144:147], v[196:199], v[64:79]
    ds_read_b64_tr_b16 v[128:129], v12 offset:53248
    ds_read_b64_tr_b16 v[130:131], v12 offset:54272
    ds_read_b64_tr_b16 v[132:133], v13 offset:53248
    s_waitcnt lgkmcnt(7)
    v_mfma_f32_32x32x16_bf16 v[80:95], v[148:151], v[196:199], v[80:95]
    ds_read_b64_tr_b16 v[134:135], v13 offset:54272
    ds_read_b64_tr_b16 v[136:137], v14 offset:53248
    ds_read_b64_tr_b16 v[138:139], v14 offset:54272
    s_waitcnt lgkmcnt(8)
    v_mfma_f32_32x32x16_bf16 v[96:111], v[152:155], v[196:199], v[96:111]
    ds_read_b64_tr_b16 v[140:141], v15 offset:53248
    ds_read_b64_tr_b16 v[142:143], v15 offset:54272
    s_waitcnt lgkmcnt(8)
    v_mfma_f32_32x32x16_bf16 v[112:127], v[156:159], v[196:199], v[112:127]
    buffer_load_dwordx4 v[196:199], v20, s[28:31], s59 offen offset:1024 sc1
    s_waitcnt vmcnt(11)
    s_waitcnt lgkmcnt(6)
    v_mfma_f32_32x32x16_bf16 v[64:79], v[128:131], v[200:203], v[64:79]
    ds_read_b64_tr_b16 v[144:145], v12 offset:57344
    ds_read_b64_tr_b16 v[146:147], v12 offset:58368
    ds_read_b64_tr_b16 v[148:149], v13 offset:57344
    s_waitcnt lgkmcnt(7)
    v_mfma_f32_32x32x16_bf16 v[80:95], v[132:135], v[200:203], v[80:95]
    ds_read_b64_tr_b16 v[150:151], v13 offset:58368
    ds_read_b64_tr_b16 v[152:153], v14 offset:57344
    ds_read_b64_tr_b16 v[154:155], v14 offset:58368
    s_waitcnt lgkmcnt(8)
    v_mfma_f32_32x32x16_bf16 v[96:111], v[136:139], v[200:203], v[96:111]
    ds_read_b64_tr_b16 v[156:157], v15 offset:57344
    ds_read_b64_tr_b16 v[158:159], v15 offset:58368
    s_waitcnt lgkmcnt(8)
    v_mfma_f32_32x32x16_bf16 v[112:127], v[140:143], v[200:203], v[112:127]
    buffer_load_dwordx4 v[200:203], v20, s[28:31], s59 offen offset:2048 sc1
    s_waitcnt vmcnt(11)
    s_waitcnt lgkmcnt(6)
    v_mfma_f32_32x32x16_bf16 v[64:79], v[144:147], v[204:207], v[64:79]
    ds_read_b64_tr_b16 v[128:129], v12 offset:61440
    ds_read_b64_tr_b16 v[130:131], v12 offset:62464
    ds_read_b64_tr_b16 v[132:133], v13 offset:61440
    s_waitcnt lgkmcnt(7)
    v_mfma_f32_32x32x16_bf16 v[80:95], v[148:151], v[204:207], v[80:95]
    ds_read_b64_tr_b16 v[134:135], v13 offset:62464
    ds_read_b64_tr_b16 v[136:137], v14 offset:61440
    ds_read_b64_tr_b16 v[138:139], v14 offset:62464
    s_waitcnt lgkmcnt(8)
    v_mfma_f32_32x32x16_bf16 v[96:111], v[152:155], v[204:207], v[96:111]
    ds_read_b64_tr_b16 v[140:141], v15 offset:61440
    ds_read_b64_tr_b16 v[142:143], v15 offset:62464
    s_waitcnt lgkmcnt(8)
    v_mfma_f32_32x32x16_bf16 v[112:127], v[156:159], v[204:207], v[112:127]
    ds_read_b128 v[56:59], v61
    buffer_load_dwordx4 v[204:207], v20, s[28:31], s59 offen offset:3072 sc1
    s_waitcnt vmcnt(11)
    s_waitcnt lgkmcnt(0)
    v_min_u32 v56, v56, v57
    v_min3_u32 v56, v56, v58, v59
    s_nop 0
    v_readfirstlane_b32 s57, v56
    s_nop 3
    s_cmp_ge_u32 s57, 4
    s_cbranch_scc1 L_F_land25
    v_mov_b32 v60, 161328
    s_mov_b32 s93, 0
L_lw_15:
    ds_read_b128 v[56:59], v60
    s_waitcnt lgkmcnt(0)
    v_min_u32 v56, v56, v57
    v_min3_u32 v56, v56, v58, v59
    s_nop 0
    v_readfirstlane_b32 s57, v56
    s_add_u32 s93, s93, 1
    s_cmp_gt_u32 s93, 200000
    s_cbranch_scc1 L_lw_15_x
    s_nop 0
    s_cmp_ge_u32 s57, 4
    s_cbranch_scc1 L_lw_15_x
    s_sleep 1
    s_branch L_lw_15
L_lw_15_x:
L_F_land25:
    v_mfma_f32_32x32x16_bf16 v[64:79], v[128:131], v[160:163], v[64:79]
    ds_read_b64_tr_b16 v[144:145], v16 offset:0
    ds_read_b64_tr_b16 v[146:147], v16 offset:1024
    ds_read_b64_tr_b16 v[148:149], v17 offset:0
    v_mfma_f32_32x32x16_bf16 v[80:95], v[132:135], v[160:163], v[80:95]
    ds_read_b64_tr_b16 v[150:151], v17 offset:1024
    ds_read_b64_tr_b16 v[152:153], v18 offset:0
    ds_read_b64_tr_b16 v[154:155], v18 offset:1024
    v_mfma_f32_32x32x16_bf16 v[96:111], v[136:139], v[160:163], v[96:111]
    ds_read_b64_tr_b16 v[156:157], v19 offset:0
    ds_read_b64_tr_b16 v[158:159], v19 offset:1024
    v_mfma_f32_32x32x16_bf16 v[112:127], v[140:143], v[160:163], v[112:127]
    s_add_u32 s59, s58, 36864
    buffer_load_dwordx4 v[160:163], v20, s[28:31], s59 offen offset:0 sc1
    s_lshl_b32 s57, s48, 2
    s_add_u32 s57, s57, 161504
    v_mov_b32 v40, s57
    v_mov_b32 v41, 2
    ds_write_b32 v40, v41
    s_waitcnt vmcnt(11)
    s_waitcnt lgkmcnt(6)
    v_mfma_f32_32x32x16_bf16 v[64:79], v[144:147], v[164:167], v[64:79]
    ds_read_b64_tr_b16 v[128:129], v16 offset:4096
    ds_read_b64_tr_b16 v[130:131], v16 offset:5120
    ds_read_b64_tr_b16 v[132:133], v17 offset:4096
    s_waitcnt lgkmcnt(7)
    v_mfma_f32_32x32x16_bf16 v[80:95], v[148:151], v[164:167], v[80:95]
    ds_read_b64_tr_b16 v[134:135], v17 offset:5120
    ds_read_b64_tr_b16 v[136:137], v18 offset:4096
    ds_read_b64_tr_b16 v[138:139], v18 offset:5120
    s_waitcnt lgkmcnt(8)
    v_mfma_f32_32x32x16_bf16 v[96:111], v[152:155], v[164:167], v[96:111]
    ds_read_b64_tr_b16 v[140:141], v19 offset:4096
    ds_read_b64_tr_b16 v[142:143], v19 offset:5120
    s_waitcnt lgkmcnt(8)
    v_mfma_f32_32x32x16_bf16 v[112:127], v[156:159], v[164:167], v[112:127]
    buffer_load_dwordx4 v[164:167], v20, s[28:31], s59 offen offset:1024 sc1
    s_waitcnt vmcnt(11)
    s_waitcnt lgkmcnt(6)
    v_mfma_f32_32x32x16_bf16 v[64:79], v[128:131], v[168:171], v[64:79]
    ds_read_b64_tr_b16 v[144:145], v16 offset:8192
    ds_read_b64_tr_b16 v[146:147], v16 offset:9216
    ds_read_b64_tr_b16 v[148:149], v17 offset:8192
    s_waitcnt lgkmcnt(7)
    v_mfma_f32_32x32x16_bf16 v[80:95], v[132:135], v[168:171], v[80:95]
    ds_read_b64_tr_b16 v[150:151], v17 offset:9216
    ds_read_b64_tr_b16 v[152:153], v18 offset:8192
    ds_read_b64_tr_b16 v[154:155], v18 offset:9216
    s_waitcnt lgkmcnt(8)
    v_mfma_f32_32x32x16_bf16 v[96:111], v[136:139], v[168:171], v[96:111]
    ds_read_b64_tr_b16 v[156:157], v19 offset:8192
    ds_read_b64_tr_b16 v[158:159], v19 offset:9216
    s_waitcnt lgkmcnt(8)
    v_mfma_f32_32x32x16_bf16 v[112:127], v[140:143], v[168:171], v[112:127]
    buffer_load_dwordx4 v[168:171], v20, s[28:31], s59 offen offset:2048 sc1
    s_waitcnt vmcnt(11)
    s_waitcnt lgkmcnt(6)
    v_mfma_f32_32x32x16_bf16 v[64:79], v[144:147], v[172:175], v[64:79]
    ds_read_b64_tr_b16 v[128:129], v16 offset:12288
    ds_read_b64_tr_b16 v[130:131], v16 offset:13312
    ds_read_b64_tr_b16 v[132:133], v17 offset:12288
    s_waitcnt lgkmcnt(7)
    v_mfma_f32_32x32x16_bf16 v[80:95], v[148:151], v[172:175], v[80:95]
    ds_read_b64_tr_b16 v[134:135], v17 offset:13312
    ds_read_b64_tr_b16 v[136:137], v18 offset:12288
    ds_read_b64_tr_b16 v[138:139], v18 offset:13312
    s_waitcnt lgkmcnt(8)
    v_mfma_f32_32x32x16_bf16 v[96:111], v[152:155], v[172:175], v[96:111]
    ds_read_b64_tr_b16 v[140:141], v19 offset:12288
    ds_read_b64_tr_b16 v[142:143], v19 offset:13312
    s_waitcnt lgkmcnt(8)
    v_mfma_f32_32x32x16_bf16 v[112:127], v[156:159], v[172:175], v[112:127]
    buffer_load_dwordx4 v[172:175], v20, s[28:31], s59 offen offset:3072 sc1
    s_mov_b32 s57, 22085632
    buffer_load_dwordx2 v[44:45], v23, s[28:31], s57 offen sc1
    s_mov_b32 s57, 22102016
    buffer_load_dwordx2 v[46:47], v23, s[28:31], s57 offen sc1
    s_mov_b32 s57, 22118400
    buffer_load_dwordx2 v[48:49], v23, s[28:31], s57 offen sc1
    s_mov_b32 s57, 22134784
    buffer_load_dwordx2 v[50:51], v23, s[28:31], s57 offen sc1
    s_waitcnt vmcnt(15)
    s_waitcnt lgkmcnt(6)
    v_mfma_f32_32x32x16_bf16 v[64:79], v[128:131], v[176:179], v[64:79]
    ds_read_b64_tr_b16 v[144:145], v16 offset:16384
    ds_read_b64_tr_b16 v[146:147], v16 offset:17408
    ds_read_b64_tr_b16 v[148:149], v17 offset:16384
    s_waitcnt lgkmcnt(7)
    v_mfma_f32_32x32x16_bf16 v[80:95], v[132:135], v[176:179], v[80:95]
    ds_read_b64_tr_b16 v[150:151], v17 offset:17408
    ds_read_b64_tr_b16 v[152:153], v18 offset:16384
    ds_read_b64_tr_b16 v[154:155], v18 offset:17408
    s_waitcnt lgkmcnt(8)
    v_mfma_f32_32x32x16_bf16 v[96:111], v[136:139], v[176:179], v[96:111]
    ds_read_b64_tr_b16 v[156:157], v19 offset:16384
    ds_read_b64_tr_b16 v[158:159], v19 offset:17408
    s_waitcnt lgkmcnt(8)
    v_mfma_f32_32x32x16_bf16 v[112:127], v[140:143], v[176:179], v[112:127]
    s_waitcnt vmcnt(14)
    s_waitcnt lgkmcnt(6)
    v_mfma_f32_32x32x16_bf16 v[64:79], v[144:147], v[180:183], v[64:79]
    ds_read_b64_tr_b16 v[128:129], v16 offset:20480
    ds_read_b64_tr_b16 v[130:131], v16 offset:21504
    ds_read_b64_tr_b16 v[132:133], v17 offset:20480
    s_waitcnt lgkmcnt(7)
    v_mfma_f32_32x32x16_bf16 v[80:95], v[148:151], v[180:183], v[80:95]
    ds_read_b64_tr_b16 v[134:135], v17 offset:21504
    ds_read_b64_tr_b16 v[136:137], v18 offset:20480
    ds_read_b64_tr_b16 v[138:139], v18 offset:21504
    s_waitcnt lgkmcnt(8)
    v_mfma_f32_32x32x16_bf16 v[96:111], v[152:155], v[180:183], v[96:111]
    ds_read_b64_tr_b16 v[140:141], v19 offset:20480
    ds_read_b64_tr_b16 v[142:143], v19 offset:21504
    s_waitcnt lgkmcnt(8)
    v_mfma_f32_32x32x16_bf16 v[112:127], v[156:159], v[180:183], v[112:127]
    s_waitcnt vmcnt(13)
    s_waitcnt lgkmcnt(6)
    v_mfma_f32_32x32x16_bf16 v[64:79], v[128:131], v[184:187], v[64:79]
    ds_read_b64_tr_b16 v[144:145], v16 offset:24576
    ds_read_b64_tr_b16 v[146:147], v16 offset:25600
    ds_read_b64_tr_b16 v[148:149], v17 offset:24576
    s_waitcnt lgkmcnt(7)
    v_mfma_f32_32x32x16_bf16 v[80:95], v[132:135], v[184:187], v[80:95]
    ds_read_b64_tr_b16 v[150:151], v17 offset:25600
    ds_read_b64_tr_b16 v[152:153], v18 offset:24576
    ds_read_b64_tr_b16 v[154:155], v18 offset:25600
    s_waitcnt lgkmcnt(8)
    v_mfma_f32_32x32x16_bf16 v[96:111], v[136:139], v[184:187], v[96:111]
    ds_read_b64_tr_b16 v[156:157], v19 offset:24576
    ds_read_b64_tr_b16 v[158:159], v19 offset:25600
    s_waitcnt lgkmcnt(8)
    v_mfma_f32_32x32x16_bf16 v[112:127], v[140:143], v[184:187], v[112:127]
    s_waitcnt vmcnt(12)
    s_waitcnt lgkmcnt(6)
    v_mfma_f32_32x32x16_bf16 v[64:79], v[144:147], v[188:191], v[64:79]
    ds_read_b64_tr_b16 v[128:129], v16 offset:28672
    ds_read_b64_tr_b16 v[130:131], v16 offset:29696
    ds_read_b64_tr_b16 v[132:133], v17 offset:28672
    s_waitcnt lgkmcnt(7)
    v_mfma_f32_32x32x16_bf16 v[80:95], v[148:151], v[188:191], v[80:95]
    ds_read_b64_tr_b16 v[134:135], v17 offset:29696
    ds_read_b64_tr_b16 v[136:137], v18 offset:28672
    ds_read_b64_tr_b16 v[138:139], v18 offset:29696
    s_waitcnt lgkmcnt(8)
    v_mfma_f32_32x32x16_bf16 v[96:111], v[152:155], v[188:191], v[96:111]
    ds_read_b64_tr_b16 v[140:141], v19 offset:28672
    ds_read_b64_tr_b16 v[142:143], v19 offset:29696
    s_waitcnt lgkmcnt(8)
    v_mfma_f32_32x32x16_bf16 v[112:127], v[156:159], v[188:191], v[112:127]
    s_waitcnt vmcnt(11)
    s_waitcnt lgkmcnt(6)
    v_mfma_f32_32x32x16_bf16 v[64:79], v[128:131], v[192:195], v[64:79]
    ds_read_b64_tr_b16 v[144:145], v16 offset:32768
    ds_read_b64_tr_b16 v[146:147], v16 offset:33792
    ds_read_b64_tr_b16 v[148:149], v17 offset:32768
    s_waitcnt lgkmcnt(7)
    v_mfma_f32_32x32x16_bf16 v[80:95], v[132:135], v[192:195], v[80:95]
    ds_read_b64_tr_b16 v[150:151], v17 offset:33792
    ds_read_b64_tr_b16 v[152:153], v18 offset:32768
    ds_read_b64_tr_b16 v[154:155], v18 offset:33792
    s_waitcnt lgkmcnt(8)
    v_mfma_f32_32x32x16_bf16 v[96:111], v[136:139], v[192:195], v[96:111]
    ds_read_b64_tr_b16 v[156:157], v19 offset:32768
    ds_read_b64_tr_b16 v[158:159], v19 offset:33792
    s_waitcnt lgkmcnt(8)
    v_mfma_f32_32x32x16_bf16 v[112:127], v[140:143], v[192:195], v[112:127]
    ds_read_b128 v[56:59], v61
    s_lshl_b32 s57, s48, 2
    s_add_u32 s57, s57, 161504
    v_mov_b32 v40, s57
    v_mov_b32 v41, 3
    ds_write_b32 v40, v41
    s_waitcnt vmcnt(10)
    s_waitcnt lgkmcnt(0)
    v_min_u32 v56, v56, v57
    v_min3_u32 v56, v56, v58, v59
    s_nop 0
    v_readfirstlane_b32 s57, v56
    s_nop 3
    s_cmp_ge_u32 s57, 5
    s_cbranch_scc1 L_F_land34
    v_mov_b32 v60, 161328
    s_mov_b32 s93, 0
L_lw_16:
    ds_read_b128 v[56:59], v60
    s_waitcnt lgkmcnt(0)
    v_min_u32 v56, v56, v57
    v_min3_u32 v56, v56, v58, v59
    s_nop 0
    v_readfirstlane_b32 s57, v56
    s_add_u32 s93, s93, 1
    s_cmp_gt_u32 s93, 200000
    s_cbranch_scc1 L_lw_16_x
    s_nop 0
    s_cmp_ge_u32 s57, 5
    s_cbranch_scc1 L_lw_16_x
    s_sleep 1
    s_branch L_lw_16
L_lw_16_x:
L_F_land34:
    v_mfma_f32_32x32x16_bf16 v[64:79], v[144:147], v[196:199], v[64:79]
    ds_read_b64_tr_b16 v[128:129], v16 offset:36864
    ds_read_b64_tr_b16 v[130:131], v16 offset:37888
    ds_read_b64_tr_b16 v[132:133], v17 offset:36864
    v_mfma_f32_32x32x16_bf16 v[80:95], v[148:151], v[196:199], v[80:95]
    ds_read_b64_tr_b16 v[134:135], v17 offset:37888
    ds_read_b64_tr_b16 v[136:137], v18 offset:36864
    ds_read_b64_tr_b16 v[138:139], v18 offset:37888
    v_mfma_f32_32x32x16_bf16 v[96:111], v[152:155], v[196:199], v[96:111]
    ds_read_b64_tr_b16 v[140:141], v19 offset:36864
    ds_read_b64_tr_b16 v[142:143], v19 offset:37888
    v_mfma_f32_32x32x16_bf16 v[112:127], v[156:159], v[196:199], v[112:127]
    s_waitcnt vmcnt(9)
    s_waitcnt lgkmcnt(6)
    v_mfma_f32_32x32x16_bf16 v[64:79], v[128:131], v[200:203], v[64:79]
    ds_read_b64_tr_b16 v[144:145], v16 offset:40960
    ds_read_b64_tr_b16 v[146:147], v16 offset:41984
    ds_read_b64_tr_b16 v[148:149], v17 offset:40960
    s_waitcnt lgkmcnt(7)
    v_mfma_f32_32x32x16_bf16 v[80:95], v[132:135], v[200:203], v[80:95]
    ds_read_b64_tr_b16 v[150:151], v17 offset:41984
    ds_read_b64_tr_b16 v[152:153], v18 offset:40960
    ds_read_b64_tr_b16 v[154:155], v18 offset:41984
    s_waitcnt lgkmcnt(8)
    v_mfma_f32_32x32x16_bf16 v[96:111], v[136:139], v[200:203], v[96:111]
    ds_read_b64_tr_b16 v[156:157], v19 offset:40960
    ds_read_b64_tr_b16 v[158:159], v19 offset:41984
    s_waitcnt lgkmcnt(8)
    v_mfma_f32_32x32x16_bf16 v[112:127], v[140:143], v[200:203], v[112:127]
    s_waitcnt vmcnt(0)
    v_add_f32 v44, v44, v46
    v_add_f32 v45, v45, v47
    v_add_f32 v48, v48, v50
    v_add_f32 v49, v49, v51
    v_add_f32 v44, v44, v48
    v_add_f32 v45, v45, v49
    s_waitcnt vmcnt(8)
    s_waitcnt lgkmcnt(6)
    v_mfma_f32_32x32x16_bf16 v[64:79], v[144:147], v[204:207], v[64:79]
    ds_read_b64_tr_b16 v[128:129], v16 offset:45056
    ds_read_b64_tr_b16 v[130:131], v16 offset:46080
    ds_read_b64_tr_b16 v[132:133], v17 offset:45056
    s_waitcnt lgkmcnt(7)
    v_mfma_f32_32x32x16_bf16 v[80:95], v[148:151], v[204:207], v[80:95]
    ds_read_b64_tr_b16 v[134:135], v17 offset:46080
    ds_read_b64_tr_b16 v[136:137], v18 offset:45056
    ds_read_b64_tr_b16 v[138:139], v18 offset:46080
    s_waitcnt lgkmcnt(8)
    v_mfma_f32_32x32x16_bf16 v[96:111], v[152:155], v[204:207], v[96:111]
    ds_read_b64_tr_b16 v[140:141], v19 offset:45056
    ds_read_b64_tr_b16 v[142:143], v19 offset:46080
    s_waitcnt lgkmcnt(8)
    v_mfma_f32_32x32x16_bf16 v[112:127], v[156:159], v[204:207], v[112:127]
    v_mov_b32 v46, v44
    v_mov_b32 v47, v45
    s_nop 0
    v_permlane32_swap_b32 v44, v46
    v_permlane32_swap_b32 v45, v47
    v_add_f32 v44, v44, v46
    v_add_f32 v45, v45, v47
    s_waitcnt vmcnt(7)
    s_waitcnt lgkmcnt(6)
    v_mfma_f32_32x32x16_bf16 v[64:79], v[128:131], v[160:163], v[64:79]
    ds_read_b64_tr_b16 v[144:145], v16 offset:49152
    ds_read_b64_tr_b16 v[146:147], v16 offset:50176
    ds_read_b64_tr_b16 v[148:149], v17 offset:49152
    s_waitcnt lgkmcnt(7)
    v_mfma_f32_32x32x16_bf16 v[80:95], v[132:135], v[160:163], v[80:95]
    ds_read_b64_tr_b16 v[150:151], v17 offset:50176
    ds_read_b64_tr_b16 v[152:153], v18 offset:49152
    ds_read_b64_tr_b16 v[154:155], v18 offset:50176
    s_waitcnt lgkmcnt(8)
    v_mfma_f32_32x32x16_bf16 v[96:111], v[136:139], v[160:163], v[96:111]
    ds_read_b64_tr_b16 v[156:157], v19 offset:49152
    ds_read_b64_tr_b16 v[158:159], v19 offset:50176
    s_waitcnt lgkmcnt(8)
    v_mfma_f32_32x32x16_bf16 v[112:127], v[140:143], v[160:163], v[112:127]
    v_mul_f32 v44, 0x3acccccd, v44
    v_mul_f32 v45, 0x3acccccd, v45
    v_fma_f32 v45, -v44, v44, v45
    v_max_f32 v45, 0, v45
    v_add_f32 v45, 0x3727c5ac, v45
    v_rsq_f32 v46, v45
    s_waitcnt vmcnt(6)
    s_waitcnt lgkmcnt(6)
    v_mfma_f32_32x32x16_bf16 v[64:79], v[144:147], v[164:167], v[64:79]
    ds_read_b64_tr_b16 v[128:129], v16 offset:53248
    ds_read_b64_tr_b16 v[130:131], v16 offset:54272
    ds_read_b64_tr_b16 v[132:133], v17 offset:53248
    s_waitcnt lgkmcnt(7)
    v_mfma_f32_32x32x16_bf16 v[80:95], v[148:151], v[164:167], v[80:95]
    ds_read_b64_tr_b16 v[134:135], v17 offset:54272
    ds_read_b64_tr_b16 v[136:137], v18 offset:53248
    ds_read_b64_tr_b16 v[138:139], v18 offset:54272
    s_waitcnt lgkmcnt(8)
    v_mfma_f32_32x32x16_bf16 v[96:111], v[152:155], v[164:167], v[96:111]
    ds_read_b64_tr_b16 v[140:141], v19 offset:53248
    ds_read_b64_tr_b16 v[142:143], v19 offset:54272
    s_waitcnt lgkmcnt(8)
    v_mfma_f32_32x32x16_bf16 v[112:127], v[156:159], v[164:167], v[112:127]
    v_mul_f32 v52, v45, v46
    v_mul_f32 v62, 0xc0135761, v46
    v_mul_f32 v54, v46, v46
    v_mul_f32 v54, v54, v46
    v_mul_f32 v54, 0xbdd2d3e8, v54
    ds_read_b128 v[56:59], v61
    s_waitcnt vmcnt(5)
    s_waitcnt lgkmcnt(0)
    v_min_u32 v56, v56, v57
    v_min3_u32 v56, v56, v58, v59
    s_nop 0
    v_readfirstlane_b32 s57, v56
    s_nop 3
    s_cmp_ge_u32 s57, 6
    s_cbranch_scc1 L_F_land39
    v_mov_b32 v60, 161328
    s_mov_b32 s93, 0
L_lw_17:
    ds_read_b128 v[56:59], v60
    s_waitcnt lgkmcnt(0)
    v_min_u32 v56, v56, v57
    v_min3_u32 v56, v56, v58, v59
    s_nop 0
    v_readfirstlane_b32 s57, v56
    s_add_u32 s93, s93, 1
    s_cmp_gt_u32 s93, 200000
    s_cbranch_scc1 L_lw_17_x
    s_nop 0
    s_cmp_ge_u32 s57, 6
    s_cbranch_scc1 L_lw_17_x
    s_sleep 1
    s_branch L_lw_17
L_lw_17_x:
L_F_land39:
    v_mfma_f32_32x32x16_bf16 v[64:79], v[128:131], v[168:171], v[64:79]
    ds_read_b64_tr_b16 v[144:145], v8 offset:0
    ds_read_b64_tr_b16 v[146:147], v8 offset:1024
    ds_read_b64_tr_b16 v[148:149], v9 offset:0
    v_mfma_f32_32x32x16_bf16 v[80:95], v[132:135], v[168:171], v[80:95]
    ds_read_b64_tr_b16 v[150:151], v9 offset:1024
    ds_read_b64_tr_b16 v[152:153], v10 offset:0
    ds_read_b64_tr_b16 v[154:155], v10 offset:1024
    v_mfma_f32_32x32x16_bf16 v[96:111], v[136:139], v[168:171], v[96:111]
    ds_read_b64_tr_b16 v[156:157], v11 offset:0
    ds_read_b64_tr_b16 v[158:159], v11 offset:1024
    v_mfma_f32_32x32x16_bf16 v[112:127], v[140:143], v[168:171], v[112:127]
    s_mov_b32 exec_hi, 0
    v_sub_f32 v42, 0, v44
    v_cvt_pk_bf16_f32 v32, v42, v42
    v_lshlrev_b32 v43, 16, v32
    v_sub_f32 v43, v42, v43
    v_cvt_pk_bf16_f32 v36, v52, v52
    v_lshlrev_b32 v37, 16, v36
    v_sub_f32 v37, v52, v37
    v_cvt_pk_bf16_f32 v33, v43, v52
    v_cvt_pk_bf16_f32 v34, v37, 0
    s_mov_b32 exec_hi, -1
    s_waitcnt vmcnt(4)
    s_waitcnt lgkmcnt(6)
    v_mfma_f32_32x32x16_bf16 v[64:79], v[144:147], v[172:175], v[64:79]
    s_waitcnt lgkmcnt(4)
    v_mfma_f32_32x32x16_bf16 v[80:95], v[148:151], v[172:175], v[80:95]
    s_waitcnt lgkmcnt(2)
    v_mfma_f32_32x32x16_bf16 v[96:111], v[152:155], v[172:175], v[96:111]
    s_waitcnt lgkmcnt(0)
    v_mfma_f32_32x32x16_bf16 v[112:127], v[156:159], v[172:175], v[112:127]
    s_lshl_b32 s57, s48, 2
    s_add_u32 s57, s57, 161344
    v_mov_b32 v40, s57
    v_mov_b32 v41, 4
    ds_write_b32 v40, v41
    s_mul_i32 s57, s92, 110592
    s_lshl_b32 s58, s91, 12
    s_add_u32 s57, s57, s58
    s_add_u32 s57, s57, 14680064
    v_mfma_f32_32x32x16_bf16 v[64:79], v[224:227], v[32:35], v[64:79]
    v_mfma_f32_32x32x16_bf16 v[80:95], v[228:231], v[32:35], v[80:95]
    v_mfma_f32_32x32x16_bf16 v[96:111], v[232:235], v[32:35], v[96:111]
    v_mfma_f32_32x32x16_bf16 v[112:127], v[236:239], v[32:35], v[112:127]
    s_nop 8
    v_pk_mul_f32 v[32:33], v[64:65], v[64:65]
    v_pk_mul_f32 v[34:35], v[66:67], v[66:67]
    v_pk_mul_f32 v[36:37], v[68:69], v[68:69]
    v_pk_mul_f32 v[38:39], v[70:71], v[70:71]
    v_pk_fma_f32 v[32:33], v[32:33], v[54:55], v[62:63] op_sel_hi:[1,0,0]
    v_pk_fma_f32 v[34:35], v[34:35], v[54:55], v[62:63] op_sel_hi:[1,0,0]
    v_pk_fma_f32 v[36:37], v[36:37], v[54:55], v[62:63] op_sel_hi:[1,0,0]
    v_pk_fma_f32 v[38:39], v[38:39], v[54:55], v[62:63] op_sel_hi:[1,0,0]
    v_pk_mul_f32 v[32:33], v[64:65], v[32:33]
    v_pk_mul_f32 v[34:35], v[66:67], v[34:35]
    v_pk_mul_f32 v[36:37], v[68:69], v[36:37]
    v_pk_mul_f32 v[38:39], v[70:71], v[38:39]
    v_exp_f32 v32, v32
    v_exp_f32 v33, v33
    v_exp_f32 v34, v34
    v_exp_f32 v35, v35
    v_exp_f32 v36, v36
    v_exp_f32 v37, v37
    v_exp_f32 v38, v38
    v_exp_f32 v39, v39
    v_pk_fma_f32 v[32:33], v[32:33], v[52:53], v[52:53] op_sel_hi:[1,0,0]
    v_pk_fma_f32 v[34:35], v[34:35], v[52:53], v[52:53] op_sel_hi:[1,0,0]
    v_pk_fma_f32 v[36:37], v[36:37], v[52:53], v[52:53] op_sel_hi:[1,0,0]
    v_pk_fma_f32 v[38:39], v[38:39], v[52:53], v[52:53] op_sel_hi:[1,0,0]
    v_rcp_f32 v32, v32
    v_rcp_f32 v33, v33
    v_rcp_f32 v34, v34
    v_rcp_f32 v35, v35
    v_rcp_f32 v36, v36
    v_rcp_f32 v37, v37
    v_rcp_f32 v38, v38
    v_rcp_f32 v39, v39
    v_pk_mul_f32 v[32:33], v[64:65], v[32:33]
    v_pk_mul_f32 v[34:35], v[66:67], v[34:35]
    v_pk_mul_f32 v[36:37], v[68:69], v[36:37]
    v_pk_mul_f32 v[38:39], v[70:71], v[38:39]
    v_cvt_pk_bf16_f32 v148, v32, v33
    v_cvt_pk_bf16_f32 v149, v34, v35
    v_cvt_pk_bf16_f32 v150, v36, v37
    v_cvt_pk_bf16_f32 v151, v38, v39
    buffer_store_dwordx4 v[148:151], v6, s[28:31], s57 offen offset:0 sc1
    v_pk_mul_f32 v[40:41], v[72:73], v[72:73]
    v_pk_mul_f32 v[42:43], v[74:75], v[74:75]
    v_pk_mul_f32 v[44:45], v[76:77], v[76:77]
    v_pk_mul_f32 v[46:47], v[78:79], v[78:79]
    v_pk_fma_f32 v[40:41], v[40:41], v[54:55], v[62:63] op_sel_hi:[1,0,0]
    v_pk_fma_f32 v[42:43], v[42:43], v[54:55], v[62:63] op_sel_hi:[1,0,0]
    v_pk_fma_f32 v[44:45], v[44:45], v[54:55], v[62:63] op_sel_hi:[1,0,0]
    v_pk_fma_f32 v[46:47], v[46:47], v[54:55], v[62:63] op_sel_hi:[1,0,0]
    v_pk_mul_f32 v[40:41], v[72:73], v[40:41]
    v_pk_mul_f32 v[42:43], v[74:75], v[42:43]
    v_pk_mul_f32 v[44:45], v[76:77], v[44:45]
    v_pk_mul_f32 v[46:47], v[78:79], v[46:47]
    v_exp_f32 v40, v40
    v_exp_f32 v41, v41
    v_exp_f32 v42, v42
    v_exp_f32 v43, v43
    v_exp_f32 v44, v44
    v_exp_f32 v45, v45
    v_exp_f32 v46, v46
    v_exp_f32 v47, v47
    v_pk_fma_f32 v[40:41], v[40:41], v[52:53], v[52:53] op_sel_hi:[1,0,0]
    v_pk_fma_f32 v[42:43], v[42:43], v[52:53], v[52:53] op_sel_hi:[1,0,0]
    v_pk_fma_f32 v[44:45], v[44:45], v[52:53], v[52:53] op_sel_hi:[1,0,0]
    v_pk_fma_f32 v[46:47], v[46:47], v[52:53], v[52:53] op_sel_hi:[1,0,0]
    v_rcp_f32 v40, v40
    v_rcp_f32 v41, v41
    v_rcp_f32 v42, v42
    v_rcp_f32 v43, v43
    v_rcp_f32 v44, v44
    v_rcp_f32 v45, v45
    v_rcp_f32 v46, v46
    v_rcp_f32 v47, v47
    v_pk_mul_f32 v[40:41], v[72:73], v[40:41]
    v_pk_mul_f32 v[42:43], v[74:75], v[42:43]
    v_pk_mul_f32 v[44:45], v[76:77], v[44:45]
    v_pk_mul_f32 v[46:47], v[78:79], v[46:47]
    v_cvt_pk_bf16_f32 v152, v40, v41
    v_cvt_pk_bf16_f32 v153, v42, v43
    v_cvt_pk_bf16_f32 v154, v44, v45
    v_cvt_pk_bf16_f32 v155, v46, v47
    buffer_store_dwordx4 v[152:155], v6, s[28:31], s57 offen offset:512 sc1
    v_pk_mul_f32 v[32:33], v[80:81], v[80:81]
    v_pk_mul_f32 v[34:35], v[82:83], v[82:83]
    v_pk_mul_f32 v[36:37], v[84:85], v[84:85]
    v_pk_mul_f32 v[38:39], v[86:87], v[86:87]
    v_pk_fma_f32 v[32:33], v[32:33], v[54:55], v[62:63] op_sel_hi:[1,0,0]
    v_pk_fma_f32 v[34:35], v[34:35], v[54:55], v[62:63] op_sel_hi:[1,0,0]
    v_pk_fma_f32 v[36:37], v[36:37], v[54:55], v[62:63] op_sel_hi:[1,0,0]
    v_pk_fma_f32 v[38:39], v[38:39], v[54:55], v[62:63] op_sel_hi:[1,0,0]
    v_pk_mul_f32 v[32:33], v[80:81], v[32:33]
    v_pk_mul_f32 v[34:35], v[82:83], v[34:35]
    v_pk_mul_f32 v[36:37], v[84:85], v[36:37]
    v_pk_mul_f32 v[38:39], v[86:87], v[38:39]
    v_exp_f32 v32, v32
    v_exp_f32 v33, v33
    v_exp_f32 v34, v34
    v_exp_f32 v35, v35
    v_exp_f32 v36, v36
    v_exp_f32 v37, v37
    v_exp_f32 v38, v38
    v_exp_f32 v39, v39
    v_pk_fma_f32 v[32:33], v[32:33], v[52:53], v[52:53] op_sel_hi:[1,0,0]
    v_pk_fma_f32 v[34:35], v[34:35], v[52:53], v[52:53] op_sel_hi:[1,0,0]
    v_pk_fma_f32 v[36:37], v[36:37], v[52:53], v[52:53] op_sel_hi:[1,0,0]
    v_pk_fma_f32 v[38:39], v[38:39], v[52:53], v[52:53] op_sel_hi:[1,0,0]
    v_rcp_f32 v32, v32
    v_rcp_f32 v33, v33
    v_rcp_f32 v34, v34
    v_rcp_f32 v35, v35
    v_rcp_f32 v36, v36
    v_rcp_f32 v37, v37
    v_rcp_f32 v38, v38
    v_rcp_f32 v39, v39
    v_pk_mul_f32 v[32:33], v[80:81], v[32:33]
    v_pk_mul_f32 v[34:35], v[82:83], v[34:35]
    v_pk_mul_f32 v[36:37], v[84:85], v[36:37]
    v_pk_mul_f32 v[38:39], v[86:87], v[38:39]
    v_cvt_pk_bf16_f32 v156, v32, v33
    v_cvt_pk_bf16_f32 v157, v34, v35
    v_cvt_pk_bf16_f32 v158, v36, v37
    v_cvt_pk_bf16_f32 v159, v38, v39
    buffer_store_dwordx4 v[156:159], v6, s[28:31], s57 offen offset:1024 sc1
    v_pk_mul_f32 v[40:41], v[88:89], v[88:89]
    v_pk_mul_f32 v[42:43], v[90:91], v[90:91]
    v_pk_mul_f32 v[44:45], v[92:93], v[92:93]
    v_pk_mul_f32 v[46:47], v[94:95], v[94:95]
    v_pk_fma_f32 v[40:41], v[40:41], v[54:55], v[62:63] op_sel_hi:[1,0,0]
    v_pk_fma_f32 v[42:43], v[42:43], v[54:55], v[62:63] op_sel_hi:[1,0,0]
    v_pk_fma_f32 v[44:45], v[44:45], v[54:55], v[62:63] op_sel_hi:[1,0,0]
    v_pk_fma_f32 v[46:47], v[46:47], v[54:55], v[62:63] op_sel_hi:[1,0,0]
    v_pk_mul_f32 v[40:41], v[88:89], v[40:41]
    v_pk_mul_f32 v[42:43], v[90:91], v[42:43]
    v_pk_mul_f32 v[44:45], v[92:93], v[44:45]
    v_pk_mul_f32 v[46:47], v[94:95], v[46:47]
    v_exp_f32 v40, v40
    v_exp_f32 v41, v41
    v_exp_f32 v42, v42
    v_exp_f32 v43, v43
    v_exp_f32 v44, v44
    v_exp_f32 v45, v45
    v_exp_f32 v46, v46
    v_exp_f32 v47, v47
    v_pk_fma_f32 v[40:41], v[40:41], v[52:53], v[52:53] op_sel_hi:[1,0,0]
    v_pk_fma_f32 v[42:43], v[42:43], v[52:53], v[52:53] op_sel_hi:[1,0,0]
    v_pk_fma_f32 v[44:45], v[44:45], v[52:53], v[52:53] op_sel_hi:[1,0,0]
    v_pk_fma_f32 v[46:47], v[46:47], v[52:53], v[52:53] op_sel_hi:[1,0,0]
    v_rcp_f32 v40, v40
    v_rcp_f32 v41, v41
    v_rcp_f32 v42, v42
    v_rcp_f32 v43, v43
    v_rcp_f32 v44, v44
    v_rcp_f32 v45, v45
    v_rcp_f32 v46, v46
    v_rcp_f32 v47, v47
    v_pk_mul_f32 v[40:41], v[88:89], v[40:41]
    v_pk_mul_f32 v[42:43], v[90:91], v[42:43]
    v_pk_mul_f32 v[44:45], v[92:93], v[44:45]
    v_pk_mul_f32 v[46:47], v[94:95], v[46:47]
    v_cvt_pk_bf16_f32 v148, v40, v41
    v_cvt_pk_bf16_f32 v149, v42, v43
    v_cvt_pk_bf16_f32 v150, v44, v45
    v_cvt_pk_bf16_f32 v151, v46, v47
    buffer_store_dwordx4 v[148:151], v6, s[28:31], s57 offen offset:1536 sc1
    s_cmp_eq_u32 s91, 13
    s_cbranch_scc1 L_M_F_stdone
    v_pk_mul_f32 v[32:33], v[96:97], v[96:97]
    v_pk_mul_f32 v[34:35], v[98:99], v[98:99]
    v_pk_mul_f32 v[36:37], v[100:101], v[100:101]
    v_pk_mul_f32 v[38:39], v[102:103], v[102:103]
    v_pk_fma_f32 v[32:33], v[32:33], v[54:55], v[62:63] op_sel_hi:[1,0,0]
    v_pk_fma_f32 v[34:35], v[34:35], v[54:55], v[62:63] op_sel_hi:[1,0,0]
    v_pk_fma_f32 v[36:37], v[36:37], v[54:55], v[62:63] op_sel_hi:[1,0,0]
    v_pk_fma_f32 v[38:39], v[38:39], v[54:55], v[62:63] op_sel_hi:[1,0,0]
    v_pk_mul_f32 v[32:33], v[96:97], v[32:33]
    v_pk_mul_f32 v[34:35], v[98:99], v[34:35]
    v_pk_mul_f32 v[36:37], v[100:101], v[36:37]
    v_pk_mul_f32 v[38:39], v[102:103], v[38:39]
    v_exp_f32 v32, v32
    v_exp_f32 v33, v33
    v_exp_f32 v34, v34
    v_exp_f32 v35, v35
    v_exp_f32 v36, v36
    v_exp_f32 v37, v37
    v_exp_f32 v38, v38
    v_exp_f32 v39, v39
    v_pk_fma_f32 v[32:33], v[32:33], v[52:53], v[52:53] op_sel_hi:[1,0,0]
    v_pk_fma_f32 v[34:35], v[34:35], v[52:53], v[52:53] op_sel_hi:[1,0,0]
    v_pk_fma_f32 v[36:37], v[36:37], v[52:53], v[52:53] op_sel_hi:[1,0,0]
    v_pk_fma_f32 v[38:39], v[38:39], v[52:53], v[52:53] op_sel_hi:[1,0,0]
    v_rcp_f32 v32, v32
    v_rcp_f32 v33, v33
    v_rcp_f32 v34, v34
    v_rcp_f32 v35, v35
    v_rcp_f32 v36, v36
    v_rcp_f32 v37, v37
    v_rcp_f32 v38, v38
    v_rcp_f32 v39, v39
    v_pk_mul_f32 v[32:33], v[96:97], v[32:33]
    v_pk_mul_f32 v[34:35], v[98:99], v[34:35]
    v_pk_mul_f32 v[36:37], v[100:101], v[36:37]
    v_pk_mul_f32 v[38:39], v[102:103], v[38:39]
    v_cvt_pk_bf16_f32 v152, v32, v33
    v_cvt_pk_bf16_f32 v153, v34, v35
    v_cvt_pk_bf16_f32 v154, v36, v37
    v_cvt_pk_bf16_f32 v155, v38, v39
    buffer_store_dwordx4 v[152:155], v6, s[28:31], s57 offen offset:2048 sc1
    v_pk_mul_f32 v[40:41], v[104:105], v[104:105]
    v_pk_mul_f32 v[42:43], v[106:107], v[106:107]
    v_pk_mul_f32 v[44:45], v[108:109], v[108:109]
    v_pk_mul_f32 v[46:47], v[110:111], v[110:111]
    v_pk_fma_f32 v[40:41], v[40:41], v[54:55], v[62:63] op_sel_hi:[1,0,0]
    v_pk_fma_f32 v[42:43], v[42:43], v[54:55], v[62:63] op_sel_hi:[1,0,0]
    v_pk_fma_f32 v[44:45], v[44:45], v[54:55], v[62:63] op_sel_hi:[1,0,0]
    v_pk_fma_f32 v[46:47], v[46:47], v[54:55], v[62:63] op_sel_hi:[1,0,0]
    v_pk_mul_f32 v[40:41], v[104:105], v[40:41]
    v_pk_mul_f32 v[42:43], v[106:107], v[42:43]
    v_pk_mul_f32 v[44:45], v[108:109], v[44:45]
    v_pk_mul_f32 v[46:47], v[110:111], v[46:47]
    v_exp_f32 v40, v40
    v_exp_f32 v41, v41
    v_exp_f32 v42, v42
    v_exp_f32 v43, v43
    v_exp_f32 v44, v44
    v_exp_f32 v45, v45
    v_exp_f32 v46, v46
    v_exp_f32 v47, v47
    v_pk_fma_f32 v[40:41], v[40:41], v[52:53], v[52:53] op_sel_hi:[1,0,0]
    v_pk_fma_f32 v[42:43], v[42:43], v[52:53], v[52:53] op_sel_hi:[1,0,0]
    v_pk_fma_f32 v[44:45], v[44:45], v[52:53], v[52:53] op_sel_hi:[1,0,0]
    v_pk_fma_f32 v[46:47], v[46:47], v[52:53], v[52:53] op_sel_hi:[1,0,0]
    v_rcp_f32 v40, v40
    v_rcp_f32 v41, v41
    v_rcp_f32 v42, v42
    v_rcp_f32 v43, v43
    v_rcp_f32 v44, v44
    v_rcp_f32 v45, v45
    v_rcp_f32 v46, v46
    v_rcp_f32 v47, v47
    v_pk_mul_f32 v[40:41], v[104:105], v[40:41]
    v_pk_mul_f32 v[42:43], v[106:107], v[42:43]
    v_pk_mul_f32 v[44:45], v[108:109], v[44:45]
    v_pk_mul_f32 v[46:47], v[110:111], v[46:47]
    v_cvt_pk_bf16_f32 v156, v40, v41
    v_cvt_pk_bf16_f32 v157, v42, v43
    v_cvt_pk_bf16_f32 v158, v44, v45
    v_cvt_pk_bf16_f32 v159, v46, v47
    buffer_store_dwordx4 v[156:159], v6, s[28:31], s57 offen offset:2560 sc1
    v_pk_mul_f32 v[32:33], v[112:113], v[112:113]
    v_pk_mul_f32 v[34:35], v[114:115], v[114:115]
    v_pk_mul_f32 v[36:37], v[116:117], v[116:117]
    v_pk_mul_f32 v[38:39], v[118:119], v[118:119]
    v_pk_fma_f32 v[32:33], v[32:33], v[54:55], v[62:63] op_sel_hi:[1,0,0]
    v_pk_fma_f32 v[34:35], v[34:35], v[54:55], v[62:63] op_sel_hi:[1,0,0]
    v_pk_fma_f32 v[36:37], v[36:37], v[54:55], v[62:63] op_sel_hi:[1,0,0]
    v_pk_fma_f32 v[38:39], v[38:39], v[54:55], v[62:63] op_sel_hi:[1,0,0]
    v_pk_mul_f32 v[32:33], v[112:113], v[32:33]
    v_pk_mul_f32 v[34:35], v[114:115], v[34:35]
    v_pk_mul_f32 v[36:37], v[116:117], v[36:37]
    v_pk_mul_f32 v[38:39], v[118:119], v[38:39]
    v_exp_f32 v32, v32
    v_exp_f32 v33, v33
    v_exp_f32 v34, v34
    v_exp_f32 v35, v35
    v_exp_f32 v36, v36
    v_exp_f32 v37, v37
    v_exp_f32 v38, v38
    v_exp_f32 v39, v39
    v_pk_fma_f32 v[32:33], v[32:33], v[52:53], v[52:53] op_sel_hi:[1,0,0]
    v_pk_fma_f32 v[34:35], v[34:35], v[52:53], v[52:53] op_sel_hi:[1,0,0]
    v_pk_fma_f32 v[36:37], v[36:37], v[52:53], v[52:53] op_sel_hi:[1,0,0]
    v_pk_fma_f32 v[38:39], v[38:39], v[52:53], v[52:53] op_sel_hi:[1,0,0]
    v_rcp_f32 v32, v32
    v_rcp_f32 v33, v33
    v_rcp_f32 v34, v34
    v_rcp_f32 v35, v35
    v_rcp_f32 v36, v36
    v_rcp_f32 v37, v37
    v_rcp_f32 v38, v38
    v_rcp_f32 v39, v39
    v_pk_mul_f32 v[32:33], v[112:113], v[32:33]
    v_pk_mul_f32 v[34:35], v[114:115], v[34:35]
    v_pk_mul_f32 v[36:37], v[116:117], v[36:37]
    v_pk_mul_f32 v[38:39], v[118:119], v[38:39]
    v_cvt_pk_bf16_f32 v148, v32, v33
    v_cvt_pk_bf16_f32 v149, v34, v35
    v_cvt_pk_bf16_f32 v150, v36, v37
    v_cvt_pk_bf16_f32 v151, v38, v39
    buffer_store_dwordx4 v[148:151], v6, s[28:31], s57 offen offset:3072 sc1
    v_pk_mul_f32 v[40:41], v[120:121], v[120:121]
    v_pk_mul_f32 v[42:43], v[122:123], v[122:123]
    v_pk_mul_f32 v[44:45], v[124:125], v[124:125]
    v_pk_mul_f32 v[46:47], v[126:127], v[126:127]
    v_pk_fma_f32 v[40:41], v[40:41], v[54:55], v[62:63] op_sel_hi:[1,0,0]
    v_pk_fma_f32 v[42:43], v[42:43], v[54:55], v[62:63] op_sel_hi:[1,0,0]
    v_pk_fma_f32 v[44:45], v[44:45], v[54:55], v[62:63] op_sel_hi:[1,0,0]
    v_pk_fma_f32 v[46:47], v[46:47], v[54:55], v[62:63] op_sel_hi:[1,0,0]
    v_pk_mul_f32 v[40:41], v[120:121], v[40:41]
    v_pk_mul_f32 v[42:43], v[122:123], v[42:43]
    v_pk_mul_f32 v[44:45], v[124:125], v[44:45]
    v_pk_mul_f32 v[46:47], v[126:127], v[46:47]
    v_exp_f32 v40, v40
    v_exp_f32 v41, v41
    v_exp_f32 v42, v42
    v_exp_f32 v43, v43
    v_exp_f32 v44, v44
    v_exp_f32 v45, v45
    v_exp_f32 v46, v46
    v_exp_f32 v47, v47
    v_pk_fma_f32 v[40:41], v[40:41], v[52:53], v[52:53] op_sel_hi:[1,0,0]
    v_pk_fma_f32 v[42:43], v[42:43], v[52:53], v[52:53] op_sel_hi:[1,0,0]
    v_pk_fma_f32 v[44:45], v[44:45], v[52:53], v[52:53] op_sel_hi:[1,0,0]
    v_pk_fma_f32 v[46:47], v[46:47], v[52:53], v[52:53] op_sel_hi:[1,0,0]
    v_rcp_f32 v40, v40
    v_rcp_f32 v41, v41
    v_rcp_f32 v42, v42
    v_rcp_f32 v43, v43
    v_rcp_f32 v44, v44
    v_rcp_f32 v45, v45
    v_rcp_f32 v46, v46
    v_rcp_f32 v47, v47
    v_pk_mul_f32 v[40:41], v[120:121], v[40:41]
    v_pk_mul_f32 v[42:43], v[122:123], v[42:43]
    v_pk_mul_f32 v[44:45], v[124:125], v[44:45]
    v_pk_mul_f32 v[46:47], v[126:127], v[46:47]
    v_cvt_pk_bf16_f32 v152, v40, v41
    v_cvt_pk_bf16_f32 v153, v42, v43
    v_cvt_pk_bf16_f32 v154, v44, v45
    v_cvt_pk_bf16_f32 v155, v46, v47
    buffer_store_dwordx4 v[152:155], v6, s[28:31], s57 offen offset:3584 sc1
L_M_F_stdone:
    s_branch L_M_F_done
L_M_F_skip:
    s_lshl_b32 s57, s48, 2
    s_add_u32 s57, s57, 161504
    v_mov_b32 v40, s57
    v_mov_b32 v41, 3
    ds_write_b32 v40, v41
    s_lshl_b32 s57, s48, 2
    s_add_u32 s57, s57, 161344
    v_mov_b32 v40, s57
    v_mov_b32 v41, 4
    ds_write_b32 v40, v41
L_M_F_done:
    s_waitcnt vmcnt(0)
    s_lshl_b32 s57, s48, 2
    s_add_u32 s57, s57, 161312
    v_mov_b32 v4, s57
    v_mov_b32 v5, 3
    ds_write_b32 v4, v5
    v_lshrrev_b32 v2, 4, v1
    v_and_b32 v3, 15, v1
    v_lshlrev_b32 v8, 4, v1
    s_mul_i32 s57, s87, 5120
    v_add_u32 v8, s57, v8
    v_add_u32 v11, 61440, v8
    v_add_u32 v12, 122880, v8
    v_lshlrev_b32 v10, 4, v1
    v_mov_b32 v84, 0
    v_mov_b32 v85, 0
    v_mov_b32 v86, 0
    v_mov_b32 v87, 0
    v_mov_b32 v88, 0
    v_mov_b32 v89, 0
    v_mov_b32 v90, 0
    v_mov_b32 v91, 0
    v_mov_b32 v92, 0
    v_mov_b32 v93, 0
    v_mov_b32 v94, 0
    v_mov_b32 v95, 0
    v_mov_b32 v96, 0
    v_mov_b32 v97, 0
    v_mov_b32 v98, 0
    v_mov_b32 v99, 0
    v_mov_b32 v100, 0
    v_mov_b32 v101, 0
    v_mov_b32 v102, 0
    v_mov_b32 v103, 0
    v_mul_u32_u24 v5, 40, v2
    s_mul_i32 s57, s89, 160
    buffer_load_dwordx4 v[20:23], v5, s[44:47], s57 offen
    buffer_load_dwordx4 v[24:27], v5, s[44:47], s57 offen offset:16
    buffer_load_dwordx2 v[28:29], v5, s[44:47], s57 offen offset:32
    s_lshl_b32 s57, s88, 2
    s_lshl_b32 s58, s86, 1
    s_add_u32 s57, s57, s58
    s_add_u32 s58, s57, s87
    s_mul_i32 s58, s58, 55296
    s_lshl_b32 s59, s87, 10
    s_add_u32 s58, s58, s59
    s_add_u32 s58, s58, 14680064
    s_xor_b32 s59, s87, 1
    s_add_u32 s59, s57, s59
    s_mul_i32 s59, s59, 55296
    s_lshl_b32 s60, s87, 10
    s_add_u32 s59, s59, s60
    s_add_u32 s59, s59, 14680064
    s_waitcnt vmcnt(0)
    v_lshlrev_b32 v64, 16, v20
    v_and_b32 v65, 0xffff0000, v20
    v_lshlrev_b32 v32, 16, v240
    v_and_b32 v33, 0xffff0000, v240
    v_add_f32 v64, v64, v32
    v_add_f32 v65, v65, v33
    v_lshlrev_b32 v66, 16, v21
    v_and_b32 v67, 0xffff0000, v21
    v_lshlrev_b32 v32, 16, v241
    v_and_b32 v33, 0xffff0000, v241
    v_add_f32 v66, v66, v32
    v_add_f32 v67, v67, v33
    v_lshlrev_b32 v68, 16, v22
    v_and_b32 v69, 0xffff0000, v22
    v_lshlrev_b32 v32, 16, v242
    v_and_b32 v33, 0xffff0000, v242
    v_add_f32 v68, v68, v32
    v_add_f32 v69, v69, v33
    v_lshlrev_b32 v70, 16, v23
    v_and_b32 v71, 0xffff0000, v23
    v_lshlrev_b32 v32, 16, v243
    v_and_b32 v33, 0xffff0000, v243
    v_add_f32 v70, v70, v32
    v_add_f32 v71, v71, v33
    v_lshlrev_b32 v72, 16, v24
    v_and_b32 v73, 0xffff0000, v24
    v_lshlrev_b32 v32, 16, v244
    v_and_b32 v33, 0xffff0000, v244
    v_add_f32 v72, v72, v32
    v_add_f32 v73, v73, v33
    v_lshlrev_b32 v74, 16, v25
    v_and_b32 v75, 0xffff0000, v25
    v_lshlrev_b32 v32, 16, v245
    v_and_b32 v33, 0xffff0000, v245
    v_add_f32 v74, v74, v32
    v_add_f32 v75, v75, v33
    v_lshlrev_b32 v76, 16, v26
    v_and_b32 v77, 0xffff0000, v26
    v_lshlrev_b32 v32, 16, v246
    v_and_b32 v33, 0xffff0000, v246
    v_add_f32 v76, v76, v32
    v_add_f32 v77, v77, v33
    v_lshlrev_b32 v78, 16, v27
    v_and_b32 v79, 0xffff0000, v27
    v_lshlrev_b32 v32, 16, v247
    v_and_b32 v33, 0xffff0000, v247
    v_add_f32 v78, v78, v32
    v_add_f32 v79, v79, v33
    v_lshlrev_b32 v80, 16, v28
    v_and_b32 v81, 0xffff0000, v28
    v_lshlrev_b32 v32, 16, v248
    v_and_b32 v33, 0xffff0000, v248
    v_add_f32 v80, v80, v32
    v_add_f32 v81, v81, v33
    v_lshlrev_b32 v82, 16, v29
    v_and_b32 v83, 0xffff0000, v29
    v_lshlrev_b32 v32, 16, v249
    v_and_b32 v33, 0xffff0000, v249
    v_add_f32 v82, v82, v32
    v_add_f32 v83, v83, v33
    v_add_u32 v4, s90, v3
    v_mul_u32_u24 v5, 1280, v4
    v_mul_u32_u24 v6, 40, v2
    v_add_u32 v5, v5, v6
    s_mul_i32 s57, s48, 5120
    v_add_u32 v14, s57, v10
    s_xor_b32 s57, s48, 1
    s_mul_i32 s57, s57, 5120
    v_add_u32 v15, s57, v10
    v_mov_b32 v44, 161376
    s_mov_b32 s93, 0
L_lw_23:
    ds_read_b32 v40, v44
    s_waitcnt lgkmcnt(0)
    v_readfirstlane_b32 s57, v40
    s_add_u32 s93, s93, 1
    s_cmp_gt_u32 s93, 200000
    s_cbranch_scc1 L_lw_23_x
    s_nop 0
    s_cmp_lt_u32 s57, 3
    s_cbranch_scc1 L_lw_23
L_lw_23_x:
    s_mul_i32 s62, s89, 6144
    s_add_u32 s60, s58, 0
    s_add_u32 s61, s59, 0
    buffer_load_dwordx4 v[128:131], v10, s[28:31], s60 offen offset:0 sc1
    buffer_load_dwordx4 v[132:135], v10, s[28:31], s61 offen offset:0 sc1
    buffer_load_dwordx4 v[136:139], v10, s[28:31], s60 offen offset:2048 sc1
    buffer_load_dwordx4 v[140:143], v10, s[28:31], s61 offen offset:2048 sc1
    s_add_u32 s60, s58, 4096
    s_add_u32 s61, s59, 4096
    buffer_load_dwordx4 v[144:147], v10, s[28:31], s60 offen offset:0 sc1
    buffer_load_dwordx4 v[148:151], v10, s[28:31], s61 offen offset:0 sc1
    buffer_load_dwordx4 v[152:155], v10, s[28:31], s60 offen offset:2048 sc1
    buffer_load_dwordx4 v[156:159], v10, s[28:31], s61 offen offset:2048 sc1
    s_barrier
    ds_read_b128 v[200:203], v8 offset:0
    ds_read_b128 v[204:207], v8 offset:1024
    ds_read_b128 v[208:211], v8 offset:2048
    ds_read_b128 v[212:215], v8 offset:3072
    ds_read_b128 v[216:219], v8 offset:4096
    s_waitcnt vmcnt(6)
    s_waitcnt lgkmcnt(3)
    v_mfma_f32_16x16x32_bf16 v[64:67], v[200:203], v[128:131], v[64:67]
    v_mfma_f32_16x16x32_bf16 v[84:87], v[200:203], v[132:135], v[84:87]
    ds_read_b128 v[220:223], v8 offset:10240
    ds_read_b128 v[224:227], v8 offset:11264
    v_mfma_f32_16x16x32_bf16 v[68:71], v[204:207], v[128:131], v[68:71]
    v_mfma_f32_16x16x32_bf16 v[88:91], v[204:207], v[132:135], v[88:91]
    ds_read_b128 v[228:231], v8 offset:12288
    ds_read_b128 v[232:235], v8 offset:13312
    s_waitcnt lgkmcnt(5)
    v_mfma_f32_16x16x32_bf16 v[72:75], v[208:211], v[128:131], v[72:75]
    v_mfma_f32_16x16x32_bf16 v[92:95], v[208:211], v[132:135], v[92:95]
    ds_read_b128 v[236:239], v8 offset:14336
    v_mfma_f32_16x16x32_bf16 v[76:79], v[212:215], v[128:131], v[76:79]
    v_mfma_f32_16x16x32_bf16 v[96:99], v[212:215], v[132:135], v[96:99]
    s_waitcnt lgkmcnt(5)
    v_mfma_f32_16x16x32_bf16 v[80:83], v[216:219], v[128:131], v[80:83]
    v_mfma_f32_16x16x32_bf16 v[100:103], v[216:219], v[132:135], v[100:103]
    s_add_u32 s60, s58, 8192
    s_add_u32 s61, s59, 8192
    buffer_load_dwordx4 v[160:163], v10, s[28:31], s60 offen offset:0 sc1
    buffer_load_dwordx4 v[164:167], v10, s[28:31], s61 offen offset:0 sc1
    buffer_load_dwordx4 v[168:171], v10, s[28:31], s60 offen offset:2048 sc1
    buffer_load_dwordx4 v[172:175], v10, s[28:31], s61 offen offset:2048 sc1
    s_waitcnt vmcnt(8)
    s_waitcnt lgkmcnt(3)
    v_mfma_f32_16x16x32_bf16 v[64:67], v[220:223], v[136:139], v[64:67]
    v_mfma_f32_16x16x32_bf16 v[84:87], v[220:223], v[140:143], v[84:87]
    ds_read_b128 v[200:203], v8 offset:20480
    ds_read_b128 v[204:207], v8 offset:21504
    v_mfma_f32_16x16x32_bf16 v[68:71], v[224:227], v[136:139], v[68:71]
    v_mfma_f32_16x16x32_bf16 v[88:91], v[224:227], v[140:143], v[88:91]
    ds_read_b128 v[208:211], v8 offset:22528
    ds_read_b128 v[212:215], v8 offset:23552
    s_waitcnt lgkmcnt(5)
    v_mfma_f32_16x16x32_bf16 v[72:75], v[228:231], v[136:139], v[72:75]
    v_mfma_f32_16x16x32_bf16 v[92:95], v[228:231], v[140:143], v[92:95]
    ds_read_b128 v[216:219], v8 offset:24576
    s_barrier
    v_mfma_f32_16x16x32_bf16 v[76:79], v[232:235], v[136:139], v[76:79]
    v_mfma_f32_16x16x32_bf16 v[96:99], v[232:235], v[140:143], v[96:99]
    s_waitcnt lgkmcnt(5)
    v_mfma_f32_16x16x32_bf16 v[80:83], v[236:239], v[136:139], v[80:83]
    v_mfma_f32_16x16x32_bf16 v[100:103], v[236:239], v[140:143], v[100:103]
    s_add_u32 s60, s58, 12288
    s_add_u32 s61, s59, 12288
    buffer_load_dwordx4 v[176:179], v10, s[28:31], s60 offen offset:0 sc1
    buffer_load_dwordx4 v[180:183], v10, s[28:31], s61 offen offset:0 sc1
    buffer_load_dwordx4 v[128:131], v10, s[28:31], s60 offen offset:2048 sc1
    buffer_load_dwordx4 v[132:135], v10, s[28:31], s61 offen offset:2048 sc1
    s_waitcnt vmcnt(10)
    s_waitcnt lgkmcnt(3)
    v_mfma_f32_16x16x32_bf16 v[64:67], v[200:203], v[144:147], v[64:67]
    v_mfma_f32_16x16x32_bf16 v[84:87], v[200:203], v[148:151], v[84:87]
    ds_read_b128 v[220:223], v8 offset:30720
    ds_read_b128 v[224:227], v8 offset:31744
    v_mfma_f32_16x16x32_bf16 v[68:71], v[204:207], v[144:147], v[68:71]
    v_mfma_f32_16x16x32_bf16 v[88:91], v[204:207], v[148:151], v[88:91]
    ds_read_b128 v[228:231], v8 offset:32768
    ds_read_b128 v[232:235], v8 offset:33792
    s_waitcnt lgkmcnt(5)
    v_mfma_f32_16x16x32_bf16 v[72:75], v[208:211], v[144:147], v[72:75]
    v_mfma_f32_16x16x32_bf16 v[92:95], v[208:211], v[148:151], v[92:95]
    ds_read_b128 v[236:239], v8 offset:34816
    v_mfma_f32_16x16x32_bf16 v[76:79], v[212:215], v[144:147], v[76:79]
    v_mfma_f32_16x16x32_bf16 v[96:99], v[212:215], v[148:151], v[96:99]
    s_waitcnt lgkmcnt(5)
    v_mfma_f32_16x16x32_bf16 v[80:83], v[216:219], v[144:147], v[80:83]
    v_mfma_f32_16x16x32_bf16 v[100:103], v[216:219], v[148:151], v[100:103]
    s_add_u32 s60, s58, 16384
    s_add_u32 s61, s59, 16384
    buffer_load_dwordx4 v[136:139], v10, s[28:31], s60 offen offset:0 sc1
    buffer_load_dwordx4 v[140:143], v10, s[28:31], s61 offen offset:0 sc1
    buffer_load_dwordx4 v[144:147], v10, s[28:31], s60 offen offset:2048 sc1
    buffer_load_dwordx4 v[148:151], v10, s[28:31], s61 offen offset:2048 sc1
    s_waitcnt vmcnt(12)
    s_waitcnt lgkmcnt(3)
    v_mfma_f32_16x16x32_bf16 v[64:67], v[220:223], v[152:155], v[64:67]
    v_mfma_f32_16x16x32_bf16 v[84:87], v[220:223], v[156:159], v[84:87]
    ds_read_b128 v[200:203], v8 offset:40960
    ds_read_b128 v[204:207], v8 offset:41984
    v_mfma_f32_16x16x32_bf16 v[68:71], v[224:227], v[152:155], v[68:71]
    v_mfma_f32_16x16x32_bf16 v[88:91], v[224:227], v[156:159], v[88:91]
    ds_read_b128 v[208:211], v8 offset:43008
    ds_read_b128 v[212:215], v8 offset:44032
    s_waitcnt lgkmcnt(5)
    v_mfma_f32_16x16x32_bf16 v[72:75], v[228:231], v[152:155], v[72:75]
    v_mfma_f32_16x16x32_bf16 v[92:95], v[228:231], v[156:159], v[92:95]
    ds_read_b128 v[216:219], v8 offset:45056
    v_mfma_f32_16x16x32_bf16 v[76:79], v[232:235], v[152:155], v[76:79]
    v_mfma_f32_16x16x32_bf16 v[96:99], v[232:235], v[156:159], v[96:99]
    s_waitcnt lgkmcnt(5)
    v_mfma_f32_16x16x32_bf16 v[80:83], v[236:239], v[152:155], v[80:83]
    v_mfma_f32_16x16x32_bf16 v[100:103], v[236:239], v[156:159], v[100:103]
    s_add_u32 s60, s58, 20480
    s_add_u32 s61, s59, 20480
    buffer_load_dwordx4 v[152:155], v10, s[28:31], s60 offen offset:0 sc1
    buffer_load_dwordx4 v[156:159], v10, s[28:31], s61 offen offset:0 sc1
    s_waitcnt vmcnt(12)
    s_waitcnt lgkmcnt(3)
    v_mfma_f32_16x16x32_bf16 v[64:67], v[200:203], v[160:163], v[64:67]
    v_mfma_f32_16x16x32_bf16 v[84:87], v[200:203], v[164:167], v[84:87]
    ds_read_b128 v[220:223], v8 offset:51200
    ds_read_b128 v[224:227], v8 offset:52224
    v_mfma_f32_16x16x32_bf16 v[68:71], v[204:207], v[160:163], v[68:71]
    v_mfma_f32_16x16x32_bf16 v[88:91], v[204:207], v[164:167], v[88:91]
    ds_read_b128 v[228:231], v8 offset:53248
    ds_read_b128 v[232:235], v8 offset:54272
    s_waitcnt lgkmcnt(5)
    v_mfma_f32_16x16x32_bf16 v[72:75], v[208:211], v[160:163], v[72:75]
    v_mfma_f32_16x16x32_bf16 v[92:95], v[208:211], v[164:167], v[92:95]
    ds_read_b128 v[236:239], v8 offset:55296
    s_barrier
    v_mfma_f32_16x16x32_bf16 v[76:79], v[212:215], v[160:163], v[76:79]
    v_mfma_f32_16x16x32_bf16 v[96:99], v[212:215], v[164:167], v[96:99]
    s_waitcnt lgkmcnt(5)
    v_mfma_f32_16x16x32_bf16 v[80:83], v[216:219], v[160:163], v[80:83]
    v_mfma_f32_16x16x32_bf16 v[100:103], v[216:219], v[164:167], v[100:103]
    buffer_load_dwordx4 v[160:163], v10, s[28:31], s60 offen offset:2048 sc1
    buffer_load_dwordx4 v[164:167], v10, s[28:31], s61 offen offset:2048 sc1
    s_waitcnt vmcnt(12)
    s_waitcnt lgkmcnt(3)
    v_mfma_f32_16x16x32_bf16 v[64:67], v[220:223], v[168:171], v[64:67]
    v_mfma_f32_16x16x32_bf16 v[84:87], v[220:223], v[172:175], v[84:87]
    ds_read_b128 v[200:203], v11 offset:0
    ds_read_b128 v[204:207], v11 offset:1024
    v_mfma_f32_16x16x32_bf16 v[68:71], v[224:227], v[168:171], v[68:71]
    v_mfma_f32_16x16x32_bf16 v[88:91], v[224:227], v[172:175], v[88:91]
    ds_read_b128 v[208:211], v11 offset:2048
    ds_read_b128 v[212:215], v11 offset:3072
    s_waitcnt lgkmcnt(5)
    v_mfma_f32_16x16x32_bf16 v[72:75], v[228:231], v[168:171], v[72:75]
    v_mfma_f32_16x16x32_bf16 v[92:95], v[228:231], v[172:175], v[92:95]
    ds_read_b128 v[216:219], v11 offset:4096
    v_mfma_f32_16x16x32_bf16 v[76:79], v[232:235], v[168:171], v[76:79]
    v_mfma_f32_16x16x32_bf16 v[96:99], v[232:235], v[172:175], v[96:99]
    s_waitcnt lgkmcnt(5)
    v_mfma_f32_16x16x32_bf16 v[80:83], v[236:239], v[168:171], v[80:83]
    v_mfma_f32_16x16x32_bf16 v[100:103], v[236:239], v[172:175], v[100:103]
    s_add_u32 s60, s58, 24576
    s_add_u32 s61, s59, 24576
    buffer_load_dwordx4 v[168:171], v10, s[28:31], s60 offen offset:0 sc1
    buffer_load_dwordx4 v[172:175], v10, s[28:31], s61 offen offset:0 sc1
    s_waitcnt vmcnt(12)
    s_waitcnt lgkmcnt(3)
    v_mfma_f32_16x16x32_bf16 v[64:67], v[200:203], v[176:179], v[64:67]
    v_mfma_f32_16x16x32_bf16 v[84:87], v[200:203], v[180:183], v[84:87]
    ds_read_b128 v[220:223], v11 offset:10240
    ds_read_b128 v[224:227], v11 offset:11264
    v_mfma_f32_16x16x32_bf16 v[68:71], v[204:207], v[176:179], v[68:71]
    v_mfma_f32_16x16x32_bf16 v[88:91], v[204:207], v[180:183], v[88:91]
    ds_read_b128 v[228:231], v11 offset:12288
    ds_read_b128 v[232:235], v11 offset:13312
    s_waitcnt lgkmcnt(5)
    v_mfma_f32_16x16x32_bf16 v[72:75], v[208:211], v[176:179], v[72:75]
    v_mfma_f32_16x16x32_bf16 v[92:95], v[208:211], v[180:183], v[92:95]
    ds_read_b128 v[236:239], v11 offset:14336
    v_mfma_f32_16x16x32_bf16 v[76:79], v[212:215], v[176:179], v[76:79]
    v_mfma_f32_16x16x32_bf16 v[96:99], v[212:215], v[180:183], v[96:99]
    s_waitcnt lgkmcnt(5)
    v_mfma_f32_16x16x32_bf16 v[80:83], v[216:219], v[176:179], v[80:83]
    v_mfma_f32_16x16x32_bf16 v[100:103], v[216:219], v[180:183], v[100:103]
    buffer_load_dwordx4 v[176:179], v10, s[28:31], s60 offen offset:2048 sc1
    buffer_load_dwordx4 v[180:183], v10, s[28:31], s61 offen offset:2048 sc1
    s_waitcnt vmcnt(12)
    s_waitcnt lgkmcnt(3)
    v_mfma_f32_16x16x32_bf16 v[64:67], v[220:223], v[128:131], v[64:67]
    v_mfma_f32_16x16x32_bf16 v[84:87], v[220:223], v[132:135], v[84:87]
    ds_read_b128 v[200:203], v11 offset:20480
    ds_read_b128 v[204:207], v11 offset:21504
    v_mfma_f32_16x16x32_bf16 v[68:71], v[224:227], v[128:131], v[68:71]
    v_mfma_f32_16x16x32_bf16 v[88:91], v[224:227], v[132:135], v[88:91]
    ds_read_b128 v[208:211], v11 offset:22528
    ds_read_b128 v[212:215], v11 offset:23552
    s_waitcnt lgkmcnt(5)
    v_mfma_f32_16x16x32_bf16 v[72:75], v[228:231], v[128:131], v[72:75]
    v_mfma_f32_16x16x32_bf16 v[92:95], v[228:231], v[132:135], v[92:95]
    ds_read_b128 v[216:219], v11 offset:24576
    s_barrier
    v_mfma_f32_16x16x32_bf16 v[76:79], v[232:235], v[128:131], v[76:79]
    v_mfma_f32_16x16x32_bf16 v[96:99], v[232:235], v[132:135], v[96:99]
    s_waitcnt lgkmcnt(5)
    v_mfma_f32_16x16x32_bf16 v[80:83], v[236:239], v[128:131], v[80:83]
    v_mfma_f32_16x16x32_bf16 v[100:103], v[236:239], v[132:135], v[100:103]
    s_add_u32 s60, s58, 28672
    s_add_u32 s61, s59, 28672
    buffer_load_dwordx4 v[128:131], v10, s[28:31], s60 offen offset:0 sc1
    buffer_load_dwordx4 v[132:135], v10, s[28:31], s61 offen offset:0 sc1
    s_waitcnt vmcnt(12)
    s_waitcnt lgkmcnt(3)
    v_mfma_f32_16x16x32_bf16 v[64:67], v[200:203], v[136:139], v[64:67]
    v_mfma_f32_16x16x32_bf16 v[84:87], v[200:203], v[140:143], v[84:87]
    ds_read_b128 v[220:223], v11 offset:30720
    ds_read_b128 v[224:227], v11 offset:31744
    v_mfma_f32_16x16x32_bf16 v[68:71], v[204:207], v[136:139], v[68:71]
    v_mfma_f32_16x16x32_bf16 v[88:91], v[204:207], v[140:143], v[88:91]
    ds_read_b128 v[228:231], v11 offset:32768
    ds_read_b128 v[232:235], v11 offset:33792
    s_waitcnt lgkmcnt(5)
    v_mfma_f32_16x16x32_bf16 v[72:75], v[208:211], v[136:139], v[72:75]
    v_mfma_f32_16x16x32_bf16 v[92:95], v[208:211], v[140:143], v[92:95]
    ds_read_b128 v[236:239], v11 offset:34816
    v_mfma_f32_16x16x32_bf16 v[76:79], v[212:215], v[136:139], v[76:79]
    v_mfma_f32_16x16x32_bf16 v[96:99], v[212:215], v[140:143], v[96:99]
    s_waitcnt lgkmcnt(5)
    v_mfma_f32_16x16x32_bf16 v[80:83], v[216:219], v[136:139], v[80:83]
    v_mfma_f32_16x16x32_bf16 v[100:103], v[216:219], v[140:143], v[100:103]
    buffer_load_dwordx4 v[136:139], v10, s[28:31], s60 offen offset:2048 sc1
    buffer_load_dwordx4 v[140:143], v10, s[28:31], s61 offen offset:2048 sc1
    s_waitcnt vmcnt(12)
    s_waitcnt lgkmcnt(3)
    v_mfma_f32_16x16x32_bf16 v[64:67], v[220:223], v[144:147], v[64:67]
    v_mfma_f32_16x16x32_bf16 v[84:87], v[220:223], v[148:151], v[84:87]
    ds_read_b128 v[200:203], v11 offset:40960
    ds_read_b128 v[204:207], v11 offset:41984
    v_mfma_f32_16x16x32_bf16 v[68:71], v[224:227], v[144:147], v[68:71]
    v_mfma_f32_16x16x32_bf16 v[88:91], v[224:227], v[148:151], v[88:91]
    ds_read_b128 v[208:211], v11 offset:43008
    ds_read_b128 v[212:215], v11 offset:44032
    s_waitcnt lgkmcnt(5)
    v_mfma_f32_16x16x32_bf16 v[72:75], v[228:231], v[144:147], v[72:75]
    v_mfma_f32_16x16x32_bf16 v[92:95], v[228:231], v[148:151], v[92:95]
    ds_read_b128 v[216:219], v11 offset:45056
    v_mfma_f32_16x16x32_bf16 v[76:79], v[232:235], v[144:147], v[76:79]
    v_mfma_f32_16x16x32_bf16 v[96:99], v[232:235], v[148:151], v[96:99]
    s_waitcnt lgkmcnt(5)
    v_mfma_f32_16x16x32_bf16 v[80:83], v[236:239], v[144:147], v[80:83]
    v_mfma_f32_16x16x32_bf16 v[100:103], v[236:239], v[148:151], v[100:103]
    s_add_u32 s60, s58, 32768
    s_add_u32 s61, s59, 32768
    buffer_load_dwordx4 v[144:147], v10, s[28:31], s60 offen offset:0 sc1
    buffer_load_dwordx4 v[148:151], v10, s[28:31], s61 offen offset:0 sc1
    s_waitcnt vmcnt(12)
    s_waitcnt lgkmcnt(3)
    v_mfma_f32_16x16x32_bf16 v[64:67], v[200:203], v[152:155], v[64:67]
    v_mfma_f32_16x16x32_bf16 v[84:87], v[200:203], v[156:159], v[84:87]
    ds_read_b128 v[220:223], v11 offset:51200
    ds_read_b128 v[224:227], v11 offset:52224
    v_mfma_f32_16x16x32_bf16 v[68:71], v[204:207], v[152:155], v[68:71]
    v_mfma_f32_16x16x32_bf16 v[88:91], v[204:207], v[156:159], v[88:91]
    ds_read_b128 v[228:231], v11 offset:53248
    ds_read_b128 v[232:235], v11 offset:54272
    s_waitcnt lgkmcnt(5)
    v_mfma_f32_16x16x32_bf16 v[72:75], v[208:211], v[152:155], v[72:75]
    v_mfma_f32_16x16x32_bf16 v[92:95], v[208:211], v[156:159], v[92:95]
    ds_read_b128 v[236:239], v11 offset:55296
    s_barrier
    v_mfma_f32_16x16x32_bf16 v[76:79], v[212:215], v[152:155], v[76:79]
    v_mfma_f32_16x16x32_bf16 v[96:99], v[212:215], v[156:159], v[96:99]
    s_waitcnt lgkmcnt(5)
    v_mfma_f32_16x16x32_bf16 v[80:83], v[216:219], v[152:155], v[80:83]
    v_mfma_f32_16x16x32_bf16 v[100:103], v[216:219], v[156:159], v[100:103]
    buffer_load_dwordx4 v[152:155], v10, s[28:31], s60 offen offset:2048 sc1
    buffer_load_dwordx4 v[156:159], v10, s[28:31], s61 offen offset:2048 sc1
    s_waitcnt vmcnt(12)
    s_waitcnt lgkmcnt(3)
    v_mfma_f32_16x16x32_bf16 v[64:67], v[220:223], v[160:163], v[64:67]
    v_mfma_f32_16x16x32_bf16 v[84:87], v[220:223], v[164:167], v[84:87]
    ds_read_b128 v[200:203], v12 offset:0
    ds_read_b128 v[204:207], v12 offset:1024
    v_mfma_f32_16x16x32_bf16 v[68:71], v[224:227], v[160:163], v[68:71]
    v_mfma_f32_16x16x32_bf16 v[88:91], v[224:227], v[164:167], v[88:91]
    ds_read_b128 v[208:211], v12 offset:2048
    ds_read_b128 v[212:215], v12 offset:3072
    s_waitcnt lgkmcnt(5)
    v_mfma_f32_16x16x32_bf16 v[72:75], v[228:231], v[160:163], v[72:75]
    v_mfma_f32_16x16x32_bf16 v[92:95], v[228:231], v[164:167], v[92:95]
    ds_read_b128 v[216:219], v12 offset:4096
    v_mfma_f32_16x16x32_bf16 v[76:79], v[232:235], v[160:163], v[76:79]
    v_mfma_f32_16x16x32_bf16 v[96:99], v[232:235], v[164:167], v[96:99]
    s_waitcnt lgkmcnt(5)
    v_mfma_f32_16x16x32_bf16 v[80:83], v[236:239], v[160:163], v[80:83]
    v_mfma_f32_16x16x32_bf16 v[100:103], v[236:239], v[164:167], v[100:103]
    s_add_u32 s60, s58, 36864
    s_add_u32 s61, s59, 36864
    buffer_load_dwordx4 v[160:163], v10, s[28:31], s60 offen offset:0 sc1
    buffer_load_dwordx4 v[164:167], v10, s[28:31], s61 offen offset:0 sc1
    s_waitcnt vmcnt(12)
    s_waitcnt lgkmcnt(3)
    v_mfma_f32_16x16x32_bf16 v[64:67], v[200:203], v[168:171], v[64:67]
    v_mfma_f32_16x16x32_bf16 v[84:87], v[200:203], v[172:175], v[84:87]
    ds_read_b128 v[220:223], v12 offset:10240
    ds_read_b128 v[224:227], v12 offset:11264
    v_mfma_f32_16x16x32_bf16 v[68:71], v[204:207], v[168:171], v[68:71]
    v_mfma_f32_16x16x32_bf16 v[88:91], v[204:207], v[172:175], v[88:91]
    ds_read_b128 v[228:231], v12 offset:12288
    ds_read_b128 v[232:235], v12 offset:13312
    s_waitcnt lgkmcnt(5)
    v_mfma_f32_16x16x32_bf16 v[72:75], v[208:211], v[168:171], v[72:75]
    v_mfma_f32_16x16x32_bf16 v[92:95], v[208:211], v[172:175], v[92:95]
    ds_read_b128 v[236:239], v12 offset:14336
    v_mfma_f32_16x16x32_bf16 v[76:79], v[212:215], v[168:171], v[76:79]
    v_mfma_f32_16x16x32_bf16 v[96:99], v[212:215], v[172:175], v[96:99]
    s_waitcnt lgkmcnt(5)
    v_mfma_f32_16x16x32_bf16 v[80:83], v[216:219], v[168:171], v[80:83]
    v_mfma_f32_16x16x32_bf16 v[100:103], v[216:219], v[172:175], v[100:103]
    buffer_load_dwordx4 v[168:171], v10, s[28:31], s60 offen offset:2048 sc1
    buffer_load_dwordx4 v[172:175], v10, s[28:31], s61 offen offset:2048 sc1
    s_waitcnt vmcnt(12)
    s_waitcnt lgkmcnt(3)
    v_mfma_f32_16x16x32_bf16 v[64:67], v[220:223], v[176:179], v[64:67]
    v_mfma_f32_16x16x32_bf16 v[84:87], v[220:223], v[180:183], v[84:87]
    ds_read_b128 v[200:203], v12 offset:20480
    ds_read_b128 v[204:207], v12 offset:21504
    v_mfma_f32_16x16x32_bf16 v[68:71], v[224:227], v[176:179], v[68:71]
    v_mfma_f32_16x16x32_bf16 v[88:91], v[224:227], v[180:183], v[88:91]
    ds_read_b128 v[208:211], v12 offset:22528
    ds_read_b128 v[212:215], v12 offset:23552
    s_waitcnt lgkmcnt(5)
    v_mfma_f32_16x16x32_bf16 v[72:75], v[228:231], v[176:179], v[72:75]
    v_mfma_f32_16x16x32_bf16 v[92:95], v[228:231], v[180:183], v[92:95]
    ds_read_b128 v[216:219], v12 offset:24576
    s_barrier
    v_mfma_f32_16x16x32_bf16 v[76:79], v[232:235], v[176:179], v[76:79]
    v_mfma_f32_16x16x32_bf16 v[96:99], v[232:235], v[180:183], v[96:99]
    s_waitcnt lgkmcnt(5)
    v_mfma_f32_16x16x32_bf16 v[80:83], v[236:239], v[176:179], v[80:83]
    v_mfma_f32_16x16x32_bf16 v[100:103], v[236:239], v[180:183], v[100:103]
    s_add_u32 s60, s58, 40960
    s_add_u32 s61, s59, 40960
    buffer_load_dwordx4 v[176:179], v10, s[28:31], s60 offen offset:0 sc1
    buffer_load_dwordx4 v[180:183], v10, s[28:31], s61 offen offset:0 sc1
    s_waitcnt vmcnt(12)
    s_waitcnt lgkmcnt(3)
    v_mfma_f32_16x16x32_bf16 v[64:67], v[200:203], v[128:131], v[64:67]
    v_mfma_f32_16x16x32_bf16 v[84:87], v[200:203], v[132:135], v[84:87]
    ds_read_b128 v[220:223], v8 offset:0
    ds_read_b128 v[224:227], v8 offset:1024
    v_mfma_f32_16x16x32_bf16 v[68:71], v[204:207], v[128:131], v[68:71]
    v_mfma_f32_16x16x32_bf16 v[88:91], v[204:207], v[132:135], v[88:91]
    ds_read_b128 v[228:231], v8 offset:2048
    ds_read_b128 v[232:235], v8 offset:3072
    s_waitcnt lgkmcnt(5)
    v_mfma_f32_16x16x32_bf16 v[72:75], v[208:211], v[128:131], v[72:75]
    v_mfma_f32_16x16x32_bf16 v[92:95], v[208:211], v[132:135], v[92:95]
    ds_read_b128 v[236:239], v8 offset:4096
    v_mfma_f32_16x16x32_bf16 v[76:79], v[212:215], v[128:131], v[76:79]
    v_mfma_f32_16x16x32_bf16 v[96:99], v[212:215], v[132:135], v[96:99]
    s_waitcnt lgkmcnt(5)
    v_mfma_f32_16x16x32_bf16 v[80:83], v[216:219], v[128:131], v[80:83]
    v_mfma_f32_16x16x32_bf16 v[100:103], v[216:219], v[132:135], v[100:103]
    buffer_load_dwordx4 v[128:131], v10, s[28:31], s60 offen offset:2048 sc1
    buffer_load_dwordx4 v[132:135], v10, s[28:31], s61 offen offset:2048 sc1
    s_waitcnt vmcnt(12)
    s_waitcnt lgkmcnt(3)
    v_mfma_f32_16x16x32_bf16 v[64:67], v[220:223], v[136:139], v[64:67]
    v_mfma_f32_16x16x32_bf16 v[84:87], v[220:223], v[140:143], v[84:87]
    ds_read_b128 v[200:203], v8 offset:10240
    ds_read_b128 v[204:207], v8 offset:11264
    v_mfma_f32_16x16x32_bf16 v[68:71], v[224:227], v[136:139], v[68:71]
    v_mfma_f32_16x16x32_bf16 v[88:91], v[224:227], v[140:143], v[88:91]
    ds_read_b128 v[208:211], v8 offset:12288
    ds_read_b128 v[212:215], v8 offset:13312
    s_waitcnt lgkmcnt(5)
    v_mfma_f32_16x16x32_bf16 v[72:75], v[228:231], v[136:139], v[72:75]
    v_mfma_f32_16x16x32_bf16 v[92:95], v[228:231], v[140:143], v[92:95]
    ds_read_b128 v[216:219], v8 offset:14336
    v_mfma_f32_16x16x32_bf16 v[76:79], v[232:235], v[136:139], v[76:79]
    v_mfma_f32_16x16x32_bf16 v[96:99], v[232:235], v[140:143], v[96:99]
    s_waitcnt lgkmcnt(5)
    v_mfma_f32_16x16x32_bf16 v[80:83], v[236:239], v[136:139], v[80:83]
    v_mfma_f32_16x16x32_bf16 v[100:103], v[236:239], v[140:143], v[100:103]
    s_add_u32 s60, s58, 45056
    s_add_u32 s61, s59, 45056
    buffer_load_dwordx4 v[136:139], v10, s[28:31], s60 offen offset:0 sc1
    buffer_load_dwordx4 v[140:143], v10, s[28:31], s61 offen offset:0 sc1
    s_waitcnt vmcnt(12)
    s_waitcnt lgkmcnt(3)
    v_mfma_f32_16x16x32_bf16 v[64:67], v[200:203], v[144:147], v[64:67]
    v_mfma_f32_16x16x32_bf16 v[84:87], v[200:203], v[148:151], v[84:87]
    ds_read_b128 v[220:223], v8 offset:20480
    ds_read_b128 v[224:227], v8 offset:21504
    v_mfma_f32_16x16x32_bf16 v[68:71], v[204:207], v[144:147], v[68:71]
    v_mfma_f32_16x16x32_bf16 v[88:91], v[204:207], v[148:151], v[88:91]
    ds_read_b128 v[228:231], v8 offset:22528
    ds_read_b128 v[232:235], v8 offset:23552
    s_waitcnt lgkmcnt(5)
    v_mfma_f32_16x16x32_bf16 v[72:75], v[208:211], v[144:147], v[72:75]
    v_mfma_f32_16x16x32_bf16 v[92:95], v[208:211], v[148:151], v[92:95]
    ds_read_b128 v[236:239], v8 offset:24576
    s_barrier
    v_mfma_f32_16x16x32_bf16 v[76:79], v[212:215], v[144:147], v[76:79]
    v_mfma_f32_16x16x32_bf16 v[96:99], v[212:215], v[148:151], v[96:99]
    s_waitcnt lgkmcnt(5)
    v_mfma_f32_16x16x32_bf16 v[80:83], v[216:219], v[144:147], v[80:83]
    v_mfma_f32_16x16x32_bf16 v[100:103], v[216:219], v[148:151], v[100:103]
    buffer_load_dwordx4 v[144:147], v10, s[28:31], s60 offen offset:2048 sc1
    buffer_load_dwordx4 v[148:151], v10, s[28:31], s61 offen offset:2048 sc1
    s_waitcnt vmcnt(12)
    s_waitcnt lgkmcnt(3)
    v_mfma_f32_16x16x32_bf16 v[64:67], v[220:223], v[152:155], v[64:67]
    v_mfma_f32_16x16x32_bf16 v[84:87], v[220:223], v[156:159], v[84:87]
    ds_read_b128 v[200:203], v8 offset:30720
    ds_read_b128 v[204:207], v8 offset:31744
    v_mfma_f32_16x16x32_bf16 v[68:71], v[224:227], v[152:155], v[68:71]
    v_mfma_f32_16x16x32_bf16 v[88:91], v[224:227], v[156:159], v[88:91]
    ds_read_b128 v[208:211], v8 offset:32768
    ds_read_b128 v[212:215], v8 offset:33792
    s_waitcnt lgkmcnt(5)
    v_mfma_f32_16x16x32_bf16 v[72:75], v[228:231], v[152:155], v[72:75]
    v_mfma_f32_16x16x32_bf16 v[92:95], v[228:231], v[156:159], v[92:95]
    ds_read_b128 v[216:219], v8 offset:34816
    v_mfma_f32_16x16x32_bf16 v[76:79], v[232:235], v[152:155], v[76:79]
    v_mfma_f32_16x16x32_bf16 v[96:99], v[232:235], v[156:159], v[96:99]
    s_waitcnt lgkmcnt(5)
    v_mfma_f32_16x16x32_bf16 v[80:83], v[236:239], v[152:155], v[80:83]
    v_mfma_f32_16x16x32_bf16 v[100:103], v[236:239], v[156:159], v[100:103]
    s_add_u32 s60, s58, 49152
    s_add_u32 s61, s59, 49152
    buffer_load_dwordx4 v[152:155], v10, s[28:31], s60 offen offset:0 sc1
    buffer_load_dwordx4 v[156:159], v10, s[28:31], s61 offen offset:0 sc1
    s_waitcnt vmcnt(12)
    s_waitcnt lgkmcnt(3)
    v_mfma_f32_16x16x32_bf16 v[64:67], v[200:203], v[160:163], v[64:67]
    v_mfma_f32_16x16x32_bf16 v[84:87], v[200:203], v[164:167], v[84:87]
    ds_read_b128 v[220:223], v8 offset:40960
    ds_read_b128 v[224:227], v8 offset:41984
    v_mfma_f32_16x16x32_bf16 v[68:71], v[204:207], v[160:163], v[68:71]
    v_mfma_f32_16x16x32_bf16 v[88:91], v[204:207], v[164:167], v[88:91]
    ds_read_b128 v[228:231], v8 offset:43008
    ds_read_b128 v[232:235], v8 offset:44032
    s_waitcnt lgkmcnt(5)
    v_mfma_f32_16x16x32_bf16 v[72:75], v[208:211], v[160:163], v[72:75]
    v_mfma_f32_16x16x32_bf16 v[92:95], v[208:211], v[164:167], v[92:95]
    ds_read_b128 v[236:239], v8 offset:45056
    v_mfma_f32_16x16x32_bf16 v[76:79], v[212:215], v[160:163], v[76:79]
    v_mfma_f32_16x16x32_bf16 v[96:99], v[212:215], v[164:167], v[96:99]
    s_waitcnt lgkmcnt(5)
    v_mfma_f32_16x16x32_bf16 v[80:83], v[216:219], v[160:163], v[80:83]
    v_mfma_f32_16x16x32_bf16 v[100:103], v[216:219], v[164:167], v[100:103]
    buffer_load_dwordx4 v[160:163], v10, s[28:31], s60 offen offset:2048 sc1
    buffer_load_dwordx4 v[164:167], v10, s[28:31], s61 offen offset:2048 sc1
    s_waitcnt vmcnt(12)
    s_waitcnt lgkmcnt(3)
    v_mfma_f32_16x16x32_bf16 v[64:67], v[220:223], v[168:171], v[64:67]
    v_mfma_f32_16x16x32_bf16 v[84:87], v[220:223], v[172:175], v[84:87]
    ds_read_b128 v[200:203], v8 offset:51200
    ds_read_b128 v[204:207], v8 offset:52224
    v_mfma_f32_16x16x32_bf16 v[68:71], v[224:227], v[168:171], v[68:71]
    v_mfma_f32_16x16x32_bf16 v[88:91], v[224:227], v[172:175], v[88:91]
    ds_read_b128 v[208:211], v8 offset:53248
    ds_read_b128 v[212:215], v8 offset:54272
    s_waitcnt lgkmcnt(5)
    v_mfma_f32_16x16x32_bf16 v[72:75], v[228:231], v[168:171], v[72:75]
    v_mfma_f32_16x16x32_bf16 v[92:95], v[228:231], v[172:175], v[92:95]
    ds_read_b128 v[216:219], v8 offset:55296
    s_barrier
    v_mfma_f32_16x16x32_bf16 v[76:79], v[232:235], v[168:171], v[76:79]
    v_mfma_f32_16x16x32_bf16 v[96:99], v[232:235], v[172:175], v[96:99]
    s_waitcnt lgkmcnt(5)
    v_mfma_f32_16x16x32_bf16 v[80:83], v[236:239], v[168:171], v[80:83]
    v_mfma_f32_16x16x32_bf16 v[100:103], v[236:239], v[172:175], v[100:103]
    s_add_u32 s60, s58, 53248
    s_add_u32 s61, s59, 53248
    buffer_load_dwordx4 v[168:171], v10, s[28:31], s60 offen offset:0 sc1
    buffer_load_dwordx4 v[172:175], v10, s[28:31], s61 offen offset:0 sc1
    s_waitcnt vmcnt(12)
    s_waitcnt lgkmcnt(3)
    v_mfma_f32_16x16x32_bf16 v[64:67], v[200:203], v[176:179], v[64:67]
    v_mfma_f32_16x16x32_bf16 v[84:87], v[200:203], v[180:183], v[84:87]
    ds_read_b128 v[220:223], v11 offset:0
    ds_read_b128 v[224:227], v11 offset:1024
    v_mfma_f32_16x16x32_bf16 v[68:71], v[204:207], v[176:179], v[68:71]
    v_mfma_f32_16x16x32_bf16 v[88:91], v[204:207], v[180:183], v[88:91]
    ds_read_b128 v[228:231], v11 offset:2048
    ds_read_b128 v[232:235], v11 offset:3072
    s_waitcnt lgkmcnt(5)
    v_mfma_f32_16x16x32_bf16 v[72:75], v[208:211], v[176:179], v[72:75]
    v_mfma_f32_16x16x32_bf16 v[92:95], v[208:211], v[180:183], v[92:95]
    ds_read_b128 v[236:239], v11 offset:4096
    v_mfma_f32_16x16x32_bf16 v[76:79], v[212:215], v[176:179], v[76:79]
    v_mfma_f32_16x16x32_bf16 v[96:99], v[212:215], v[180:183], v[96:99]
    s_waitcnt lgkmcnt(5)
    v_mfma_f32_16x16x32_bf16 v[80:83], v[216:219], v[176:179], v[80:83]
    v_mfma_f32_16x16x32_bf16 v[100:103], v[216:219], v[180:183], v[100:103]
    s_waitcnt vmcnt(10)
    s_waitcnt lgkmcnt(3)
    v_mfma_f32_16x16x32_bf16 v[64:67], v[220:223], v[128:131], v[64:67]
    v_mfma_f32_16x16x32_bf16 v[84:87], v[220:223], v[132:135], v[84:87]
    ds_read_b128 v[200:203], v11 offset:10240
    ds_read_b128 v[204:207], v11 offset:11264
    v_mfma_f32_16x16x32_bf16 v[68:71], v[224:227], v[128:131], v[68:71]
    v_mfma_f32_16x16x32_bf16 v[88:91], v[224:227], v[132:135], v[88:91]
    ds_read_b128 v[208:211], v11 offset:12288
    ds_read_b128 v[212:215], v11 offset:13312
    s_waitcnt lgkmcnt(5)
    v_mfma_f32_16x16x32_bf16 v[72:75], v[228:231], v[128:131], v[72:75]
    v_mfma_f32_16x16x32_bf16 v[92:95], v[228:231], v[132:135], v[92:95]
    ds_read_b128 v[216:219], v11 offset:14336
    v_mfma_f32_16x16x32_bf16 v[76:79], v[232:235], v[128:131], v[76:79]
    v_mfma_f32_16x16x32_bf16 v[96:99], v[232:235], v[132:135], v[96:99]
    s_waitcnt lgkmcnt(5)
    v_mfma_f32_16x16x32_bf16 v[80:83], v[236:239], v[128:131], v[80:83]
    v_mfma_f32_16x16x32_bf16 v[100:103], v[236:239], v[132:135], v[100:103]
    s_waitcnt vmcnt(8)
    s_waitcnt lgkmcnt(3)
    v_mfma_f32_16x16x32_bf16 v[64:67], v[200:203], v[136:139], v[64:67]
    v_mfma_f32_16x16x32_bf16 v[84:87], v[200:203], v[140:143], v[84:87]
    ds_read_b128 v[220:223], v11 offset:20480
    ds_read_b128 v[224:227], v11 offset:21504
    v_mfma_f32_16x16x32_bf16 v[68:71], v[204:207], v[136:139], v[68:71]
    v_mfma_f32_16x16x32_bf16 v[88:91], v[204:207], v[140:143], v[88:91]
    ds_read_b128 v[228:231], v11 offset:22528
    ds_read_b128 v[232:235], v11 offset:23552
    s_waitcnt lgkmcnt(5)
    v_mfma_f32_16x16x32_bf16 v[72:75], v[208:211], v[136:139], v[72:75]
    v_mfma_f32_16x16x32_bf16 v[92:95], v[208:211], v[140:143], v[92:95]
    ds_read_b128 v[236:239], v11 offset:24576
    s_barrier
    v_mfma_f32_16x16x32_bf16 v[76:79], v[212:215], v[136:139], v[76:79]
    v_mfma_f32_16x16x32_bf16 v[96:99], v[212:215], v[140:143], v[96:99]
    s_waitcnt lgkmcnt(5)
    v_mfma_f32_16x16x32_bf16 v[80:83], v[216:219], v[136:139], v[80:83]
    v_mfma_f32_16x16x32_bf16 v[100:103], v[216:219], v[140:143], v[100:103]
    s_waitcnt vmcnt(6)
    s_waitcnt lgkmcnt(3)
    v_mfma_f32_16x16x32_bf16 v[64:67], v[220:223], v[144:147], v[64:67]
    v_mfma_f32_16x16x32_bf16 v[84:87], v[220:223], v[148:151], v[84:87]
    ds_read_b128 v[200:203], v11 offset:30720
    ds_read_b128 v[204:207], v11 offset:31744
    v_mfma_f32_16x16x32_bf16 v[68:71], v[224:227], v[144:147], v[68:71]
    v_mfma_f32_16x16x32_bf16 v[88:91], v[224:227], v[148:151], v[88:91]
    ds_read_b128 v[208:211], v11 offset:32768
    ds_read_b128 v[212:215], v11 offset:33792
    s_waitcnt lgkmcnt(5)
    v_mfma_f32_16x16x32_bf16 v[72:75], v[228:231], v[144:147], v[72:75]
    v_mfma_f32_16x16x32_bf16 v[92:95], v[228:231], v[148:151], v[92:95]
    ds_read_b128 v[216:219], v11 offset:34816
    v_mfma_f32_16x16x32_bf16 v[76:79], v[232:235], v[144:147], v[76:79]
    v_mfma_f32_16x16x32_bf16 v[96:99], v[232:235], v[148:151], v[96:99]
    s_waitcnt lgkmcnt(5)
    v_mfma_f32_16x16x32_bf16 v[80:83], v[236:239], v[144:147], v[80:83]
    v_mfma_f32_16x16x32_bf16 v[100:103], v[236:239], v[148:151], v[100:103]
    s_waitcnt vmcnt(4)
    s_waitcnt lgkmcnt(3)
    v_mfma_f32_16x16x32_bf16 v[64:67], v[200:203], v[152:155], v[64:67]
    v_mfma_f32_16x16x32_bf16 v[84:87], v[200:203], v[156:159], v[84:87]
    ds_read_b128 v[220:223], v11 offset:40960
    ds_read_b128 v[224:227], v11 offset:41984
    v_mfma_f32_16x16x32_bf16 v[68:71], v[204:207], v[152:155], v[68:71]
    v_mfma_f32_16x16x32_bf16 v[88:91], v[204:207], v[156:159], v[88:91]
    ds_read_b128 v[228:231], v11 offset:43008
    ds_read_b128 v[232:235], v11 offset:44032
    s_waitcnt lgkmcnt(5)
    v_mfma_f32_16x16x32_bf16 v[72:75], v[208:211], v[152:155], v[72:75]
    v_mfma_f32_16x16x32_bf16 v[92:95], v[208:211], v[156:159], v[92:95]
    ds_read_b128 v[236:239], v11 offset:45056
    v_mfma_f32_16x16x32_bf16 v[76:79], v[212:215], v[152:155], v[76:79]
    v_mfma_f32_16x16x32_bf16 v[96:99], v[212:215], v[156:159], v[96:99]
    s_waitcnt lgkmcnt(5)
    v_mfma_f32_16x16x32_bf16 v[80:83], v[216:219], v[152:155], v[80:83]
    v_mfma_f32_16x16x32_bf16 v[100:103], v[216:219], v[156:159], v[100:103]
    s_waitcnt vmcnt(2)
    s_waitcnt lgkmcnt(3)
    v_mfma_f32_16x16x32_bf16 v[64:67], v[220:223], v[160:163], v[64:67]
    v_mfma_f32_16x16x32_bf16 v[84:87], v[220:223], v[164:167], v[84:87]
    ds_read_b128 v[200:203], v11 offset:51200
    ds_read_b128 v[204:207], v11 offset:52224
    v_mfma_f32_16x16x32_bf16 v[68:71], v[224:227], v[160:163], v[68:71]
    v_mfma_f32_16x16x32_bf16 v[88:91], v[224:227], v[164:167], v[88:91]
    ds_read_b128 v[208:211], v11 offset:53248
    ds_read_b128 v[212:215], v11 offset:54272
    s_waitcnt lgkmcnt(5)
    v_mfma_f32_16x16x32_bf16 v[72:75], v[228:231], v[160:163], v[72:75]
    v_mfma_f32_16x16x32_bf16 v[92:95], v[228:231], v[164:167], v[92:95]
    ds_read_b128 v[216:219], v11 offset:55296
    v_mfma_f32_16x16x32_bf16 v[76:79], v[232:235], v[160:163], v[76:79]
    v_mfma_f32_16x16x32_bf16 v[96:99], v[232:235], v[164:167], v[96:99]
    s_waitcnt lgkmcnt(5)
    v_mfma_f32_16x16x32_bf16 v[80:83], v[236:239], v[160:163], v[80:83]
    v_mfma_f32_16x16x32_bf16 v[100:103], v[236:239], v[164:167], v[100:103]
    s_waitcnt vmcnt(0)
    s_waitcnt lgkmcnt(3)
    v_mfma_f32_16x16x32_bf16 v[64:67], v[200:203], v[168:171], v[64:67]
    v_mfma_f32_16x16x32_bf16 v[84:87], v[200:203], v[172:175], v[84:87]
    v_mfma_f32_16x16x32_bf16 v[68:71], v[204:207], v[168:171], v[68:71]
    v_mfma_f32_16x16x32_bf16 v[88:91], v[204:207], v[172:175], v[88:91]
    s_waitcnt lgkmcnt(1)
    v_mfma_f32_16x16x32_bf16 v[72:75], v[208:211], v[168:171], v[72:75]
    v_mfma_f32_16x16x32_bf16 v[92:95], v[208:211], v[172:175], v[92:95]
    v_mfma_f32_16x16x32_bf16 v[76:79], v[212:215], v[168:171], v[76:79]
    v_mfma_f32_16x16x32_bf16 v[96:99], v[212:215], v[172:175], v[96:99]
    s_waitcnt lgkmcnt(0)
    v_mfma_f32_16x16x32_bf16 v[80:83], v[216:219], v[168:171], v[80:83]
    v_mfma_f32_16x16x32_bf16 v[100:103], v[216:219], v[172:175], v[100:103]
    ds_write_b128 v14, v[84:87] offset:0
    ds_write_b128 v14, v[88:91] offset:1024
    s_nop 0
    ds_write_b128 v14, v[92:95] offset:2048
    s_nop 0
    ds_write_b128 v14, v[96:99] offset:3072
    s_nop 1
    ds_write_b128 v14, v[100:103] offset:4096
    s_lshl_b32 s57, s48, 2
    s_add_u32 s57, s57, 161360
    v_mov_b32 v12, s57
    v_mov_b32 v13, 2
    ds_write_b32 v12, v13
    s_xor_b32 s57, s48, 1
    s_lshl_b32 s57, s57, 2
    s_add_u32 s57, s57, 161360
    v_mov_b32 v20, s57
    s_mov_b32 s93, 0
L_lw_24:
    ds_read_b32 v16, v20
    s_waitcnt lgkmcnt(0)
    v_readfirstlane_b32 s57, v16
    s_add_u32 s93, s93, 1
    s_cmp_gt_u32 s93, 200000
    s_cbranch_scc1 L_lw_24_x
    s_nop 0
    s_cmp_lt_u32 s57, 2
    s_cbranch_scc1 L_lw_24
L_lw_24_x:
    ds_read_b128 v[84:87], v15 offset:0
    ds_read_b128 v[88:91], v15 offset:1024
    ds_read_b128 v[92:95], v15 offset:2048
    ds_read_b128 v[96:99], v15 offset:3072
    ds_read_b128 v[100:103], v15 offset:4096
    s_mul_i32 s57, s89, 160
    s_waitcnt lgkmcnt(4)
    v_add_f32 v64, v64, v84
    v_add_f32 v65, v65, v85
    v_add_f32 v66, v66, v86
    v_add_f32 v67, v67, v87
    v_cvt_pk_bf16_f32 v36, v64, v65
    v_cvt_pk_bf16_f32 v37, v66, v67
    s_waitcnt lgkmcnt(3)
    v_add_f32 v68, v68, v88
    v_add_f32 v69, v69, v89
    v_add_f32 v70, v70, v90
    v_add_f32 v71, v71, v91
    v_cvt_pk_bf16_f32 v38, v68, v69
    v_cvt_pk_bf16_f32 v39, v70, v71
    buffer_store_dwordx4 v[36:39], v5, s[32:35], s57 offen
    s_waitcnt lgkmcnt(2)
    v_add_f32 v72, v72, v92
    v_add_f32 v73, v73, v93
    v_add_f32 v74, v74, v94
    v_add_f32 v75, v75, v95
    v_cvt_pk_bf16_f32 v40, v72, v73
    v_cvt_pk_bf16_f32 v41, v74, v75
    s_waitcnt lgkmcnt(1)
    v_add_f32 v76, v76, v96
    v_add_f32 v77, v77, v97
    v_add_f32 v78, v78, v98
    v_add_f32 v79, v79, v99
    v_cvt_pk_bf16_f32 v42, v76, v77
    v_cvt_pk_bf16_f32 v43, v78, v79
    buffer_store_dwordx4 v[40:43], v5, s[32:35], s57 offen offset:16
    s_waitcnt lgkmcnt(0)
    v_add_f32 v80, v80, v100
    v_add_f32 v81, v81, v101
    v_add_f32 v82, v82, v102
    v_add_f32 v83, v83, v103
    v_cvt_pk_bf16_f32 v44, v80, v81
    v_cvt_pk_bf16_f32 v45, v82, v83
    buffer_store_dwordx2 v[44:45], v5, s[32:35], s57 offen offset:32
    s_endpgm
L_ATT:
    v_mov_b32 v8, 161288
    ds_read_b32 v9, v8
    v_lshrrev_b32 v2, 5, v1
    v_and_b32 v3, 31, v1
    s_mul_i32 s57, s50, 5
    s_add_u32 s57, s57, 1
    s_lshr_b32 s57, s57, 1
    s_and_b32 s58, s50, 1
    s_add_u32 s59, s57, 2
    s_sub_u32 s60, s57, 1
    s_cmp_eq_u32 s58, 0
    s_cselect_b32 s59, s59, s60
    s_lshl_b32 s58, s58, 3
    s_lshl_b32 s57, s57, 9
    s_lshl_b32 s59, s59, 9
    v_lshlrev_b32 v4, 4, v1
    v_mul_u32_u24 v5, 2560, v2
    v_add_u32 v5, v5, v3
    v_lshlrev_b32 v5, 4, v5
    v_add_u32 v5, s58, v5
    s_lshl_b32 s60, s49, 3
    s_lshl_b32 s61, s48, 1
    s_add_u32 s60, s60, s61
    s_add_u32 s60, s60, 0
    s_sub_u32 s60, s60, 8
    s_max_i32 s60, s60, 0
    s_mul_i32 s61, s60, 122880
    s_add_u32 s62, s57, s61
    s_add_u32 s62, s62, 40960
    buffer_load_dwordx4 v[16:19], v4, s[28:31], s62 offen sc1
    s_add_u32 s62, s62, 40960
    buffer_load_dwordx4 v[24:27], v4, s[28:31], s62 offen sc1
    s_add_u32 s62, s59, s61
    s_add_u32 s62, s62, 40960
    buffer_load_dwordx2 v[32:33], v5, s[28:31], s62 offen sc1
    s_lshl_b32 s60, s49, 3
    s_lshl_b32 s61, s48, 1
    s_add_u32 s60, s60, s61
    s_add_u32 s60, s60, 1
    s_sub_u32 s60, s60, 8
    s_max_i32 s60, s60, 0
    s_mul_i32 s61, s60, 122880
    s_add_u32 s62, s57, s61
    s_add_u32 s62, s62, 40960
    buffer_load_dwordx4 v[20:23], v4, s[28:31], s62 offen sc1
    s_add_u32 s62, s62, 40960
    buffer_load_dwordx4 v[28:31], v4, s[28:31], s62 offen sc1
    s_add_u32 s62, s59, s61
    s_add_u32 s62, s62, 40960
    buffer_load_dwordx2 v[36:37], v5, s[28:31], s62 offen sc1
    s_lshl_b32 s60, s49, 3
    s_add_u32 s60, s60, s48
    s_mul_i32 s61, s60, 122880
    s_add_u32 s62, s57, s61
    buffer_load_dwordx4 v[192:195], v4, s[28:31], s62 offen sc1
    s_add_u32 s62, s59, s61
    buffer_load_dwordx2 v[196:197], v5, s[28:31], s62 offen sc1
    s_waitcnt lgkmcnt(0)
    v_readfirstlane_b32 s52, v9
    v_cmp_le_u32 s[88:89], 32, v1
    v_mov_b32 v34, 0
    v_mov_b32 v35, 0
    v_mov_b32 v39, 0
    v_mov_b32 v6, 0x3f80
    v_cndmask_b32 v34, v34, v6, s[88:89]
    v_mov_b32 v38, v34
    v_mov_b32 v6, 0xf149f2ca
    v_mov_b32 v7, 0
    v_lshlrev_b32 v40, 2, v2
    v_sub_u32 v40, v3, v40
    v_cmp_le_i32 vcc, 0, v40
    s_nop 1
    v_cndmask_b32 v128, v6, v7, vcc
    v_cndmask_b32 v144, v7, v6, vcc
    v_cmp_le_i32 vcc, 1, v40
    s_nop 1
    v_cndmask_b32 v129, v6, v7, vcc
    v_cndmask_b32 v145, v7, v6, vcc
    v_cmp_le_i32 vcc, 2, v40
    s_nop 1
    v_cndmask_b32 v130, v6, v7, vcc
    v_cndmask_b32 v146, v7, v6, vcc
    v_cmp_le_i32 vcc, 3, v40
    s_nop 1
    v_cndmask_b32 v131, v6, v7, vcc
    v_cndmask_b32 v147, v7, v6, vcc
    v_cmp_le_i32 vcc, 8, v40
    s_nop 1
    v_cndmask_b32 v132, v6, v7, vcc
    v_cndmask_b32 v148, v7, v6, vcc
    v_cmp_le_i32 vcc, 9, v40
    s_nop 1
    v_cndmask_b32 v133, v6, v7, vcc
    v_cndmask_b32 v149, v7, v6, vcc
    v_cmp_le_i32 vcc, 10, v40
    s_nop 1
    v_cndmask_b32 v134, v6, v7, vcc
    v_cndmask_b32 v150, v7, v6, vcc
    v_cmp_le_i32 vcc, 11, v40
    s_nop 1
    v_cndmask_b32 v135, v6, v7, vcc
    v_cndmask_b32 v151, v7, v6, vcc
    v_cmp_le_i32 vcc, 16, v40
    s_nop 1
    v_cndmask_b32 v136, v6, v7, vcc
    v_cndmask_b32 v152, v7, v6, vcc
    v_cmp_le_i32 vcc, 17, v40
    s_nop 1
    v_cndmask_b32 v137, v6, v7, vcc
    v_cndmask_b32 v153, v7, v6, vcc
    v_cmp_le_i32 vcc, 18, v40
    s_nop 1
    v_cndmask_b32 v138, v6, v7, vcc
    v_cndmask_b32 v154, v7, v6, vcc
    v_cmp_le_i32 vcc, 19, v40
    s_nop 1
    v_cndmask_b32 v139, v6, v7, vcc
    v_cndmask_b32 v155, v7, v6, vcc
    v_cmp_le_i32 vcc, 24, v40
    s_nop 1
    v_cndmask_b32 v140, v6, v7, vcc
    v_cndmask_b32 v156, v7, v6, vcc
    v_cmp_le_i32 vcc, 25, v40
    s_nop 1
    v_cndmask_b32 v141, v6, v7, vcc
    v_cndmask_b32 v157, v7, v6, vcc
    v_cmp_le_i32 vcc, 26, v40
    s_nop 1
    v_cndmask_b32 v142, v6, v7, vcc
    v_cndmask_b32 v158, v7, v6, vcc
    v_cmp_le_i32 vcc, 27, v40
    s_nop 1
    v_cndmask_b32 v143, v6, v7, vcc
    v_cndmask_b32 v159, v7, v6, vcc
    s_lshl_b32 s60, s48, 11
    s_add_u32 s60, s60, 102400
    v_lshlrev_b32 v41, 4, v1
    v_add_u32 v41, s60, v41
    s_lshl_b32 s60, s48, 10
    s_add_u32 s60, s60, 118784
    v_lshlrev_b32 v42, 3, v1
    v_add_u32 v42, s60, v42
    s_lshl_b32 s60, s48, 12
    s_add_u32 s60, s60, 126976
    v_lshlrev_b32 v43, 6, v3
    v_add_u32 v43, s60, v43
    v_lshl_add_u32 v44, v2, 4, v43
    v_lshlrev_b32 v45, 4, v2
    v_sub_u32 v45, v43, v45
    v_add_u32 v45, 48, v45
    v_mov_b32 v48, 0
    s_lshl_b32 s61, s48, 10
    s_add_u32 s61, s61, 102400
    v_lshlrev_b32 v50, 4, v1
    v_add_u32 v50, s61, v50
    s_lshl_b32 s61, s48, 9
    s_add_u32 s61, s61, 118784
    v_lshlrev_b32 v51, 3, v1
    v_add_u32 v51, s61, v51
    v_bfe_u32 v6, v1, 2, 2
    v_lshl_add_u32 v6, v2, 2, v6
    v_lshlrev_b32 v6, 6, v6
    v_bfe_u32 v7, v1, 4, 1
    v_lshlrev_b32 v7, 5, v7
    v_and_b32 v53, 3, v1
    v_lshl_add_u32 v7, v53, 3, v7
    v_add_u32 v6, v6, v7
    s_lshl_b32 s61, s48, 11
    s_add_u32 s61, s61, 126976
    v_add_u32 v53, s61, v6
    v_mov_b32 v171, 0x3f80
    v_mov_b32 v175, 0x3f80
    v_mov_b32 v54, 0xff61b1e6
    s_mov_b32 s90, 0
    s_lshl_b32 s91, s49, 3
    s_add_u32 s91, s91, s48
    s_and_b32 s60, s50, 7
    s_mul_i32 s61, s60, 10
    s_add_u32 s61, s61, s48
    s_mul_i32 s60, s60, 102400
    s_add_u32 s92, s60, 23068672
    s_cmp_ge_u32 s61, 100
    s_cselect_b32 s62, 100, 0
    s_sub_u32 s86, s61, s62
    s_lshl_b32 s93, s48, 10
    s_add_u32 s86, s92, s93
    v_lshlrev_b32 v47, 4, v1
    s_waitcnt vmcnt(2)
    ds_write_b128 v41, v[16:19] offset:0
    ds_write_b128 v44, v[24:27] offset:0
    v_cndmask_b32 v62, v32, v48, s[88:89]
    v_cndmask_b32 v63, v33, v48, s[88:89]
    ds_write_b64 v42, v[62:63] offset:0
    v_cndmask_b32 v32, v48, v32, s[88:89]
    v_cndmask_b32 v33, v48, v33, s[88:89]
    ds_write_b128 v45, v[32:35] offset:0
    ds_write_b128 v41, v[20:23] offset:1024
    ds_write_b128 v44, v[28:31] offset:2048
    v_cndmask_b32 v62, v36, v48, s[88:89]
    v_cndmask_b32 v63, v37, v48, s[88:89]
    ds_write_b64 v42, v[62:63] offset:512
    v_cndmask_b32 v36, v48, v36, s[88:89]
    v_cndmask_b32 v37, v48, v37, s[88:89]
    ds_write_b128 v45, v[36:39] offset:2048
    s_waitcnt lgkmcnt(0)
    s_barrier
    s_waitcnt vmcnt(0)
    v_cndmask_b32 v196, v196, v48, s[88:89]
    v_cndmask_b32 v197, v197, v48, s[88:89]
    s_mov_b32 s98, 0x3f80
    s_mov_b32 s99, 0x3f803f80
L_ATT_MAIN:
    v_mov_b32 v198, 0xf1490000
    v_cndmask_b32 v198, v198, v48, s[88:89]
    v_mov_b32 v199, 0
    ds_read_b128 v[160:163], v50 offset:8192
    ds_read_b64 v[168:169], v51 offset:4096
    s_cmp_ge_u32 s91, 0
    s_cselect_b32 s60, s98, s99
    v_mov_b32 v170, s60
    ds_read_b128 v[164:167], v50 offset:7168
    ds_read_b64 v[172:173], v51 offset:3584
    s_cmp_ge_u32 s91, 1
    s_cselect_b32 s60, s98, s99
    v_mov_b32 v174, s60
    s_waitcnt lgkmcnt(2)
    v_mfma_f32_32x32x16_bf16 v[64:79], v[160:163], v[192:195], v[128:143]
    v_mfma_f32_32x32x16_bf16 v[64:79], v[168:171], v[196:199], v[64:79]
    v_mov_b32 v59, v54
    s_nop 10
    v_max3_f32 v59, v64, v65, v59
    v_max3_f32 v59, v66, v67, v59
    v_max3_f32 v59, v68, v69, v59
    v_max3_f32 v59, v70, v71, v59
    v_max3_f32 v59, v72, v73, v59
    v_max3_f32 v59, v74, v75, v59
    v_max3_f32 v59, v76, v77, v59
    v_max3_f32 v59, v78, v79, v59
    v_mov_b32 v60, v59
    s_nop 1
    v_permlane32_swap_b32 v59, v60
    v_max_f32 v59, v59, v60
    v_sub_f32 v59, 0, v59
    v_cvt_pk_bf16_f32 v60, v59, v59
    v_and_b32 v60, 0xffff, v60
    v_or_b32 v198, 0xf1490000, v60
    v_lshlrev_b32 v60, 16, v60
    v_sub_f32 v61, v59, v60
    v_cvt_pk_bf16_f32 v61, v61, v61
    v_and_b32 v199, 0xffff, v61
    v_lshlrev_b32 v61, 16, v199
    v_add_f32 v59, v60, v61
    v_cndmask_b32 v198, v198, v48, s[88:89]
    v_cndmask_b32 v199, v199, v48, s[88:89]
    s_waitcnt lgkmcnt(0)
    v_mfma_f32_32x32x16_bf16 v[80:95], v[164:167], v[192:195], 0
    v_add_f32 v64, v59, v64
    v_exp_f32 v64, v64
    v_add_f32 v65, v59, v65
    v_exp_f32 v65, v65
    v_add_f32 v66, v59, v66
    v_exp_f32 v66, v66
    v_add_f32 v67, v59, v67
    v_exp_f32 v67, v67
    v_mfma_f32_32x32x16_bf16 v[80:95], v[172:175], v[196:199], v[80:95]
    ds_read_b128 v[160:163], v50 offset:6144
    ds_read_b64 v[168:169], v51 offset:3072
    s_cmp_ge_u32 s91, 2
    s_cselect_b32 s60, s98, s99
    v_mov_b32 v170, s60
    v_add_f32 v68, v59, v68
    v_exp_f32 v68, v68
    v_add_f32 v69, v59, v69
    v_exp_f32 v69, v69
    v_add_f32 v70, v59, v70
    v_exp_f32 v70, v70
    v_add_f32 v71, v59, v71
    v_exp_f32 v71, v71
    ds_read_b64_tr_b16 v[176:177], v53 offset:16384
    ds_read_b64_tr_b16 v[178:179], v53 offset:16896
    ds_read_b64_tr_b16 v[180:181], v53 offset:17408
    ds_read_b64_tr_b16 v[182:183], v53 offset:17920
    v_add_f32 v72, v59, v72
    v_exp_f32 v72, v72
    v_add_f32 v73, v59, v73
    v_exp_f32 v73, v73
    v_add_f32 v74, v59, v74
    v_exp_f32 v74, v74
    v_add_f32 v75, v59, v75
    v_exp_f32 v75, v75
    s_cmp_lg_u32 s90, 0
    s_cbranch_scc1 L_A_nodma0
    s_add_u32 m0, s93, 0
    s_add_u32 s62, s86, 0
    buffer_load_dwordx4 v47, s[28:31], s62 offen sc1 lds
    s_add_u32 m0, s93, 8192
    s_add_u32 s62, s86, 8192
    buffer_load_dwordx4 v47, s[28:31], s62 offen sc1 lds
L_A_nodma0:
    v_add_f32 v76, v59, v76
    v_exp_f32 v76, v76
    v_add_f32 v77, v59, v77
    v_exp_f32 v77, v77
    v_add_f32 v78, v59, v78
    v_exp_f32 v78, v78
    v_add_f32 v79, v59, v79
    v_exp_f32 v79, v79
    v_cvt_pk_bf16_f32 v112, v64, v65
    v_cvt_pk_bf16_f32 v113, v66, v67
    v_cvt_pk_bf16_f32 v114, v68, v69
    v_cvt_pk_bf16_f32 v115, v70, v71
    v_cvt_pk_bf16_f32 v116, v72, v73
    v_cvt_pk_bf16_f32 v117, v74, v75
    v_cvt_pk_bf16_f32 v118, v76, v77
    v_cvt_pk_bf16_f32 v119, v78, v79
    s_waitcnt lgkmcnt(0)
    v_mfma_f32_32x32x16_bf16 v[64:79], v[160:163], v[192:195], 0
    v_exp_f32 v80, v80
    v_exp_f32 v81, v81
    v_exp_f32 v82, v82
    v_exp_f32 v83, v83
    v_mfma_f32_32x32x16_bf16 v[64:79], v[168:171], v[196:199], v[64:79]
    ds_read_b128 v[164:167], v50 offset:5120
    ds_read_b64 v[172:173], v51 offset:2560
    s_cmp_ge_u32 s91, 3
    s_cselect_b32 s60, s98, s99
    v_mov_b32 v174, s60
    v_exp_f32 v84, v84
    v_exp_f32 v85, v85
    v_exp_f32 v86, v86
    v_exp_f32 v87, v87
    v_mfma_f32_32x32x16_bf16 v[96:111], v[176:179], v[112:115], 0
    ds_read_b64_tr_b16 v[184:185], v53 offset:14336
    ds_read_b64_tr_b16 v[186:187], v53 offset:14848
    ds_read_b64_tr_b16 v[188:189], v53 offset:15360
    ds_read_b64_tr_b16 v[190:191], v53 offset:15872
    v_exp_f32 v88, v88
    v_exp_f32 v89, v89
    v_exp_f32 v90, v90
    v_exp_f32 v91, v91
    v_mfma_f32_32x32x16_bf16 v[96:111], v[180:183], v[116:119], v[96:111]
    s_cmp_lg_u32 s90, 0
    s_cbranch_scc1 L_A_nodma1
    s_add_u32 m0, s93, 16384
    s_add_u32 s62, s86, 16384
    buffer_load_dwordx4 v47, s[28:31], s62 offen sc1 lds
    s_add_u32 m0, s93, 24576
    s_add_u32 s62, s86, 24576
    buffer_load_dwordx4 v47, s[28:31], s62 offen sc1 lds
L_A_nodma1:
    v_exp_f32 v92, v92
    v_exp_f32 v93, v93
    v_exp_f32 v94, v94
    v_exp_f32 v95, v95
    v_cvt_pk_bf16_f32 v120, v80, v81
    v_cvt_pk_bf16_f32 v121, v82, v83
    v_cvt_pk_bf16_f32 v122, v84, v85
    v_cvt_pk_bf16_f32 v123, v86, v87
    v_cvt_pk_bf16_f32 v124, v88, v89
    v_cvt_pk_bf16_f32 v125, v90, v91
    v_cvt_pk_bf16_f32 v126, v92, v93
    v_cvt_pk_bf16_f32 v127, v94, v95
    s_waitcnt lgkmcnt(0)
    v_mfma_f32_32x32x16_bf16 v[80:95], v[164:167], v[192:195], 0
    v_exp_f32 v64, v64
    v_exp_f32 v65, v65
    v_exp_f32 v66, v66
    v_exp_f32 v67, v67
    v_mfma_f32_32x32x16_bf16 v[80:95], v[172:175], v[196:199], v[80:95]
    ds_read_b128 v[160:163], v50 offset:4096
    ds_read_b64 v[168:169], v51 offset:2048
    s_cmp_ge_u32 s91, 4
    s_cselect_b32 s60, s98, s99
    v_mov_b32 v170, s60
    v_exp_f32 v68, v68
    v_exp_f32 v69, v69
    v_exp_f32 v70, v70
    v_exp_f32 v71, v71
    v_mfma_f32_32x32x16_bf16 v[96:111], v[184:187], v[120:123], v[96:111]
    ds_read_b64_tr_b16 v[176:177], v53 offset:12288
    ds_read_b64_tr_b16 v[178:179], v53 offset:12800
    ds_read_b64_tr_b16 v[180:181], v53 offset:13312
    ds_read_b64_tr_b16 v[182:183], v53 offset:13824
    v_exp_f32 v72, v72
    v_exp_f32 v73, v73
    v_exp_f32 v74, v74
    v_exp_f32 v75, v75
    v_mfma_f32_32x32x16_bf16 v[96:111], v[188:191], v[124:127], v[96:111]
    s_cmp_lg_u32 s90, 0
    s_cbranch_scc1 L_A_nodma2
    s_add_u32 m0, s93, 32768
    s_add_u32 s62, s86, 32768
    buffer_load_dwordx4 v47, s[28:31], s62 offen sc1 lds
    s_add_u32 m0, s93, 40960
    s_add_u32 s62, s86, 40960
    buffer_load_dwordx4 v47, s[28:31], s62 offen sc1 lds
L_A_nodma2:
    v_exp_f32 v76, v76
    v_exp_f32 v77, v77
    v_exp_f32 v78, v78
    v_exp_f32 v79, v79
    v_cvt_pk_bf16_f32 v112, v64, v65
    v_cvt_pk_bf16_f32 v113, v66, v67
    v_cvt_pk_bf16_f32 v114, v68, v69
    v_cvt_pk_bf16_f32 v115, v70, v71
    v_cvt_pk_bf16_f32 v116, v72, v73
    v_cvt_pk_bf16_f32 v117, v74, v75
    v_cvt_pk_bf16_f32 v118, v76, v77
    v_cvt_pk_bf16_f32 v119, v78, v79
    s_waitcnt lgkmcnt(0)
    v_mfma_f32_32x32x16_bf16 v[64:79], v[160:163], v[192:195], 0
    v_exp_f32 v80, v80
    v_exp_f32 v81, v81
    v_exp_f32 v82, v82
    v_exp_f32 v83, v83
    v_mfma_f32_32x32x16_bf16 v[64:79], v[168:171], v[196:199], v[64:79]
    ds_read_b128 v[164:167], v50 offset:3072
    ds_read_b64 v[172:173], v51 offset:1536
    s_cmp_ge_u32 s91, 5
    s_cselect_b32 s60, s98, s99
    v_mov_b32 v174, s60
    v_exp_f32 v84, v84
    v_exp_f32 v85, v85
    v_exp_f32 v86, v86
    v_exp_f32 v87, v87
    v_mfma_f32_32x32x16_bf16 v[96:111], v[176:179], v[112:115], v[96:111]
    ds_read_b64_tr_b16 v[184:185], v53 offset:10240
    ds_read_b64_tr_b16 v[186:187], v53 offset:10752
    ds_read_b64_tr_b16 v[188:189], v53 offset:11264
    ds_read_b64_tr_b16 v[190:191], v53 offset:11776
    v_exp_f32 v88, v88
    v_exp_f32 v89, v89
    v_exp_f32 v90, v90
    v_exp_f32 v91, v91
    v_mfma_f32_32x32x16_bf16 v[96:111], v[180:183], v[116:119], v[96:111]
    s_cmp_lg_u32 s90, 0
    s_cbranch_scc1 L_A_nodma3
    s_add_u32 m0, s93, 49152
    s_add_u32 s62, s86, 49152
    buffer_load_dwordx4 v47, s[28:31], s62 offen sc1 lds
    s_add_u32 m0, s93, 57344
    s_add_u32 s62, s86, 57344
    buffer_load_dwordx4 v47, s[28:31], s62 offen sc1 lds
L_A_nodma3:
    v_exp_f32 v92, v92
    v_exp_f32 v93, v93
    v_exp_f32 v94, v94
    v_exp_f32 v95, v95
    v_cvt_pk_bf16_f32 v120, v80, v81
    v_cvt_pk_bf16_f32 v121, v82, v83
    v_cvt_pk_bf16_f32 v122, v84, v85
    v_cvt_pk_bf16_f32 v123, v86, v87
    v_cvt_pk_bf16_f32 v124, v88, v89
    v_cvt_pk_bf16_f32 v125, v90, v91
    v_cvt_pk_bf16_f32 v126, v92, v93
    v_cvt_pk_bf16_f32 v127, v94, v95
    s_waitcnt lgkmcnt(0)
    v_mfma_f32_32x32x16_bf16 v[80:95], v[164:167], v[192:195], 0
    v_exp_f32 v64, v64
    v_exp_f32 v65, v65
    v_exp_f32 v66, v66
    v_exp_f32 v67, v67
    v_mfma_f32_32x32x16_bf16 v[80:95], v[172:175], v[196:199], v[80:95]
    ds_read_b128 v[160:163], v50 offset:2048
    ds_read_b64 v[168:169], v51 offset:1024
    s_cmp_ge_u32 s91, 6
    s_cselect_b32 s60, s98, s99
    v_mov_b32 v170, s60
    v_exp_f32 v68, v68
    v_exp_f32 v69, v69
    v_exp_f32 v70, v70
    v_exp_f32 v71, v71
    v_mfma_f32_32x32x16_bf16 v[96:111], v[184:187], v[120:123], v[96:111]
    ds_read_b64_tr_b16 v[176:177], v53 offset:8192
    ds_read_b64_tr_b16 v[178:179], v53 offset:8704
    ds_read_b64_tr_b16 v[180:181], v53 offset:9216
    ds_read_b64_tr_b16 v[182:183], v53 offset:9728
    v_exp_f32 v72, v72
    v_exp_f32 v73, v73
    v_exp_f32 v74, v74
    v_exp_f32 v75, v75
    v_mfma_f32_32x32x16_bf16 v[96:111], v[188:191], v[124:127], v[96:111]
    s_cmp_lg_u32 s90, 0
    s_cbranch_scc1 L_A_nodma4
    s_add_u32 m0, s93, 65536
    s_add_u32 s62, s86, 65536
    buffer_load_dwordx4 v47, s[28:31], s62 offen sc1 lds
    s_add_u32 m0, s93, 73728
    s_add_u32 s62, s86, 73728
    buffer_load_dwordx4 v47, s[28:31], s62 offen sc1 lds
L_A_nodma4:
    v_exp_f32 v76, v76
    v_exp_f32 v77, v77
    v_exp_f32 v78, v78
    v_exp_f32 v79, v79
    v_cvt_pk_bf16_f32 v112, v64, v65
    v_cvt_pk_bf16_f32 v113, v66, v67
    v_cvt_pk_bf16_f32 v114, v68, v69
    v_cvt_pk_bf16_f32 v115, v70, v71
    v_cvt_pk_bf16_f32 v116, v72, v73
    v_cvt_pk_bf16_f32 v117, v74, v75
    v_cvt_pk_bf16_f32 v118, v76, v77
    v_cvt_pk_bf16_f32 v119, v78, v79
    s_waitcnt lgkmcnt(0)
    v_mfma_f32_32x32x16_bf16 v[64:79], v[160:163], v[192:195], 0
    v_exp_f32 v80, v80
    v_exp_f32 v81, v81
    v_exp_f32 v82, v82
    v_exp_f32 v83, v83
    v_mfma_f32_32x32x16_bf16 v[64:79], v[168:171], v[196:199], v[64:79]
    ds_read_b128 v[164:167], v50 offset:1024
    ds_read_b64 v[172:173], v51 offset:512
    s_cmp_ge_u32 s91, 7
    s_cselect_b32 s60, s98, s99
    v_mov_b32 v174, s60
    v_exp_f32 v84, v84
    v_exp_f32 v85, v85
    v_exp_f32 v86, v86
    v_exp_f32 v87, v87
    v_mfma_f32_32x32x16_bf16 v[96:111], v[176:179], v[112:115], v[96:111]
    ds_read_b64_tr_b16 v[184:185], v53 offset:6144
    ds_read_b64_tr_b16 v[186:187], v53 offset:6656
    ds_read_b64_tr_b16 v[188:189], v53 offset:7168
    ds_read_b64_tr_b16 v[190:191], v53 offset:7680
    v_exp_f32 v88, v88
    v_exp_f32 v89, v89
    v_exp_f32 v90, v90
    v_exp_f32 v91, v91
    v_mfma_f32_32x32x16_bf16 v[96:111], v[180:183], v[116:119], v[96:111]
    s_cmp_lg_u32 s90, 0
    s_cbranch_scc1 L_A_nodma5
    s_add_u32 m0, s93, 81920
    s_add_u32 s62, s86, 81920
    buffer_load_dwordx4 v47, s[28:31], s62 offen sc1 lds
    s_add_u32 m0, s93, 90112
    s_add_u32 s62, s86, 90112
    buffer_load_dwordx4 v47, s[28:31], s62 offen sc1 lds
    s_cmp_ge_u32 s48, 4
    s_cbranch_scc1 L_A_wo12
    s_add_u32 m0, s93, 98304
    s_add_u32 s62, s86, 98304
    buffer_load_dwordx4 v47, s[28:31], s62 offen sc1 lds
L_A_wo12:
L_A_nodma5:
    v_exp_f32 v92, v92
    v_exp_f32 v93, v93
    v_exp_f32 v94, v94
    v_exp_f32 v95, v95
    v_cvt_pk_bf16_f32 v120, v80, v81
    v_cvt_pk_bf16_f32 v121, v82, v83
    v_cvt_pk_bf16_f32 v122, v84, v85
    v_cvt_pk_bf16_f32 v123, v86, v87
    v_cvt_pk_bf16_f32 v124, v88, v89
    v_cvt_pk_bf16_f32 v125, v90, v91
    v_cvt_pk_bf16_f32 v126, v92, v93
    v_cvt_pk_bf16_f32 v127, v94, v95
    s_waitcnt lgkmcnt(0)
    v_mfma_f32_32x32x16_bf16 v[80:95], v[164:167], v[192:195], 0
    v_exp_f32 v64, v64
    v_exp_f32 v65, v65
    v_exp_f32 v66, v66
    v_exp_f32 v67, v67
    v_mfma_f32_32x32x16_bf16 v[80:95], v[172:175], v[196:199], v[80:95]
    ds_read_b128 v[160:163], v50 offset:0
    ds_read_b64 v[168:169], v51 offset:0
    s_cmp_ge_u32 s91, 8
    s_cselect_b32 s60, s98, s99
    v_mov_b32 v170, s60
    v_exp_f32 v68, v68
    v_exp_f32 v69, v69
    v_exp_f32 v70, v70
    v_exp_f32 v71, v71
    v_mfma_f32_32x32x16_bf16 v[96:111], v[184:187], v[120:123], v[96:111]
    ds_read_b64_tr_b16 v[176:177], v53 offset:4096
    ds_read_b64_tr_b16 v[178:179], v53 offset:4608
    ds_read_b64_tr_b16 v[180:181], v53 offset:5120
    ds_read_b64_tr_b16 v[182:183], v53 offset:5632
    v_exp_f32 v72, v72
    v_exp_f32 v73, v73
    v_exp_f32 v74, v74
    v_exp_f32 v75, v75
    v_mfma_f32_32x32x16_bf16 v[96:111], v[188:191], v[124:127], v[96:111]
    v_exp_f32 v76, v76
    v_exp_f32 v77, v77
    v_exp_f32 v78, v78
    v_exp_f32 v79, v79
    v_cvt_pk_bf16_f32 v112, v64, v65
    v_cvt_pk_bf16_f32 v113, v66, v67
    v_cvt_pk_bf16_f32 v114, v68, v69
    v_cvt_pk_bf16_f32 v115, v70, v71
    v_cvt_pk_bf16_f32 v116, v72, v73
    v_cvt_pk_bf16_f32 v117, v74, v75
    v_cvt_pk_bf16_f32 v118, v76, v77
    v_cvt_pk_bf16_f32 v119, v78, v79
    s_waitcnt lgkmcnt(0)
    v_mfma_f32_32x32x16_bf16 v[64:79], v[160:163], v[192:195], v[144:159]
    v_exp_f32 v80, v80
    v_exp_f32 v81, v81
    v_exp_f32 v82, v82
    v_exp_f32 v83, v83
    v_mfma_f32_32x32x16_bf16 v[64:79], v[168:171], v[196:199], v[64:79]
    v_exp_f32 v84, v84
    v_exp_f32 v85, v85
    v_exp_f32 v86, v86
    v_exp_f32 v87, v87
    v_mfma_f32_32x32x16_bf16 v[96:111], v[176:179], v[112:115], v[96:111]
    ds_read_b64_tr_b16 v[184:185], v53 offset:2048
    ds_read_b64_tr_b16 v[186:187], v53 offset:2560
    ds_read_b64_tr_b16 v[188:189], v53 offset:3072
    ds_read_b64_tr_b16 v[190:191], v53 offset:3584
    v_exp_f32 v88, v88
    v_exp_f32 v89, v89
    v_exp_f32 v90, v90
    v_exp_f32 v91, v91
    v_mfma_f32_32x32x16_bf16 v[96:111], v[180:183], v[116:119], v[96:111]
    v_exp_f32 v92, v92
    v_exp_f32 v93, v93
    v_exp_f32 v94, v94
    v_exp_f32 v95, v95
    v_cvt_pk_bf16_f32 v120, v80, v81
    v_cvt_pk_bf16_f32 v121, v82, v83
    v_cvt_pk_bf16_f32 v122, v84, v85
    v_cvt_pk_bf16_f32 v123, v86, v87
    v_cvt_pk_bf16_f32 v124, v88, v89
    v_cvt_pk_bf16_f32 v125, v90, v91
    v_cvt_pk_bf16_f32 v126, v92, v93
    v_cvt_pk_bf16_f32 v127, v94, v95
    s_waitcnt lgkmcnt(0)
    v_exp_f32 v64, v64
    v_exp_f32 v65, v65
    v_exp_f32 v66, v66
    v_exp_f32 v67, v67
    v_exp_f32 v68, v68
    v_exp_f32 v69, v69
    v_exp_f32 v70, v70
    v_exp_f32 v71, v71
    v_mfma_f32_32x32x16_bf16 v[96:111], v[184:187], v[120:123], v[96:111]
    ds_read_b64_tr_b16 v[176:177], v53 offset:0
    ds_read_b64_tr_b16 v[178:179], v53 offset:512
    ds_read_b64_tr_b16 v[180:181], v53 offset:1024
    ds_read_b64_tr_b16 v[182:183], v53 offset:1536
    v_exp_f32 v72, v72
    v_exp_f32 v73, v73
    v_exp_f32 v74, v74
    v_exp_f32 v75, v75
    v_mfma_f32_32x32x16_bf16 v[96:111], v[188:191], v[124:127], v[96:111]
    v_exp_f32 v76, v76
    v_exp_f32 v77, v77
    v_exp_f32 v78, v78
    v_exp_f32 v79, v79
    v_cvt_pk_bf16_f32 v112, v64, v65
    v_cvt_pk_bf16_f32 v113, v66, v67
    v_cvt_pk_bf16_f32 v114, v68, v69
    v_cvt_pk_bf16_f32 v115, v70, v71
    v_cvt_pk_bf16_f32 v116, v72, v73
    v_cvt_pk_bf16_f32 v117, v74, v75
    v_cvt_pk_bf16_f32 v118, v76, v77
    v_cvt_pk_bf16_f32 v119, v78, v79
    s_waitcnt lgkmcnt(0)
    v_mfma_f32_32x32x16_bf16 v[96:111], v[176:179], v[112:115], v[96:111]
    v_mfma_f32_32x32x16_bf16 v[96:111], v[180:183], v[116:119], v[96:111]
    s_nop 11
    v_mov_b32 v60, v104
    v_mov_b32 v61, v104
    s_nop 1
    v_permlane32_swap_b32 v60, v61
    s_cmp_lg_u32 s90, 0
    s_cbranch_scc1 L_ATT_OK
    v_cmp_gt_f32 vcc, 0x53800000, v61
    s_nop 3
    s_cmp_eq_u64 vcc, -1
    s_cbranch_scc1 L_ATT_OK
    v_mov_b32 v198, 0xf1490000
    v_cndmask_b32 v198, v198, v48, s[88:89]
    v_mov_b32 v199, 0
    v_mov_b32 v59, 0xff61b1e6
    ds_read_b128 v[160:163], v50 offset:8192
    ds_read_b64 v[168:169], v51 offset:4096
    s_cmp_ge_u32 s91, 0
    s_cselect_b32 s60, s98, s99
    v_mov_b32 v170, s60
    s_waitcnt lgkmcnt(0)
    v_mfma_f32_32x32x16_bf16 v[64:79], v[160:163], v[192:195], v[128:143]
    v_mfma_f32_32x32x16_bf16 v[64:79], v[168:171], v[196:199], v[64:79]
    s_nop 11
    v_max3_f32 v59, v64, v65, v59
    v_max3_f32 v59, v66, v67, v59
    v_max3_f32 v59, v68, v69, v59
    v_max3_f32 v59, v70, v71, v59
    v_max3_f32 v59, v72, v73, v59
    v_max3_f32 v59, v74, v75, v59
    v_max3_f32 v59, v76, v77, v59
    v_max3_f32 v59, v78, v79, v59
    ds_read_b128 v[160:163], v50 offset:7168
    ds_read_b64 v[168:169], v51 offset:3584
    s_cmp_ge_u32 s91, 1
    s_cselect_b32 s60, s98, s99
    v_mov_b32 v170, s60
    s_waitcnt lgkmcnt(0)
    v_mfma_f32_32x32x16_bf16 v[64:79], v[160:163], v[192:195], 0
    v_mfma_f32_32x32x16_bf16 v[64:79], v[168:171], v[196:199], v[64:79]
    s_nop 11
    v_max3_f32 v59, v64, v65, v59
    v_max3_f32 v59, v66, v67, v59
    v_max3_f32 v59, v68, v69, v59
    v_max3_f32 v59, v70, v71, v59
    v_max3_f32 v59, v72, v73, v59
    v_max3_f32 v59, v74, v75, v59
    v_max3_f32 v59, v76, v77, v59
    v_max3_f32 v59, v78, v79, v59
    ds_read_b128 v[160:163], v50 offset:6144
    ds_read_b64 v[168:169], v51 offset:3072
    s_cmp_ge_u32 s91, 2
    s_cselect_b32 s60, s98, s99
    v_mov_b32 v170, s60
    s_waitcnt lgkmcnt(0)
    v_mfma_f32_32x32x16_bf16 v[64:79], v[160:163], v[192:195], 0
    v_mfma_f32_32x32x16_bf16 v[64:79], v[168:171], v[196:199], v[64:79]
    s_nop 11
    v_max3_f32 v59, v64, v65, v59
    v_max3_f32 v59, v66, v67, v59
    v_max3_f32 v59, v68, v69, v59
    v_max3_f32 v59, v70, v71, v59
    v_max3_f32 v59, v72, v73, v59
    v_max3_f32 v59, v74, v75, v59
    v_max3_f32 v59, v76, v77, v59
    v_max3_f32 v59, v78, v79, v59
    ds_read_b128 v[160:163], v50 offset:5120
    ds_read_b64 v[168:169], v51 offset:2560
    s_cmp_ge_u32 s91, 3
    s_cselect_b32 s60, s98, s99
    v_mov_b32 v170, s60
    s_waitcnt lgkmcnt(0)
    v_mfma_f32_32x32x16_bf16 v[64:79], v[160:163], v[192:195], 0
    v_mfma_f32_32x32x16_bf16 v[64:79], v[168:171], v[196:199], v[64:79]
    s_nop 11
    v_max3_f32 v59, v64, v65, v59
    v_max3_f32 v59, v66, v67, v59
    v_max3_f32 v59, v68, v69, v59
    v_max3_f32 v59, v70, v71, v59
    v_max3_f32 v59, v72, v73, v59
    v_max3_f32 v59, v74, v75, v59
    v_max3_f32 v59, v76, v77, v59
    v_max3_f32 v59, v78, v79, v59
    ds_read_b128 v[160:163], v50 offset:4096
    ds_read_b64 v[168:169], v51 offset:2048
    s_cmp_ge_u32 s91, 4
    s_cselect_b32 s60, s98, s99
    v_mov_b32 v170, s60
    s_waitcnt lgkmcnt(0)
    v_mfma_f32_32x32x16_bf16 v[64:79], v[160:163], v[192:195], 0
    v_mfma_f32_32x32x16_bf16 v[64:79], v[168:171], v[196:199], v[64:79]
    s_nop 11
    v_max3_f32 v59, v64, v65, v59
    v_max3_f32 v59, v66, v67, v59
    v_max3_f32 v59, v68, v69, v59
    v_max3_f32 v59, v70, v71, v59
    v_max3_f32 v59, v72, v73, v59
    v_max3_f32 v59, v74, v75, v59
    v_max3_f32 v59, v76, v77, v59
    v_max3_f32 v59, v78, v79, v59
    ds_read_b128 v[160:163], v50 offset:3072
    ds_read_b64 v[168:169], v51 offset:1536
    s_cmp_ge_u32 s91, 5
    s_cselect_b32 s60, s98, s99
    v_mov_b32 v170, s60
    s_waitcnt lgkmcnt(0)
    v_mfma_f32_32x32x16_bf16 v[64:79], v[160:163], v[192:195], 0
    v_mfma_f32_32x32x16_bf16 v[64:79], v[168:171], v[196:199], v[64:79]
    s_nop 11
    v_max3_f32 v59, v64, v65, v59
    v_max3_f32 v59, v66, v67, v59
    v_max3_f32 v59, v68, v69, v59
    v_max3_f32 v59, v70, v71, v59
    v_max3_f32 v59, v72, v73, v59
    v_max3_f32 v59, v74, v75, v59
    v_max3_f32 v59, v76, v77, v59
    v_max3_f32 v59, v78, v79, v59
    ds_read_b128 v[160:163], v50 offset:2048
    ds_read_b64 v[168:169], v51 offset:1024
    s_cmp_ge_u32 s91, 6
    s_cselect_b32 s60, s98, s99
    v_mov_b32 v170, s60
    s_waitcnt lgkmcnt(0)
    v_mfma_f32_32x32x16_bf16 v[64:79], v[160:163], v[192:195], 0
    v_mfma_f32_32x32x16_bf16 v[64:79], v[168:171], v[196:199], v[64:79]
    s_nop 11
    v_max3_f32 v59, v64, v65, v59
    v_max3_f32 v59, v66, v67, v59
    v_max3_f32 v59, v68, v69, v59
    v_max3_f32 v59, v70, v71, v59
    v_max3_f32 v59, v72, v73, v59
    v_max3_f32 v59, v74, v75, v59
    v_max3_f32 v59, v76, v77, v59
    v_max3_f32 v59, v78, v79, v59
    ds_read_b128 v[160:163], v50 offset:1024
    ds_read_b64 v[168:169], v51 offset:512
    s_cmp_ge_u32 s91, 7
    s_cselect_b32 s60, s98, s99
    v_mov_b32 v170, s60
    s_waitcnt lgkmcnt(0)
    v_mfma_f32_32x32x16_bf16 v[64:79], v[160:163], v[192:195], 0
    v_mfma_f32_32x32x16_bf16 v[64:79], v[168:171], v[196:199], v[64:79]
    s_nop 11
    v_max3_f32 v59, v64, v65, v59
    v_max3_f32 v59, v66, v67, v59
    v_max3_f32 v59, v68, v69, v59
    v_max3_f32 v59, v70, v71, v59
    v_max3_f32 v59, v72, v73, v59
    v_max3_f32 v59, v74, v75, v59
    v_max3_f32 v59, v76, v77, v59
    v_max3_f32 v59, v78, v79, v59
    ds_read_b128 v[160:163], v50 offset:0
    ds_read_b64 v[168:169], v51 offset:0
    s_cmp_ge_u32 s91, 8
    s_cselect_b32 s60, s98, s99
    v_mov_b32 v170, s60
    s_waitcnt lgkmcnt(0)
    v_mfma_f32_32x32x16_bf16 v[64:79], v[160:163], v[192:195], v[144:159]
    v_mfma_f32_32x32x16_bf16 v[64:79], v[168:171], v[196:199], v[64:79]
    s_nop 11
    v_max3_f32 v59, v64, v65, v59
    v_max3_f32 v59, v66, v67, v59
    v_max3_f32 v59, v68, v69, v59
    v_max3_f32 v59, v70, v71, v59
    v_max3_f32 v59, v72, v73, v59
    v_max3_f32 v59, v74, v75, v59
    v_max3_f32 v59, v76, v77, v59
    v_max3_f32 v59, v78, v79, v59
    v_mov_b32 v54, v59
    s_mov_b32 s90, 1
    s_branch L_ATT_MAIN
L_ATT_OK:
    v_rcp_f32 v61, v61
    s_nop 0
    v_mul_f32 v96, v61, v96
    v_mul_f32 v97, v61, v97
    v_mul_f32 v98, v61, v98
    v_mul_f32 v99, v61, v99
    v_mul_f32 v100, v61, v100
    v_mul_f32 v101, v61, v101
    v_mul_f32 v102, v61, v102
    v_mul_f32 v103, v61, v103
    v_mul_f32 v104, v61, v104
    v_mul_f32 v105, v61, v105
    v_mul_f32 v106, v61, v106
    v_mul_f32 v107, v61, v107
    v_cvt_pk_bf16_f32 v112, v96, v97
    v_cvt_pk_bf16_f32 v113, v98, v99
    v_cvt_pk_bf16_f32 v114, v100, v101
    v_cvt_pk_bf16_f32 v115, v102, v103
    v_cvt_pk_bf16_f32 v116, v104, v105
    v_cvt_pk_bf16_f32 v117, v106, v107
    v_lshrrev_b32 v6, 4, v3
    v_mul_u32_u24 v6, 20480, v6
    v_and_b32 v7, 15, v3
    v_lshl_add_u32 v6, v7, 4, v6
    v_lshl_add_u32 v7, v2, 8, v6
    s_mul_i32 s60, s91, 40960
    s_add_u32 s60, s60, 8388608
    s_lshr_b32 s61, s50, 1
    s_lshl_b32 s61, s61, 10
    s_and_b32 s62, s50, 1
    s_lshl_b32 s62, s62, 9
    s_add_u32 s61, s61, s62
    s_add_u32 s61, s61, s60
    buffer_store_dwordx4 v[112:115], v7, s[28:31], s61 offen sc1
    s_lshr_b32 s61, s50, 3
    s_add_u32 s61, s61, 16
    s_lshl_b32 s61, s61, 10
    s_bfe_u32 s62, s50, 0x20001
    s_lshl_b32 s62, s62, 8
    s_add_u32 s61, s61, s62
    s_and_b32 s62, s50, 1
    s_lshl_b32 s62, s62, 3
    s_add_u32 s61, s61, s62
    s_add_u32 s61, s61, s60
    s_mov_b32 exec_hi, 0
    buffer_store_dwordx2 v[116:117], v6, s[28:31], s61 offen sc1
    s_mov_b32 exec_hi, -1
    s_waitcnt vmcnt(0)
    s_barrier
    s_cmp_ge_u32 s48, 4
    s_cbranch_scc1 L_H_W
    s_branch L_M_W
L_end:
    s_endpgm
.p2align 6
L_TAB:
.long 0, 16, 32, 48, 64, 80, 96, 112, 128, 144, 1280, 1296, 1312, 1328, 1344, 1360, 1376, 1392, 1408, 1424, 2560, 2576, 2592, 2608, 2624, 2640, 2656, 2672, 2688, 2704, 3840, 3856, 3872, 3888, 3904, 3920, 3936, 3952, 3968, 3984, 5120, 5136, 5152, 5168, 5184, 5200, 5216, 5232, 5248, 5264, 6400, 6416, 6432, 6448, 6464, 6480, 6496, 6512, 6528, 6544, 7680, 7696, 7712, 7728
.long 7744, 7760, 7776, 7792, 7808, 7824, 8960, 8976, 8992, 9008, 9024, 9040, 9056, 9072, 9088, 9104, 30720, 30736, 30752, 30768, 30784, 30800, 30816, 30832, 30848, 30864, 32000, 32016, 32032, 32048, 32064, 32080, 32096, 32112, 32128, 32144, 33280, 33296, 33312, 33328, 33344, 33360, 33376, 33392, 33408, 33424, 34560, 34576, 34592, 34608, 34624, 34640, 34656, 34672, 34688, 34704, 35840, 35856, 35872, 35888, 35904, 35920, 35936, 35952
.long 35968, 35984, 37120, 37136, 37152, 37168, 37184, 37200, 37216, 37232, 37248, 37264, 38400, 38416, 38432, 38448, 38464, 38480, 38496, 38512, 38528, 38544, 39680, 39696, 39712, 39728, 39744, 39760, 39776, 39792, 39808, 39824, 10240, 10256, 10272, 10288, 10304, 10320, 10336, 10352, 10368, 10384, 11520, 11536, 11552, 11568, 11584, 11600, 11616, 11632, 11648, 11664, 12800, 12816, 12832, 12848, 12864, 12880, 12896, 12912, 12928, 12944, 14080, 14096
.long 14112, 14128, 14144, 14160, 14176, 14192, 14208, 14224, 15360, 15376, 15392, 15408, 15424, 15440, 15456, 15472, 15488, 15504, 16640, 16656, 16672, 16688, 16704, 16720, 16736, 16752, 16768, 16784, 17920, 17936, 17952, 17968, 17984, 18000, 18016, 18032, 18048, 18064, 19200, 19216, 19232, 19248, 19264, 19280, 19296, 19312, 19328, 19344, 40960, 40976, 40992, 41008, 41024, 41040, 41056, 41072, 41088, 41104, 42240, 42256, 42272, 42288, 42304, 42320
.long 42336, 42352, 42368, 42384, 43520, 43536, 43552, 43568, 43584, 43600, 43616, 43632, 43648, 43664, 44800, 44816, 44832, 44848, 44864, 44880, 44896, 44912, 44928, 44944, 46080, 46096, 46112, 46128, 46144, 46160, 46176, 46192, 46208, 46224, 47360, 47376, 47392, 47408, 47424, 47440, 47456, 47472, 47488, 47504, 48640, 48656, 48672, 48688, 48704, 48720, 48736, 48752, 48768, 48784, 49920, 49936, 49952, 49968, 49984, 50000, 50016, 50032, 50048, 50064
.long 20480, 20496, 20512, 20528, 20544, 20560, 20576, 20592, 20608, 20624, 21760, 21776, 21792, 21808, 21824, 21840, 21856, 21872, 21888, 21904, 23040, 23056, 23072, 23088, 23104, 23120, 23136, 23152, 23168, 23184, 24320, 24336, 24352, 24368, 24384, 24400, 24416, 24432, 24448, 24464, 71680, 71696, 71712, 71728, 71744, 71760, 71776, 71792, 71808, 71824, 72960, 72976, 72992, 73008, 73024, 73040, 73056, 73072, 73088, 73104, 74240, 74256, 74272, 74288
.long 74304, 74320, 74336, 74352, 74368, 74384, 75520, 75536, 75552, 75568, 75584, 75600, 75616, 75632, 75648, 75664, 122880, 122896, 122912, 122928, 122944, 122960, 122976, 122992, 123008, 123024, 124160, 124176, 124192, 124208, 124224, 124240, 124256, 124272, 124288, 124304, 125440, 125456, 125472, 125488, 125504, 125520, 125536, 125552, 125568, 125584, 126720, 126736, 126752, 126768, 126784, 126800, 126816, 126832, 126848, 126864, 174080, 174096, 174112, 174128, 174144, 174160, 174176, 174192
.long 174208, 174224, 175360, 175376, 175392, 175408, 175424, 175440, 175456, 175472, 175488, 175504, 176640, 176656, 176672, 176688, 176704, 176720, 176736, 176752, 176768, 176784, 177920, 177936, 177952, 177968, 177984, 178000, 178016, 178032, 178048, 178064, 25600, 25616, 25632, 25648, 25664, 25680, 25696, 25712, 25728, 25744, 26880, 26896, 26912, 26928, 26944, 26960, 26976, 26992, 27008, 27024, 28160, 28176, 28192, 28208, 28224, 28240, 28256, 28272, 28288, 28304, 29440, 29456
.long 29472, 29488, 29504, 29520, 29536, 29552, 29568, 29584, 76800, 76816, 76832, 76848, 76864, 76880, 76896, 76912, 76928, 76944, 78080, 78096, 78112, 78128, 78144, 78160, 78176, 78192, 78208, 78224, 79360, 79376, 79392, 79408, 79424, 79440, 79456, 79472, 79488, 79504, 80640, 80656, 80672, 80688, 80704, 80720, 80736, 80752, 80768, 80784, 128000, 128016, 128032, 128048, 128064, 128080, 128096, 128112, 128128, 128144, 129280, 129296, 129312, 129328, 129344, 129360
.long 129376, 129392, 129408, 129424, 130560, 130576, 130592, 130608, 130624, 130640, 130656, 130672, 130688, 130704, 131840, 131856, 131872, 131888, 131904, 131920, 131936, 131952, 131968, 131984, 179200, 179216, 179232, 179248, 179264, 179280, 179296, 179312, 179328, 179344, 180480, 180496, 180512, 180528, 180544, 180560, 180576, 180592, 180608, 180624, 181760, 181776, 181792, 181808, 181824, 181840, 181856, 181872, 181888, 181904, 183040, 183056, 183072, 183088, 183104, 183120, 183136, 183152, 183168, 183184
.long 0, 16, 32, 48, 64, 80, 96, 112, 128, 144, 1280, 1296, 1312, 1328, 1344, 1360, 1376, 1392, 1408, 1424, 2560, 2576, 2592, 2608, 2624, 2640, 2656, 2672, 2688, 2704, 3840, 3856, 3872, 3888, 3904, 3920, 3936, 3952, 3968, 3984, 10240, 10256, 10272, 10288, 10304, 10320, 10336, 10352, 10368, 10384, 11520, 11536, 11552, 11568, 11584, 11600, 11616, 11632, 11648, 11664, 12800, 12816, 12832, 12848
.long 12864, 12880, 12896, 12912, 12928, 12944, 14080, 14096, 14112, 14128, 14144, 14160, 14176, 14192, 14208, 14224, 20480, 20496, 20512, 20528, 20544, 20560, 20576, 20592, 20608, 20624, 21760, 21776, 21792, 21808, 21824, 21840, 21856, 21872, 21888, 21904, 23040, 23056, 23072, 23088, 23104, 23120, 23136, 23152, 23168, 23184, 24320, 24336, 24352, 24368, 24384, 24400, 24416, 24432, 24448, 24464, 30720, 30736, 30752, 30768, 30784, 30800, 30816, 30832
.long 30848, 30864, 32000, 32016, 32032, 32048, 32064, 32080, 32096, 32112, 32128, 32144, 33280, 33296, 33312, 33328, 33344, 33360, 33376, 33392, 33408, 33424, 34560, 34576, 34592, 34608, 34624, 34640, 34656, 34672, 34688, 34704, 5120, 5136, 5152, 5168, 5184, 5200, 5216, 5232, 5248, 5264, 6400, 6416, 6432, 6448, 6464, 6480, 6496, 6512, 6528, 6544, 7680, 7696, 7712, 7728, 7744, 7760, 7776, 7792, 7808, 7824, 8960, 8976
.long 8992, 9008, 9024, 9040, 9056, 9072, 9088, 9104, 15360, 15376, 15392, 15408, 15424, 15440, 15456, 15472, 15488, 15504, 16640, 16656, 16672, 16688, 16704, 16720, 16736, 16752, 16768, 16784, 17920, 17936, 17952, 17968, 17984, 18000, 18016, 18032, 18048, 18064, 19200, 19216, 19232, 19248, 19264, 19280, 19296, 19312, 19328, 19344, 25600, 25616, 25632, 25648, 25664, 25680, 25696, 25712, 25728, 25744, 26880, 26896, 26912, 26928, 26944, 26960
.long 26976, 26992, 27008, 27024, 28160, 28176, 28192, 28208, 28224, 28240, 28256, 28272, 28288, 28304, 29440, 29456, 29472, 29488, 29504, 29520, 29536, 29552, 29568, 29584, 35840, 35856, 35872, 35888, 35904, 35920, 35936, 35952, 35968, 35984, 37120, 37136, 37152, 37168, 37184, 37200, 37216, 37232, 37248, 37264, 38400, 38416, 38432, 38448, 38464, 38480, 38496, 38512, 38528, 38544, 39680, 39696, 39712, 39728, 39744, 39760, 39776, 39792, 39808, 39824
L_TABEND:

.section .rodata,"a"
.p2align 6
.amdhsa_kernel sequential_preLN__sliding_block__dense_activation_gelu__prompt_kernel
  .amdhsa_next_free_vgpr 256
  .amdhsa_next_free_sgpr 100
  .amdhsa_accum_offset 256
  .amdhsa_group_segment_fixed_size 0
  .amdhsa_kernarg_size 88
  .amdhsa_user_sgpr_count 2
  .amdhsa_user_sgpr_kernarg_segment_ptr 1
  .amdhsa_system_sgpr_workgroup_id_x 1
.end_amdhsa_kernel
```
